```python
import torch

def _softmax(x, axis=-1):
    return torch.softmax(x, dim=axis)
def _gelu(x):
    return torch.nn.functional.gelu(x, approximate="tanh")
def _silu(x):
    return torch.nn.functional.silu(x)
def _sigmoid(x):
    return torch.sigmoid(x)
def _layernorm(x, axis=-1, eps=1e-5):
    m = x.mean(dim=axis, keepdim=True)
    v = x.var(dim=axis, keepdim=True, unbiased=False)
    return (x - m) / torch.sqrt(v + eps)
def _scatter_add(tgt, idx, src, axis=0):
    return tgt.clone().index_add_(axis, idx, src)
def _segment_sum(src, seg, n):
    out = torch.zeros((n,) + src.shape[1:], dtype=src.dtype)
    return out.index_add_(0, seg, src)
def _pad(x, pw):
    flat = tuple(v for pair in reversed(pw) for v in pair)
    return torch.nn.functional.pad(x, flat)

kernel_name = 'standalone__convnext_block__vision'

def setup_inputs():

    _w = (lambda a: (lambda t: t.to(torch.bfloat16) if t.is_floating_point() else t)(torch.as_tensor(a)))
    H = W = 224
    C = 192
    return {
        "x": _w((lambda *s: torch.randn(*s, dtype=torch.bfloat16) * 0.05)(1, H, W, C)),
        "dw": _w((lambda *s: torch.randn(*s, dtype=torch.bfloat16) * 0.05)(7, 7, C)),
        "w1": _w((lambda *s: torch.randn(*s, dtype=torch.bfloat16) * 0.05)(C, 4 * C)),
        "w2": _w((lambda *s: torch.randn(*s, dtype=torch.bfloat16) * 0.05)(4 * C, C)),
    }

def reference(x, dw, w1, w2):
    B, H, W, C = x.shape
    pad = 3
    xp = _pad(x, ((0,0),(pad,pad),(pad,pad),(0,0)))
    out = torch.zeros_like(x)
    for i in range(7):
        for j in range(7):
            out = out + xp[:, i:i+H, j:j+W, :] * dw[i, j][None, None, None, :]
    h = _layernorm(out, axis=-1)
    return x + _gelu(h @ w1) @ w2
```

```asm
; @launch grid=(256,1,1) block=(256,1,1) lds=163840
.amdgcn_target "amdgcn-amd-amdhsa--gfx950"
.text
.globl standalone__convnext_block__vision_kernel
.p2align 8
.type standalone__convnext_block__vision_kernel,@function
standalone__convnext_block__vision_kernel:
    s_cmp_ge_u32 s2, 0x100
    s_cbranch_scc1 L_END
    s_load_dwordx2 s[16:17], s[0:1], 0
    s_load_dwordx2 s[20:21], s[0:1], 8
    s_load_dwordx2 s[24:25], s[0:1], 16
    s_load_dwordx2 s[28:29], s[0:1], 24
    s_load_dwordx2 s[32:33], s[0:1], 32
    s_getpc_b64 s[4:5]
L_PC:
    s_mov_b32 s6, L_TEND-L_PC
    s_mov_b32 s7, 0x20000
    s_bfe_u32 s63, s2, 0x30003
    s_lshl_b32 s63, s63, 7
    v_lshlrev_b32 v230, 10, v0
    buffer_load_dword a55, v230, s[4:7], s63 offen
    v_lshlrev_b32 v247, 4, v0
    v_lshrrev_b32 v200, 6, v0
    v_lshrrev_b32 v201, 3, v0
    v_readfirstlane_b32 s36, v200
    v_and_b32 v202, 7, v0
    v_and_b32 v63, 63, v0
    s_lshr_b32 s39, s2, 6
    s_lshl_b32 s63, s2, 1
    s_and_b32 s63, s63, 12
    s_add_u32 s39, s39, s63
    s_bfe_u32 s40, s2, 0x30003
    s_lshl_b32 s63, s2, 3
    s_and_b32 s63, s63, 8
    s_add_u32 s40, s40, s63
    s_mul_i32 s42, s39, 0x126000
    s_mul_i32 s40, s40, 14
    s_mul_i32 s63, s40, 0x180
    s_add_u32 s42, s42, s63
    s_sub_u32 s41, s42, 0x3f480
    s_sub_u32 s40, s40, 3
    s_mov_b32 s18, 0x1260000
    s_mov_b32 s19, 0x20000
    s_mov_b32 s68, 0xffffffec
    s_movk_i32 s69, 0x180
    v_mov_b32 v203, 0x80000000
    s_lshl_b32 s46, s36, 10
    v_mul_u32_u24 v205, 0xccd, v201
    v_lshrrev_b32 v205, 16, v205
    v_mad_i32_i24 v206, v205, s68, v201
    v_add_u32 v207, s40, v206
    v_cmp_gt_u32 vcc, 0xe0, v207
    v_bfe_u32 v207, v206, 1, 3
    v_xor_b32 v207, v207, v202
    v_mul_u32_u24 v208, 0x15000, v205
    v_mad_u32_u24 v208, v206, s69, v208
    v_lshl_add_u32 v208, v207, 4, v208
    v_add_u32 v208, s41, v208
    v_cndmask_b32 v32, v203, v208, vcc
    v_add_u32 v37, 0xa8000, v32
    s_add_u32 s63, s46, 0xc000
    s_cmp_lt_u32 s36, 2
    s_cselect_b32 s53, 0xa8000, 0x40000000
    s_cselect_b32 s47, s63, 0x28000
    s_mov_b32 s50, 0xa8000
    s_waitcnt lgkmcnt(0)
    s_add_u32 m0, s46, 0x1b800
    s_nop 0
    buffer_load_dwordx4 v32, s[16:19], 0 offen lds
    s_add_u32 m0, s46, 0x20800
    s_nop 0
    buffer_load_dwordx4 v37, s[16:19], 0 offen lds
    s_add_u32 m0, s46, 0x25800
    s_nop 0
    buffer_load_dwordx4 v37, s[16:19], s50 offen lds
    v_add_u32 v204, 32, v201
    v_mul_u32_u24 v205, 0xccd, v204
    v_lshrrev_b32 v205, 16, v205
    v_mad_i32_i24 v206, v205, s68, v204
    v_add_u32 v207, s40, v206
    v_cmp_gt_u32 vcc, 0xe0, v207
    v_bfe_u32 v207, v206, 1, 3
    v_xor_b32 v207, v207, v202
    v_mul_u32_u24 v208, 0x15000, v205
    v_mad_u32_u24 v208, v206, s69, v208
    v_lshl_add_u32 v208, v207, 4, v208
    v_add_u32 v208, s41, v208
    v_cndmask_b32 v33, v203, v208, vcc
    v_add_u32 v38, 0xa8000, v33
    s_add_u32 m0, s46, 0x1c800
    s_nop 0
    buffer_load_dwordx4 v33, s[16:19], 0 offen lds
    s_add_u32 m0, s46, 0x21800
    s_nop 0
    buffer_load_dwordx4 v38, s[16:19], 0 offen lds
    s_add_u32 m0, s46, 0x26800
    s_nop 0
    buffer_load_dwordx4 v38, s[16:19], s50 offen lds
    v_add_u32 v204, 64, v201
    v_mul_u32_u24 v205, 0xccd, v204
    v_lshrrev_b32 v205, 16, v205
    v_mad_i32_i24 v206, v205, s68, v204
    v_add_u32 v207, s40, v206
    v_cmp_gt_u32 vcc, 0xe0, v207
    v_bfe_u32 v207, v206, 1, 3
    v_xor_b32 v207, v207, v202
    v_mul_u32_u24 v208, 0x15000, v205
    v_mad_u32_u24 v208, v206, s69, v208
    v_lshl_add_u32 v208, v207, 4, v208
    v_add_u32 v208, s41, v208
    v_cndmask_b32 v34, v203, v208, vcc
    v_add_u32 v39, 0xa8000, v34
    v_add_u32 v204, 0x60, v201
    v_mul_u32_u24 v205, 0xccd, v204
    v_lshrrev_b32 v205, 16, v205
    v_mad_i32_i24 v206, v205, s68, v204
    v_add_u32 v207, s40, v206
    v_cmp_gt_u32 vcc, 0xe0, v207
    v_bfe_u32 v207, v206, 1, 3
    v_xor_b32 v207, v207, v202
    v_mul_u32_u24 v208, 0x15000, v205
    v_mad_u32_u24 v208, v206, s69, v208
    v_lshl_add_u32 v208, v207, 4, v208
    v_add_u32 v208, s41, v208
    v_cndmask_b32 v35, v203, v208, vcc
    v_add_u32 v40, 0xa8000, v35
    v_add_u32 v204, 0x80, v201
    v_mul_u32_u24 v205, 0xccd, v204
    v_lshrrev_b32 v205, 16, v205
    v_mad_i32_i24 v206, v205, s68, v204
    v_add_u32 v207, s40, v206
    v_cmp_gt_u32 vcc, 0xe0, v207
    v_bfe_u32 v207, v206, 1, 3
    v_xor_b32 v207, v207, v202
    v_mul_u32_u24 v208, 0x15000, v205
    v_mad_u32_u24 v208, v206, s69, v208
    v_lshl_add_u32 v208, v207, 4, v208
    v_add_u32 v208, s41, v208
    v_cndmask_b32 v36, v203, v208, vcc
    v_add_u32 v41, 0xa8000, v36
    s_mov_b32 s22, 0x4980
    s_mov_b32 s23, 0x20000
    s_mul_i32 s63, s36, 0x140
    v_add_u32 v204, s63, v63
    s_mul_i32 s64, s36, 0x1400
    s_add_u32 s64, s64, 0x16800
    v_add_u32 v205, 0, v204
    v_mul_u32_u24 v206, 0xa3e, v205
    v_lshrrev_b32 v206, 16, v206
    v_sub_u32 v205, v205, v206
    v_lshlrev_b32 v210, 4, v205
    s_add_u32 m0, s64, 0
    s_nop 0
    buffer_load_dwordx4 v210, s[20:23], 0 offen lds
    v_add_u32 v205, 64, v204
    v_mul_u32_u24 v206, 0xa3e, v205
    v_lshrrev_b32 v206, 16, v206
    v_sub_u32 v205, v205, v206
    v_lshlrev_b32 v211, 4, v205
    s_add_u32 m0, s64, 0x400
    s_nop 0
    buffer_load_dwordx4 v211, s[20:23], 0 offen lds
    v_add_u32 v205, 0x80, v204
    v_mul_u32_u24 v206, 0xa3e, v205
    v_lshrrev_b32 v206, 16, v206
    v_sub_u32 v205, v205, v206
    v_lshlrev_b32 v212, 4, v205
    s_add_u32 m0, s64, 0x800
    s_nop 0
    buffer_load_dwordx4 v212, s[20:23], 0 offen lds
    v_add_u32 v205, 0xc0, v204
    v_mul_u32_u24 v206, 0xa3e, v205
    v_lshrrev_b32 v206, 16, v206
    v_sub_u32 v205, v205, v206
    v_lshlrev_b32 v213, 4, v205
    s_add_u32 m0, s64, 0xc00
    s_nop 0
    buffer_load_dwordx4 v213, s[20:23], 0 offen lds
    v_add_u32 v205, 0x100, v204
    v_mul_u32_u24 v206, 0xa3e, v205
    v_lshrrev_b32 v206, 16, v206
    v_sub_u32 v205, v205, v206
    v_lshlrev_b32 v214, 4, v205
    s_add_u32 m0, s64, 0x1000
    s_nop 0
    buffer_load_dwordx4 v214, s[20:23], 0 offen lds
    s_mov_b32 s26, 0x48000
    s_mov_b32 s27, 0x20000
    s_mov_b32 s30, 0x48000
    s_mov_b32 s31, 0x20000
    s_add_u32 s8, s4, L_TAB-L_PC
    s_addc_u32 s9, s5, 0
    s_mov_b32 s10, 0xe000
    s_mov_b32 s11, 0x20000
    s_mov_b32 s34, 0x1260000
    s_mov_b32 s35, 0x20000
    s_lshr_b32 s37, s36, 1
    s_and_b32 s38, s36, 1
    s_xor_b32 s43, s37, s38
    s_mov_b32 s67, 0xbef00000
    s_mov_b32 s59, 0x44e944e9
    s_mov_b32 s73, 0xb780b780
    s_movk_i32 s48, 0x80
    s_movk_i32 s49, 0x100
    s_add_u32 s51, s50, 0x80
    s_add_u32 s54, s53, 0x80
    s_add_u32 s52, s50, 0x100
    s_add_u32 s55, s53, 0x100
    s_mov_b32 s44, 0xcccccccc
    s_mov_b32 s45, 0xcccccccc
    v_and_b32 v200, 3, v63
    v_bfe_u32 v201, v63, 2, 2
    v_lshrrev_b32 v202, 4, v63
    v_and_b32 v203, 1, v202
    v_lshrrev_b32 v204, 5, v63
    v_lshlrev_b32 v205, 4, v63
    v_mul_u32_u24 v206, 20, v204
    v_add_u32 v206, v206, v203
    v_lshlrev_b32 v206, 7, v206
    s_lshl_b32 s63, s37, 2
    s_lshl_b32 s64, s38, 6
    v_add_u32 v209, s63, v200
    v_min_u32 v209, 6, v209
    v_add_u32 v209, v209, v201
    v_lshl_add_u32 v215, v209, 8, v206
    v_and_b32 v209, 7, v209
    v_lshl_add_u32 v215, v209, 4, v215
    v_xor_b32 v215, s64, v215
    v_add_u32 v64, 0x1b800, v215
    v_xor_b32 v65, 16, v64
    v_xor_b32 v66, 32, v64
    v_xor_b32 v67, 48, v64
    v_lshrrev_b32 v207, 1, v200
    v_and_b32 v208, 1, v200
    v_lshl_add_u32 v209, v201, 1, v203
    v_sub_u32 v209, v209, v208
    v_sub_u32 v215, v204, v207
    s_movk_i32 s69, 0x190
    s_add_u32 s63, s64, 0x16800
    v_mov_b32 v218, s63
    s_add_u32 s63, s63, 0x4c90
    v_add_u32 v217, 0, v215
    v_mad_i32_i24 v216, v217, 7, v209
    v_max_u32 v217, v217, v209
    v_cmp_gt_u32 vcc, 7, v217
    v_mad_u32_u24 v216, v216, s69, v218
    v_sub_u32 v219, 22, v204
    v_and_b32 v219, 15, v219
    v_lshl_add_u32 v219, v219, 4, s63
    v_cndmask_b32 v72, v219, v216, vcc
    v_add_u32 v217, 2, v215
    v_mad_i32_i24 v216, v217, 7, v209
    v_max_u32 v217, v217, v209
    v_cmp_gt_u32 vcc, 7, v217
    v_mad_u32_u24 v216, v216, s69, v218
    v_sub_u32 v219, 20, v204
    v_and_b32 v219, 15, v219
    v_lshl_add_u32 v219, v219, 4, s63
    v_cndmask_b32 v73, v219, v216, vcc
    v_add_u32 v217, 4, v215
    v_mad_i32_i24 v216, v217, 7, v209
    v_max_u32 v217, v217, v209
    v_cmp_gt_u32 vcc, 7, v217
    v_mad_u32_u24 v216, v216, s69, v218
    v_sub_u32 v219, 18, v204
    v_and_b32 v219, 15, v219
    v_lshl_add_u32 v219, v219, 4, s63
    v_cndmask_b32 v74, v219, v216, vcc
    v_add_u32 v217, 6, v215
    v_mad_i32_i24 v216, v217, 7, v209
    v_max_u32 v217, v217, v209
    v_cmp_gt_u32 vcc, 7, v217
    v_mad_u32_u24 v216, v216, s69, v218
    v_sub_u32 v219, 16, v204
    v_and_b32 v219, 15, v219
    v_lshl_add_u32 v219, v219, 4, s63
    v_cndmask_b32 v75, v219, v216, vcc
    s_mul_i32 s61, s36, 0x12000
    s_mul_i32 s62, s36, 0x1800
    s_add_u32 s65, s62, 0x1c000
    s_mov_b32 s66, s62
    s_mov_b32 vcc_lo, 0xaaaaaaaa
    s_mov_b32 vcc_hi, 0xaaaaaaaa
    s_add_u32 m0, s46, 0x1d800
    s_nop 0
    buffer_load_dwordx4 v34, s[16:19], 0 offen lds
    s_add_u32 m0, s46, 0x22800
    s_nop 0
    buffer_load_dwordx4 v39, s[16:19], 0 offen lds
    s_add_u32 m0, s46, 0x27800
    s_nop 0
    buffer_load_dwordx4 v39, s[16:19], s53 offen lds
    s_add_u32 m0, s46, 0x1e800
    s_nop 0
    buffer_load_dwordx4 v35, s[16:19], 0 offen lds
    s_add_u32 m0, s46, 0x23800
    s_nop 0
    buffer_load_dwordx4 v40, s[16:19], 0 offen lds
    s_add_u32 m0, s46, 0x1f800
    s_nop 0
    buffer_load_dwordx4 v36, s[16:19], 0 offen lds
    s_add_u32 m0, s46, 0x24800
    s_nop 0
    buffer_load_dwordx4 v41, s[16:19], 0 offen lds
    s_waitcnt vmcnt(7)
    s_barrier
    ds_read_b64_tr_b16 a[96:97], v72
    ds_read_b64_tr_b16 a[98:99], v73
    ds_read_b64_tr_b16 a[100:101], v74
    ds_read_b64_tr_b16 a[102:103], v75
    s_add_u32 m0, s46, 0
    s_nop 0
    buffer_load_dwordx4 v32, s[16:19], s48 offen lds
    ds_read_b64_tr_b16 a[104:105], v72 offset:8
    ds_read_b64_tr_b16 a[106:107], v73 offset:8
    ds_read_b64_tr_b16 a[108:109], v74 offset:8
    ds_read_b64_tr_b16 a[110:111], v75 offset:8
    ds_read_b64_tr_b16 a[112:113], v72 offset:16
    ds_read_b64_tr_b16 a[114:115], v73 offset:16
    ds_read_b64_tr_b16 a[116:117], v74 offset:16
    ds_read_b64_tr_b16 a[118:119], v75 offset:16
    ds_read_b64_tr_b16 a[120:121], v72 offset:24
    ds_read_b64_tr_b16 a[122:123], v73 offset:24
    ds_read_b64_tr_b16 a[124:125], v74 offset:24
    ds_read_b64_tr_b16 a[126:127], v75 offset:24
    ds_read_b64_tr_b16 a[128:129], v72 offset:32
    ds_read_b64_tr_b16 a[130:131], v73 offset:32
    ds_read_b64_tr_b16 a[132:133], v74 offset:32
    ds_read_b64_tr_b16 a[134:135], v75 offset:32
    s_add_u32 m0, s46, 0x1000
    s_nop 0
    buffer_load_dwordx4 v33, s[16:19], s48 offen lds
    ds_read_b64_tr_b16 a[216:217], v72 offset:40
    ds_read_b64_tr_b16 a[218:219], v73 offset:40
    ds_read_b64_tr_b16 a[220:221], v74 offset:40
    ds_read_b64_tr_b16 a[222:223], v75 offset:40
    ds_read_b64_tr_b16 a[144:145], v72 offset:48
    ds_read_b64_tr_b16 a[146:147], v73 offset:48
    ds_read_b64_tr_b16 a[148:149], v74 offset:48
    ds_read_b64_tr_b16 a[150:151], v75 offset:48
    ds_read_b64_tr_b16 a[152:153], v72 offset:56
    ds_read_b64_tr_b16 a[154:155], v73 offset:56
    ds_read_b64_tr_b16 a[156:157], v74 offset:56
    ds_read_b64_tr_b16 a[158:159], v75 offset:56
    ds_read_b64_tr_b16 a[160:161], v72 offset:128
    ds_read_b64_tr_b16 a[162:163], v73 offset:128
    ds_read_b64_tr_b16 a[164:165], v74 offset:128
    s_add_u32 m0, s46, 0x2000
    s_nop 0
    buffer_load_dwordx4 v34, s[16:19], s48 offen lds
    ds_read_b64_tr_b16 a[166:167], v75 offset:128
    ds_read_b64_tr_b16 a[168:169], v72 offset:136
    ds_read_b64_tr_b16 a[170:171], v73 offset:136
    ds_read_b64_tr_b16 a[172:173], v74 offset:136
    ds_read_b64_tr_b16 a[174:175], v75 offset:136
    ds_read_b64_tr_b16 a[176:177], v72 offset:144
    ds_read_b64_tr_b16 a[178:179], v73 offset:144
    ds_read_b64_tr_b16 a[180:181], v74 offset:144
    ds_read_b64_tr_b16 a[182:183], v75 offset:144
    ds_read_b64_tr_b16 a[184:185], v72 offset:152
    ds_read_b64_tr_b16 a[186:187], v73 offset:152
    ds_read_b64_tr_b16 a[188:189], v74 offset:152
    ds_read_b64_tr_b16 a[190:191], v75 offset:152
    ds_read_b64_tr_b16 a[224:225], v72 offset:160
    ds_read_b64_tr_b16 a[226:227], v73 offset:160
    s_add_u32 m0, s46, 0x3000
    s_nop 0
    buffer_load_dwordx4 v35, s[16:19], s48 offen lds
    ds_read_b64_tr_b16 a[228:229], v74 offset:160
    ds_read_b64_tr_b16 a[230:231], v75 offset:160
    ds_read_b64_tr_b16 a[232:233], v72 offset:168
    ds_read_b64_tr_b16 a[234:235], v73 offset:168
    ds_read_b64_tr_b16 a[236:237], v74 offset:168
    ds_read_b64_tr_b16 a[238:239], v75 offset:168
    ds_read_b64_tr_b16 a[248:249], v72 offset:176
    ds_read_b64_tr_b16 a[250:251], v73 offset:176
    ds_read_b64_tr_b16 a[252:253], v74 offset:176
    ds_read_b64_tr_b16 a[254:255], v75 offset:176
    ds_read_b64_tr_b16 a[56:57], v72 offset:184
    ds_read_b64_tr_b16 a[58:59], v73 offset:184
    ds_read_b64_tr_b16 a[60:61], v74 offset:184
    ds_read_b64_tr_b16 a[62:63], v75 offset:184
    ds_read_b64_tr_b16 a[64:65], v72 offset:256
    ds_read_b64_tr_b16 a[66:67], v73 offset:256
    s_add_u32 m0, s46, 0x4000
    s_nop 0
    buffer_load_dwordx4 v36, s[16:19], s48 offen lds
    ds_read_b64_tr_b16 a[68:69], v74 offset:256
    ds_read_b64_tr_b16 a[70:71], v75 offset:256
    ds_read_b64_tr_b16 a[72:73], v72 offset:264
    ds_read_b64_tr_b16 a[74:75], v73 offset:264
    ds_read_b64_tr_b16 a[76:77], v74 offset:264
    ds_read_b64_tr_b16 a[78:79], v75 offset:264
    ds_read_b64_tr_b16 a[80:81], v72 offset:272
    ds_read_b64_tr_b16 a[82:83], v73 offset:272
    ds_read_b64_tr_b16 a[84:85], v74 offset:272
    ds_read_b64_tr_b16 a[86:87], v75 offset:272
    ds_read_b64_tr_b16 a[88:89], v72 offset:280
    ds_read_b64_tr_b16 a[90:91], v73 offset:280
    ds_read_b64_tr_b16 a[92:93], v74 offset:280
    ds_read_b64_tr_b16 a[94:95], v75 offset:280
    ds_read_b64_tr_b16 a[136:137], v72 offset:288
    s_add_u32 m0, s46, 0x5000
    s_nop 0
    buffer_load_dwordx4 v37, s[16:19], s48 offen lds
    ds_read_b64_tr_b16 a[138:139], v73 offset:288
    ds_read_b64_tr_b16 a[140:141], v74 offset:288
    ds_read_b64_tr_b16 a[142:143], v75 offset:288
    ds_read_b64_tr_b16 a[192:193], v72 offset:296
    ds_read_b64_tr_b16 a[194:195], v73 offset:296
    ds_read_b64_tr_b16 a[196:197], v74 offset:296
    ds_read_b64_tr_b16 a[198:199], v75 offset:296
    ds_read_b64_tr_b16 a[200:201], v72 offset:304
    ds_read_b64_tr_b16 a[202:203], v73 offset:304
    ds_read_b64_tr_b16 a[204:205], v74 offset:304
    ds_read_b64_tr_b16 a[206:207], v75 offset:304
    ds_read_b64_tr_b16 a[208:209], v72 offset:312
    ds_read_b64_tr_b16 a[210:211], v73 offset:312
    ds_read_b64_tr_b16 a[212:213], v74 offset:312
    ds_read_b64_tr_b16 a[214:215], v75 offset:312
    s_add_u32 m0, s46, 0x6000
    s_nop 0
    buffer_load_dwordx4 v38, s[16:19], s48 offen lds
    s_add_u32 m0, s46, 0x7000
    s_nop 0
    buffer_load_dwordx4 v39, s[16:19], s48 offen lds
    s_waitcnt vmcnt(8) lgkmcnt(0)
    s_barrier
    ds_read_b64_tr_b16 a[0:1], v64
    ds_read_b64_tr_b16 a[2:3], v64 offset:5120
    ds_read_b64_tr_b16 a[4:5], v64 offset:10240
    ds_read_b64_tr_b16 a[6:7], v64 offset:15360
    ds_read_b64_tr_b16 a[8:9], v64 offset:20480
    ds_read_b64_tr_b16 a[10:11], v64 offset:25600
    ds_read_b64_tr_b16 a[12:13], v64 offset:30720
    ds_read_b64_tr_b16 a[14:15], v64 offset:35840
    ds_read_b64_tr_b16 a[16:17], v64 offset:40960
    ds_read_b64_tr_b16 a[18:19], v64 offset:46080
    s_waitcnt lgkmcnt(8)
    v_mfma_f32_16x16x32_bf16 v[48:51], a[96:99], a[0:3], 0
    s_waitcnt lgkmcnt(6)
    ds_read_b64_tr_b16 a[20:21], v64 offset:8
    v_mfma_f32_16x16x32_bf16 v[48:51], a[100:103], a[4:7], v[48:51]
    ds_read_b64_tr_b16 a[22:23], v64 offset:5128
    v_mfma_f32_16x16x32_bf16 v[52:55], a[96:99], a[2:5], 0
    s_waitcnt lgkmcnt(7)
    s_add_u32 m0, s46, 0x8000
    ds_read_b64_tr_b16 a[24:25], v64 offset:10248
    v_mfma_f32_16x16x32_bf16 v[52:55], a[100:103], a[6:9], v[52:55]
    buffer_load_dwordx4 v40, s[16:19], s48 offen lds
    v_mfma_f32_16x16x32_bf16 v[56:59], a[96:99], a[4:7], 0
    s_waitcnt lgkmcnt(7)
    ds_read_b64_tr_b16 a[26:27], v64 offset:15368
    v_cndmask_b32 v48, v48, v49, vcc
    v_cndmask_b32 v50, v50, v51, vcc
    v_mfma_f32_16x16x32_bf16 v[56:59], a[100:103], a[8:11], v[56:59]
    ds_read_b64_tr_b16 a[28:29], v64 offset:20488
    v_cndmask_b32 v88, v48, v50, s[44:45]
    v_mfma_f32_16x16x32_bf16 v[60:63], a[96:99], a[6:9], 0
    s_waitcnt lgkmcnt(8)
    v_cndmask_b32 v52, v52, v53, vcc
    v_cndmask_b32 v54, v54, v55, vcc
    v_mfma_f32_16x16x32_bf16 v[60:63], a[100:103], a[10:13], v[60:63]
    ds_read_b64_tr_b16 a[30:31], v64 offset:25608
    v_cndmask_b32 v112, v52, v54, s[44:45]
    v_mfma_f32_16x16x32_bf16 v[48:51], a[96:99], a[8:11], 0
    s_waitcnt lgkmcnt(8)
    ds_read_b64_tr_b16 a[32:33], v64 offset:30728
    v_cndmask_b32 v56, v56, v57, vcc
    v_cndmask_b32 v58, v58, v59, vcc
    v_mfma_f32_16x16x32_bf16 v[48:51], a[100:103], a[12:15], v[48:51]
    s_add_u32 m0, s46, 0x9000
    ds_read_b64_tr_b16 a[34:35], v64 offset:35848
    v_cndmask_b32 v136, v56, v58, s[44:45]
    v_mfma_f32_16x16x32_bf16 v[52:55], a[96:99], a[10:13], 0
    s_waitcnt lgkmcnt(9)
    buffer_load_dwordx4 v41, s[16:19], s48 offen lds
    v_cndmask_b32 v60, v60, v61, vcc
    v_cndmask_b32 v62, v62, v63, vcc
    v_mfma_f32_16x16x32_bf16 v[52:55], a[100:103], a[14:17], v[52:55]
    ds_read_b64_tr_b16 a[36:37], v64 offset:40968
    v_cndmask_b32 v160, v60, v62, s[44:45]
    v_mfma_f32_16x16x32_bf16 v[56:59], a[96:99], a[12:15], 0
    s_waitcnt lgkmcnt(9)
    ds_read_b64_tr_b16 a[38:39], v64 offset:46088
    v_cndmask_b32 v48, v48, v49, vcc
    v_cndmask_b32 v50, v50, v51, vcc
    v_mfma_f32_16x16x32_bf16 v[56:59], a[100:103], a[16:19], v[56:59]
    s_waitcnt lgkmcnt(8)
    v_cndmask_b32 v184, v48, v50, s[44:45]
    v_mfma_f32_16x16x32_bf16 v[60:63], a[104:107], a[20:23], 0
    s_waitcnt lgkmcnt(6)
    ds_read_b64_tr_b16 a[0:1], v65
    v_cndmask_b32 v52, v52, v53, vcc
    v_cndmask_b32 v54, v54, v55, vcc
    v_mfma_f32_16x16x32_bf16 v[60:63], a[108:111], a[24:27], v[60:63]
    ds_read_b64_tr_b16 a[2:3], v65 offset:5120
    v_cndmask_b32 v208, v52, v54, s[44:45]
    v_mfma_f32_16x16x32_bf16 v[48:51], a[104:107], a[22:25], 0
    s_waitcnt lgkmcnt(7)
    s_add_u32 m0, s46, 0xa000
    ds_read_b64_tr_b16 a[4:5], v65 offset:10240
    v_cndmask_b32 v56, v56, v57, vcc
    v_cndmask_b32 v58, v58, v59, vcc
    v_mfma_f32_16x16x32_bf16 v[48:51], a[108:111], a[26:29], v[48:51]
    buffer_load_dwordx4 v37, s[16:19], s51 offen lds
    v_cndmask_b32 v232, v56, v58, s[44:45]
    v_mfma_f32_16x16x32_bf16 v[52:55], a[104:107], a[24:27], 0
    s_waitcnt lgkmcnt(7)
    ds_read_b64_tr_b16 a[6:7], v65 offset:15360
    v_cndmask_b32 v60, v60, v61, vcc
    v_cndmask_b32 v62, v62, v63, vcc
    v_mfma_f32_16x16x32_bf16 v[52:55], a[108:111], a[28:31], v[52:55]
    ds_read_b64_tr_b16 a[8:9], v65 offset:20480
    v_cndmask_b32 v89, v60, v62, s[44:45]
    v_mfma_f32_16x16x32_bf16 v[56:59], a[104:107], a[26:29], 0
    s_waitcnt lgkmcnt(8)
    v_cndmask_b32 v48, v48, v49, vcc
    v_cndmask_b32 v50, v50, v51, vcc
    v_mfma_f32_16x16x32_bf16 v[56:59], a[108:111], a[30:33], v[56:59]
    ds_read_b64_tr_b16 a[10:11], v65 offset:25600
    v_cndmask_b32 v113, v48, v50, s[44:45]
    v_mfma_f32_16x16x32_bf16 v[60:63], a[104:107], a[28:31], 0
    s_waitcnt lgkmcnt(8)
    ds_read_b64_tr_b16 a[12:13], v65 offset:30720
    v_cndmask_b32 v52, v52, v53, vcc
    v_cndmask_b32 v54, v54, v55, vcc
    v_mfma_f32_16x16x32_bf16 v[60:63], a[108:111], a[32:35], v[60:63]
    s_add_u32 m0, s46, 0xb000
    ds_read_b64_tr_b16 a[14:15], v65 offset:35840
    v_cndmask_b32 v137, v52, v54, s[44:45]
    v_mfma_f32_16x16x32_bf16 v[48:51], a[104:107], a[30:33], 0
    s_waitcnt lgkmcnt(9)
    buffer_load_dwordx4 v38, s[16:19], s51 offen lds
    v_cndmask_b32 v56, v56, v57, vcc
    v_cndmask_b32 v58, v58, v59, vcc
    v_mfma_f32_16x16x32_bf16 v[48:51], a[108:111], a[34:37], v[48:51]
    ds_read_b64_tr_b16 a[16:17], v65 offset:40960
    v_cndmask_b32 v161, v56, v58, s[44:45]
    v_mfma_f32_16x16x32_bf16 v[52:55], a[104:107], a[32:35], 0
    s_waitcnt lgkmcnt(9)
    ds_read_b64_tr_b16 a[18:19], v65 offset:46080
    v_cndmask_b32 v60, v60, v61, vcc
    v_cndmask_b32 v62, v62, v63, vcc
    v_mfma_f32_16x16x32_bf16 v[52:55], a[108:111], a[36:39], v[52:55]
    s_waitcnt lgkmcnt(8)
    v_cndmask_b32 v185, v60, v62, s[44:45]
    v_mfma_f32_16x16x32_bf16 v[56:59], a[112:115], a[0:3], 0
    s_waitcnt lgkmcnt(6)
    ds_read_b64_tr_b16 a[20:21], v65 offset:8
    v_cndmask_b32 v48, v48, v49, vcc
    v_cndmask_b32 v50, v50, v51, vcc
    v_mfma_f32_16x16x32_bf16 v[56:59], a[116:119], a[4:7], v[56:59]
    ds_read_b64_tr_b16 a[22:23], v65 offset:5128
    v_cndmask_b32 v209, v48, v50, s[44:45]
    v_mfma_f32_16x16x32_bf16 v[60:63], a[112:115], a[2:5], 0
    s_waitcnt lgkmcnt(7)
    s_add_u32 m0, s47, 0
    ds_read_b64_tr_b16 a[24:25], v65 offset:10248
    v_cndmask_b32 v52, v52, v53, vcc
    v_cndmask_b32 v54, v54, v55, vcc
    v_mfma_f32_16x16x32_bf16 v[60:63], a[116:119], a[6:9], v[60:63]
    buffer_load_dwordx4 v39, s[16:19], s54 offen lds
    v_cndmask_b32 v233, v52, v54, s[44:45]
    v_mfma_f32_16x16x32_bf16 v[48:51], a[112:115], a[4:7], 0
    s_waitcnt lgkmcnt(7)
    ds_read_b64_tr_b16 a[26:27], v65 offset:15368
    v_cndmask_b32 v56, v56, v57, vcc
    v_cndmask_b32 v58, v58, v59, vcc
    v_mfma_f32_16x16x32_bf16 v[48:51], a[116:119], a[8:11], v[48:51]
    ds_read_b64_tr_b16 a[28:29], v65 offset:20488
    v_cndmask_b32 v90, v56, v58, s[44:45]
    v_mfma_f32_16x16x32_bf16 v[52:55], a[112:115], a[6:9], 0
    s_waitcnt lgkmcnt(8)
    v_cndmask_b32 v60, v60, v61, vcc
    v_cndmask_b32 v62, v62, v63, vcc
    v_mfma_f32_16x16x32_bf16 v[52:55], a[116:119], a[10:13], v[52:55]
    ds_read_b64_tr_b16 a[30:31], v65 offset:25608
    v_cndmask_b32 v114, v60, v62, s[44:45]
    v_mfma_f32_16x16x32_bf16 v[56:59], a[112:115], a[8:11], 0
    s_waitcnt lgkmcnt(8)
    ds_read_b64_tr_b16 a[32:33], v65 offset:30728
    v_cndmask_b32 v48, v48, v49, vcc
    v_cndmask_b32 v50, v50, v51, vcc
    v_mfma_f32_16x16x32_bf16 v[56:59], a[116:119], a[12:15], v[56:59]
    s_add_u32 m0, s46, 0xc800
    ds_read_b64_tr_b16 a[34:35], v65 offset:35848
    v_cndmask_b32 v138, v48, v50, s[44:45]
    v_mfma_f32_16x16x32_bf16 v[60:63], a[112:115], a[10:13], 0
    s_waitcnt lgkmcnt(9)
    buffer_load_dwordx4 v32, s[16:19], s49 offen lds
    v_cndmask_b32 v52, v52, v53, vcc
    v_cndmask_b32 v54, v54, v55, vcc
    v_mfma_f32_16x16x32_bf16 v[60:63], a[116:119], a[14:17], v[60:63]
    ds_read_b64_tr_b16 a[36:37], v65 offset:40968
    v_cndmask_b32 v162, v52, v54, s[44:45]
    v_mfma_f32_16x16x32_bf16 v[48:51], a[112:115], a[12:15], 0
    s_waitcnt lgkmcnt(9)
    ds_read_b64_tr_b16 a[38:39], v65 offset:46088
    v_cndmask_b32 v56, v56, v57, vcc
    v_cndmask_b32 v58, v58, v59, vcc
    v_mfma_f32_16x16x32_bf16 v[48:51], a[116:119], a[16:19], v[48:51]
    s_waitcnt lgkmcnt(8)
    v_cndmask_b32 v186, v56, v58, s[44:45]
    v_mfma_f32_16x16x32_bf16 v[52:55], a[120:123], a[20:23], 0
    s_waitcnt lgkmcnt(6)
    ds_read_b64_tr_b16 a[0:1], v66
    v_cndmask_b32 v60, v60, v61, vcc
    v_cndmask_b32 v62, v62, v63, vcc
    v_mfma_f32_16x16x32_bf16 v[52:55], a[124:127], a[24:27], v[52:55]
    ds_read_b64_tr_b16 a[2:3], v66 offset:5120
    v_cndmask_b32 v210, v60, v62, s[44:45]
    v_mfma_f32_16x16x32_bf16 v[56:59], a[120:123], a[22:25], 0
    s_waitcnt lgkmcnt(7)
    s_add_u32 m0, s46, 0xd800
    ds_read_b64_tr_b16 a[4:5], v66 offset:10240
    v_cndmask_b32 v48, v48, v49, vcc
    v_cndmask_b32 v50, v50, v51, vcc
    v_mfma_f32_16x16x32_bf16 v[56:59], a[124:127], a[26:29], v[56:59]
    buffer_load_dwordx4 v33, s[16:19], s49 offen lds
    v_cndmask_b32 v234, v48, v50, s[44:45]
    v_mfma_f32_16x16x32_bf16 v[60:63], a[120:123], a[24:27], 0
    s_waitcnt lgkmcnt(7)
    ds_read_b64_tr_b16 a[6:7], v66 offset:15360
    v_cndmask_b32 v52, v52, v53, vcc
    v_cndmask_b32 v54, v54, v55, vcc
    v_mfma_f32_16x16x32_bf16 v[60:63], a[124:127], a[28:31], v[60:63]
    ds_read_b64_tr_b16 a[8:9], v66 offset:20480
    v_cndmask_b32 v91, v52, v54, s[44:45]
    v_mfma_f32_16x16x32_bf16 v[48:51], a[120:123], a[26:29], 0
    s_waitcnt lgkmcnt(8)
    v_cndmask_b32 v56, v56, v57, vcc
    v_cndmask_b32 v58, v58, v59, vcc
    v_mfma_f32_16x16x32_bf16 v[48:51], a[124:127], a[30:33], v[48:51]
    ds_read_b64_tr_b16 a[10:11], v66 offset:25600
    v_cndmask_b32 v115, v56, v58, s[44:45]
    v_mfma_f32_16x16x32_bf16 v[52:55], a[120:123], a[28:31], 0
    s_waitcnt lgkmcnt(8)
    ds_read_b64_tr_b16 a[12:13], v66 offset:30720
    v_cndmask_b32 v60, v60, v61, vcc
    v_cndmask_b32 v62, v62, v63, vcc
    v_mfma_f32_16x16x32_bf16 v[52:55], a[124:127], a[32:35], v[52:55]
    ds_read_b64_tr_b16 a[14:15], v66 offset:35840
    v_cndmask_b32 v139, v60, v62, s[44:45]
    v_mfma_f32_16x16x32_bf16 v[56:59], a[120:123], a[30:33], 0
    s_waitcnt lgkmcnt(9)
    v_cndmask_b32 v48, v48, v49, vcc
    v_cndmask_b32 v50, v50, v51, vcc
    v_mfma_f32_16x16x32_bf16 v[56:59], a[124:127], a[34:37], v[56:59]
    ds_read_b64_tr_b16 a[16:17], v66 offset:40960
    v_cndmask_b32 v163, v48, v50, s[44:45]
    v_mfma_f32_16x16x32_bf16 v[60:63], a[120:123], a[32:35], 0
    s_waitcnt lgkmcnt(9)
    s_add_u32 m0, s46, 0xe800
    ds_read_b64_tr_b16 a[18:19], v66 offset:46080
    v_cndmask_b32 v52, v52, v53, vcc
    v_cndmask_b32 v54, v54, v55, vcc
    v_mfma_f32_16x16x32_bf16 v[60:63], a[124:127], a[36:39], v[60:63]
    s_waitcnt lgkmcnt(8)
    buffer_load_dwordx4 v34, s[16:19], s49 offen lds
    v_cndmask_b32 v187, v52, v54, s[44:45]
    v_mfma_f32_16x16x32_bf16 v[48:51], a[128:131], a[0:3], 0
    s_waitcnt lgkmcnt(6)
    ds_read_b64_tr_b16 a[20:21], v66 offset:8
    v_cndmask_b32 v56, v56, v57, vcc
    v_cndmask_b32 v58, v58, v59, vcc
    v_mfma_f32_16x16x32_bf16 v[48:51], a[132:135], a[4:7], v[48:51]
    ds_read_b64_tr_b16 a[22:23], v66 offset:5128
    v_cndmask_b32 v211, v56, v58, s[44:45]
    v_mfma_f32_16x16x32_bf16 v[52:55], a[128:131], a[2:5], 0
    s_waitcnt lgkmcnt(7)
    ds_read_b64_tr_b16 a[24:25], v66 offset:10248
    v_cndmask_b32 v60, v60, v61, vcc
    v_cndmask_b32 v62, v62, v63, vcc
    v_mfma_f32_16x16x32_bf16 v[52:55], a[132:135], a[6:9], v[52:55]
    v_cndmask_b32 v235, v60, v62, s[44:45]
    v_mfma_f32_16x16x32_bf16 v[56:59], a[128:131], a[4:7], 0
    s_waitcnt lgkmcnt(7)
    ds_read_b64_tr_b16 a[26:27], v66 offset:15368
    v_cndmask_b32 v48, v48, v49, vcc
    v_cndmask_b32 v50, v50, v51, vcc
    v_mfma_f32_16x16x32_bf16 v[56:59], a[132:135], a[8:11], v[56:59]
    s_add_u32 m0, s46, 0xf800
    ds_read_b64_tr_b16 a[28:29], v66 offset:20488
    v_cndmask_b32 v92, v48, v50, s[44:45]
    v_mfma_f32_16x16x32_bf16 v[60:63], a[128:131], a[6:9], 0
    s_waitcnt lgkmcnt(8)
    buffer_load_dwordx4 v35, s[16:19], s49 offen lds
    v_cndmask_b32 v52, v52, v53, vcc
    v_cndmask_b32 v54, v54, v55, vcc
    v_mfma_f32_16x16x32_bf16 v[60:63], a[132:135], a[10:13], v[60:63]
    ds_read_b64_tr_b16 a[30:31], v66 offset:25608
    v_cndmask_b32 v116, v52, v54, s[44:45]
    v_mfma_f32_16x16x32_bf16 v[48:51], a[128:131], a[8:11], 0
    s_waitcnt lgkmcnt(8)
    ds_read_b64_tr_b16 a[32:33], v66 offset:30728
    v_cndmask_b32 v56, v56, v57, vcc
    v_cndmask_b32 v58, v58, v59, vcc
    v_mfma_f32_16x16x32_bf16 v[48:51], a[132:135], a[12:15], v[48:51]
    ds_read_b64_tr_b16 a[34:35], v66 offset:35848
    v_cndmask_b32 v140, v56, v58, s[44:45]
    v_mfma_f32_16x16x32_bf16 v[52:55], a[128:131], a[10:13], 0
    s_waitcnt lgkmcnt(9)
    v_cndmask_b32 v60, v60, v61, vcc
    v_cndmask_b32 v62, v62, v63, vcc
    v_mfma_f32_16x16x32_bf16 v[52:55], a[132:135], a[14:17], v[52:55]
    ds_read_b64_tr_b16 a[36:37], v66 offset:40968
    v_cndmask_b32 v164, v60, v62, s[44:45]
    v_mfma_f32_16x16x32_bf16 v[56:59], a[128:131], a[12:15], 0
    s_waitcnt lgkmcnt(9)
    s_add_u32 m0, s46, 0x10800
    ds_read_b64_tr_b16 a[38:39], v66 offset:46088
    v_cndmask_b32 v48, v48, v49, vcc
    v_cndmask_b32 v50, v50, v51, vcc
    v_mfma_f32_16x16x32_bf16 v[56:59], a[132:135], a[16:19], v[56:59]
    s_waitcnt lgkmcnt(8)
    buffer_load_dwordx4 v36, s[16:19], s49 offen lds
    v_cndmask_b32 v188, v48, v50, s[44:45]
    v_mfma_f32_16x16x32_bf16 v[60:63], a[216:219], a[20:23], 0
    s_waitcnt lgkmcnt(6)
    ds_read_b64_tr_b16 a[0:1], v67
    v_cndmask_b32 v52, v52, v53, vcc
    v_cndmask_b32 v54, v54, v55, vcc
    v_mfma_f32_16x16x32_bf16 v[60:63], a[220:223], a[24:27], v[60:63]
    ds_read_b64_tr_b16 a[2:3], v67 offset:5120
    v_cndmask_b32 v212, v52, v54, s[44:45]
    v_mfma_f32_16x16x32_bf16 v[48:51], a[216:219], a[22:25], 0
    s_waitcnt lgkmcnt(7)
    ds_read_b64_tr_b16 a[4:5], v67 offset:10240
    v_cndmask_b32 v56, v56, v57, vcc
    v_cndmask_b32 v58, v58, v59, vcc
    v_mfma_f32_16x16x32_bf16 v[48:51], a[220:223], a[26:29], v[48:51]
    v_cndmask_b32 v236, v56, v58, s[44:45]
    v_mfma_f32_16x16x32_bf16 v[52:55], a[216:219], a[24:27], 0
    s_waitcnt lgkmcnt(7)
    ds_read_b64_tr_b16 a[6:7], v67 offset:15360
    v_cndmask_b32 v60, v60, v61, vcc
    v_cndmask_b32 v62, v62, v63, vcc
    v_mfma_f32_16x16x32_bf16 v[52:55], a[220:223], a[28:31], v[52:55]
    s_add_u32 m0, s46, 0x14800
    ds_read_b64_tr_b16 a[8:9], v67 offset:20480
    v_cndmask_b32 v93, v60, v62, s[44:45]
    v_mfma_f32_16x16x32_bf16 v[56:59], a[216:219], a[26:29], 0
    s_waitcnt lgkmcnt(8)
    buffer_load_dwordx4 v40, s[16:19], s49 offen lds
    v_cndmask_b32 v48, v48, v49, vcc
    v_cndmask_b32 v50, v50, v51, vcc
    v_mfma_f32_16x16x32_bf16 v[56:59], a[220:223], a[30:33], v[56:59]
    ds_read_b64_tr_b16 a[10:11], v67 offset:25600
    v_cndmask_b32 v117, v48, v50, s[44:45]
    v_mfma_f32_16x16x32_bf16 v[60:63], a[216:219], a[28:31], 0
    s_waitcnt lgkmcnt(8)
    ds_read_b64_tr_b16 a[12:13], v67 offset:30720
    v_cndmask_b32 v52, v52, v53, vcc
    v_cndmask_b32 v54, v54, v55, vcc
    v_mfma_f32_16x16x32_bf16 v[60:63], a[220:223], a[32:35], v[60:63]
    ds_read_b64_tr_b16 a[14:15], v67 offset:35840
    v_cndmask_b32 v141, v52, v54, s[44:45]
    v_mfma_f32_16x16x32_bf16 v[48:51], a[216:219], a[30:33], 0
    s_waitcnt lgkmcnt(9)
    v_cndmask_b32 v56, v56, v57, vcc
    v_cndmask_b32 v58, v58, v59, vcc
    v_mfma_f32_16x16x32_bf16 v[48:51], a[220:223], a[34:37], v[48:51]
    ds_read_b64_tr_b16 a[16:17], v67 offset:40960
    v_cndmask_b32 v165, v56, v58, s[44:45]
    v_mfma_f32_16x16x32_bf16 v[52:55], a[216:219], a[32:35], 0
    s_waitcnt lgkmcnt(9)
    s_add_u32 m0, s46, 0x15800
    ds_read_b64_tr_b16 a[18:19], v67 offset:46080
    v_cndmask_b32 v60, v60, v61, vcc
    v_cndmask_b32 v62, v62, v63, vcc
    v_mfma_f32_16x16x32_bf16 v[52:55], a[220:223], a[36:39], v[52:55]
    s_waitcnt lgkmcnt(8)
    buffer_load_dwordx4 v41, s[16:19], s49 offen lds
    v_cndmask_b32 v189, v60, v62, s[44:45]
    v_mfma_f32_16x16x32_bf16 v[56:59], a[144:147], a[0:3], 0
    s_waitcnt lgkmcnt(6)
    ds_read_b64_tr_b16 a[20:21], v67 offset:8
    v_cndmask_b32 v48, v48, v49, vcc
    v_cndmask_b32 v50, v50, v51, vcc
    v_mfma_f32_16x16x32_bf16 v[56:59], a[148:151], a[4:7], v[56:59]
    ds_read_b64_tr_b16 a[22:23], v67 offset:5128
    v_cndmask_b32 v213, v48, v50, s[44:45]
    v_mfma_f32_16x16x32_bf16 v[60:63], a[144:147], a[2:5], 0
    s_waitcnt lgkmcnt(7)
    ds_read_b64_tr_b16 a[24:25], v67 offset:10248
    v_cndmask_b32 v52, v52, v53, vcc
    v_cndmask_b32 v54, v54, v55, vcc
    v_mfma_f32_16x16x32_bf16 v[60:63], a[148:151], a[6:9], v[60:63]
    v_cndmask_b32 v237, v52, v54, s[44:45]
    v_mfma_f32_16x16x32_bf16 v[48:51], a[144:147], a[4:7], 0
    s_waitcnt lgkmcnt(7)
    ds_read_b64_tr_b16 a[26:27], v67 offset:15368
    v_cndmask_b32 v56, v56, v57, vcc
    v_cndmask_b32 v58, v58, v59, vcc
    v_mfma_f32_16x16x32_bf16 v[48:51], a[148:151], a[8:11], v[48:51]
    s_add_u32 m0, s46, 0x11800
    ds_read_b64_tr_b16 a[28:29], v67 offset:20488
    v_cndmask_b32 v94, v56, v58, s[44:45]
    v_mfma_f32_16x16x32_bf16 v[52:55], a[144:147], a[6:9], 0
    s_waitcnt lgkmcnt(8)
    buffer_load_dwordx4 v37, s[16:19], s49 offen lds
    v_cndmask_b32 v60, v60, v61, vcc
    v_cndmask_b32 v62, v62, v63, vcc
    v_mfma_f32_16x16x32_bf16 v[52:55], a[148:151], a[10:13], v[52:55]
    ds_read_b64_tr_b16 a[30:31], v67 offset:25608
    v_cndmask_b32 v118, v60, v62, s[44:45]
    v_mfma_f32_16x16x32_bf16 v[56:59], a[144:147], a[8:11], 0
    s_waitcnt lgkmcnt(8)
    ds_read_b64_tr_b16 a[32:33], v67 offset:30728
    v_cndmask_b32 v48, v48, v49, vcc
    v_cndmask_b32 v50, v50, v51, vcc
    v_mfma_f32_16x16x32_bf16 v[56:59], a[148:151], a[12:15], v[56:59]
    ds_read_b64_tr_b16 a[34:35], v67 offset:35848
    v_cndmask_b32 v142, v48, v50, s[44:45]
    v_mfma_f32_16x16x32_bf16 v[60:63], a[144:147], a[10:13], 0
    s_waitcnt lgkmcnt(9)
    v_cndmask_b32 v52, v52, v53, vcc
    v_cndmask_b32 v54, v54, v55, vcc
    v_mfma_f32_16x16x32_bf16 v[60:63], a[148:151], a[14:17], v[60:63]
    ds_read_b64_tr_b16 a[36:37], v67 offset:40968
    v_cndmask_b32 v166, v52, v54, s[44:45]
    v_mfma_f32_16x16x32_bf16 v[48:51], a[144:147], a[12:15], 0
    s_waitcnt lgkmcnt(9)
    ds_read_b64_tr_b16 a[38:39], v67 offset:46088
    v_cndmask_b32 v56, v56, v57, vcc
    v_cndmask_b32 v58, v58, v59, vcc
    v_mfma_f32_16x16x32_bf16 v[48:51], a[148:151], a[16:19], v[48:51]
    s_waitcnt lgkmcnt(8)
    v_cndmask_b32 v190, v56, v58, s[44:45]
    v_mfma_f32_16x16x32_bf16 v[52:55], a[152:155], a[20:23], 0
    s_waitcnt lgkmcnt(6)
    v_cndmask_b32 v60, v60, v61, vcc
    v_cndmask_b32 v62, v62, v63, vcc
    v_mfma_f32_16x16x32_bf16 v[52:55], a[156:159], a[24:27], v[52:55]
    v_cndmask_b32 v214, v60, v62, s[44:45]
    v_mfma_f32_16x16x32_bf16 v[56:59], a[152:155], a[22:25], 0
    s_waitcnt lgkmcnt(5)
    v_cndmask_b32 v48, v48, v49, vcc
    v_cndmask_b32 v50, v50, v51, vcc
    v_mfma_f32_16x16x32_bf16 v[56:59], a[156:159], a[26:29], v[56:59]
    v_cndmask_b32 v238, v48, v50, s[44:45]
    v_mfma_f32_16x16x32_bf16 v[60:63], a[152:155], a[24:27], 0
    s_waitcnt lgkmcnt(4)
    v_cndmask_b32 v52, v52, v53, vcc
    v_cndmask_b32 v54, v54, v55, vcc
    v_mfma_f32_16x16x32_bf16 v[60:63], a[156:159], a[28:31], v[60:63]
    v_cndmask_b32 v95, v52, v54, s[44:45]
    v_mfma_f32_16x16x32_bf16 v[48:51], a[152:155], a[26:29], 0
    s_waitcnt lgkmcnt(3)
    v_cndmask_b32 v56, v56, v57, vcc
    v_cndmask_b32 v58, v58, v59, vcc
    v_mfma_f32_16x16x32_bf16 v[48:51], a[156:159], a[30:33], v[48:51]
    v_cndmask_b32 v119, v56, v58, s[44:45]
    v_mfma_f32_16x16x32_bf16 v[52:55], a[152:155], a[28:31], 0
    s_waitcnt lgkmcnt(2)
    v_cndmask_b32 v60, v60, v61, vcc
    v_cndmask_b32 v62, v62, v63, vcc
    v_mfma_f32_16x16x32_bf16 v[52:55], a[156:159], a[32:35], v[52:55]
    v_cndmask_b32 v143, v60, v62, s[44:45]
    v_mfma_f32_16x16x32_bf16 v[56:59], a[152:155], a[30:33], 0
    s_waitcnt lgkmcnt(1)
    v_cndmask_b32 v48, v48, v49, vcc
    v_cndmask_b32 v50, v50, v51, vcc
    v_mfma_f32_16x16x32_bf16 v[56:59], a[156:159], a[34:37], v[56:59]
    v_cndmask_b32 v167, v48, v50, s[44:45]
    v_mfma_f32_16x16x32_bf16 v[60:63], a[152:155], a[32:35], 0
    s_waitcnt lgkmcnt(0)
    v_cndmask_b32 v52, v52, v53, vcc
    v_cndmask_b32 v54, v54, v55, vcc
    v_mfma_f32_16x16x32_bf16 v[60:63], a[156:159], a[36:39], v[60:63]
    v_cndmask_b32 v191, v52, v54, s[44:45]
    s_nop 0
    v_cndmask_b32 v56, v56, v57, vcc
    v_cndmask_b32 v58, v58, v59, vcc
    v_cndmask_b32 v215, v56, v58, s[44:45]
    s_nop 2
    v_cndmask_b32 v60, v60, v61, vcc
    v_cndmask_b32 v62, v62, v63, vcc
    v_cndmask_b32 v239, v60, v62, s[44:45]
    v_add_u32 v64, 0xfffe4800, v64
    v_add_u32 v65, 0xfffe4800, v65
    v_add_u32 v66, 0xfffe4800, v66
    v_add_u32 v67, 0xfffe4800, v67
    s_waitcnt vmcnt(8)
    s_barrier
    ds_read_b64_tr_b16 a[0:1], v64
    ds_read_b64_tr_b16 a[2:3], v64 offset:5120
    ds_read_b64_tr_b16 a[4:5], v64 offset:10240
    ds_read_b64_tr_b16 a[6:7], v64 offset:15360
    ds_read_b64_tr_b16 a[8:9], v64 offset:20480
    ds_read_b64_tr_b16 a[10:11], v64 offset:25600
    ds_read_b64_tr_b16 a[12:13], v64 offset:30720
    ds_read_b64_tr_b16 a[14:15], v64 offset:35840
    ds_read_b64_tr_b16 a[16:17], v64 offset:40960
    ds_read_b64_tr_b16 a[18:19], v64 offset:46080
    v_pk_mul_f32 v[86:87], v[88:89], v[88:89]
    v_pk_mul_f32 v[68:69], v[112:113], v[112:113]
    v_pk_mul_f32 v[70:71], v[136:137], v[136:137]
    v_pk_mul_f32 v[46:47], v[160:161], v[160:161]
    v_pk_mul_f32 v[42:43], v[184:185], v[184:185]
    v_pk_mul_f32 v[44:45], v[208:209], v[208:209]
    v_pk_mul_f32 v[40:41], v[232:233], v[232:233]
    v_pk_fma_f32 v[86:87], v[90:91], v[90:91], v[86:87]
    v_pk_add_f32 v[72:73], v[88:89], v[90:91]
    v_pk_fma_f32 v[68:69], v[114:115], v[114:115], v[68:69]
    v_pk_add_f32 v[74:75], v[112:113], v[114:115]
    v_pk_fma_f32 v[70:71], v[138:139], v[138:139], v[70:71]
    v_pk_add_f32 v[76:77], v[136:137], v[138:139]
    v_pk_fma_f32 v[46:47], v[162:163], v[162:163], v[46:47]
    v_pk_add_f32 v[78:79], v[160:161], v[162:163]
    v_pk_fma_f32 v[42:43], v[186:187], v[186:187], v[42:43]
    v_pk_add_f32 v[80:81], v[184:185], v[186:187]
    v_pk_fma_f32 v[44:45], v[210:211], v[210:211], v[44:45]
    v_pk_add_f32 v[82:83], v[208:209], v[210:211]
    v_pk_fma_f32 v[40:41], v[234:235], v[234:235], v[40:41]
    v_pk_add_f32 v[84:85], v[232:233], v[234:235]
    v_pk_fma_f32 v[86:87], v[92:93], v[92:93], v[86:87]
    v_pk_add_f32 v[72:73], v[72:73], v[92:93]
    v_pk_fma_f32 v[68:69], v[116:117], v[116:117], v[68:69]
    v_pk_add_f32 v[74:75], v[74:75], v[116:117]
    v_pk_fma_f32 v[70:71], v[140:141], v[140:141], v[70:71]
    v_pk_add_f32 v[76:77], v[76:77], v[140:141]
    v_pk_fma_f32 v[46:47], v[164:165], v[164:165], v[46:47]
    v_pk_add_f32 v[78:79], v[78:79], v[164:165]
    v_pk_fma_f32 v[42:43], v[188:189], v[188:189], v[42:43]
    v_pk_add_f32 v[80:81], v[80:81], v[188:189]
    v_pk_fma_f32 v[44:45], v[212:213], v[212:213], v[44:45]
    v_pk_add_f32 v[82:83], v[82:83], v[212:213]
    v_pk_fma_f32 v[40:41], v[236:237], v[236:237], v[40:41]
    v_pk_add_f32 v[84:85], v[84:85], v[236:237]
    v_pk_fma_f32 v[86:87], v[94:95], v[94:95], v[86:87]
    v_pk_add_f32 v[72:73], v[72:73], v[94:95]
    v_pk_fma_f32 v[68:69], v[118:119], v[118:119], v[68:69]
    v_pk_add_f32 v[74:75], v[74:75], v[118:119]
    v_pk_fma_f32 v[70:71], v[142:143], v[142:143], v[70:71]
    v_pk_add_f32 v[76:77], v[76:77], v[142:143]
    v_pk_fma_f32 v[46:47], v[166:167], v[166:167], v[46:47]
    v_pk_add_f32 v[78:79], v[78:79], v[166:167]
    v_pk_fma_f32 v[42:43], v[190:191], v[190:191], v[42:43]
    v_pk_add_f32 v[80:81], v[80:81], v[190:191]
    v_pk_fma_f32 v[44:45], v[214:215], v[214:215], v[44:45]
    v_pk_add_f32 v[82:83], v[82:83], v[214:215]
    v_pk_fma_f32 v[40:41], v[238:239], v[238:239], v[40:41]
    v_pk_add_f32 v[84:85], v[84:85], v[238:239]
    s_waitcnt lgkmcnt(8)
    v_mfma_f32_16x16x32_bf16 v[48:51], a[160:163], a[0:3], 0
    s_waitcnt lgkmcnt(6)
    ds_read_b64_tr_b16 a[20:21], v64 offset:8
    v_mfma_f32_16x16x32_bf16 v[48:51], a[164:167], a[4:7], v[48:51]
    ds_read_b64_tr_b16 a[22:23], v64 offset:5128
    v_mfma_f32_16x16x32_bf16 v[52:55], a[160:163], a[2:5], 0
    s_waitcnt lgkmcnt(7)
    s_add_u32 m0, s46, 0x12800
    ds_read_b64_tr_b16 a[24:25], v64 offset:10248
    v_mfma_f32_16x16x32_bf16 v[52:55], a[164:167], a[6:9], v[52:55]
    buffer_load_dwordx4 v38, s[16:19], s49 offen lds
    v_mfma_f32_16x16x32_bf16 v[56:59], a[160:163], a[4:7], 0
    s_waitcnt lgkmcnt(7)
    ds_read_b64_tr_b16 a[26:27], v64 offset:15368
    v_cndmask_b32 v48, v48, v49, vcc
    v_cndmask_b32 v50, v50, v51, vcc
    v_mfma_f32_16x16x32_bf16 v[56:59], a[164:167], a[8:11], v[56:59]
    s_add_u32 m0, s46, 0x13800
    ds_read_b64_tr_b16 a[28:29], v64 offset:20488
    v_cndmask_b32 v96, v48, v50, s[44:45]
    v_mfma_f32_16x16x32_bf16 v[60:63], a[160:163], a[6:9], 0
    s_waitcnt lgkmcnt(8)
    buffer_load_dwordx4 v39, s[16:19], s49 offen lds
    v_cndmask_b32 v52, v52, v53, vcc
    v_cndmask_b32 v54, v54, v55, vcc
    v_mfma_f32_16x16x32_bf16 v[60:63], a[164:167], a[10:13], v[60:63]
    ds_read_b64_tr_b16 a[30:31], v64 offset:25608
    v_cndmask_b32 v120, v52, v54, s[44:45]
    v_mfma_f32_16x16x32_bf16 v[48:51], a[160:163], a[8:11], 0
    s_waitcnt lgkmcnt(8)
    ds_read_b64_tr_b16 a[32:33], v64 offset:30728
    v_cndmask_b32 v56, v56, v57, vcc
    v_cndmask_b32 v58, v58, v59, vcc
    v_mfma_f32_16x16x32_bf16 v[48:51], a[164:167], a[12:15], v[48:51]
    s_add_u32 m0, s46, 0x16800
    ds_read_b64_tr_b16 a[34:35], v64 offset:35848
    v_cndmask_b32 v144, v56, v58, s[44:45]
    v_mfma_f32_16x16x32_bf16 v[52:55], a[160:163], a[10:13], 0
    s_waitcnt lgkmcnt(9)
    buffer_load_dwordx4 v37, s[16:19], s52 offen lds
    v_cndmask_b32 v60, v60, v61, vcc
    v_cndmask_b32 v62, v62, v63, vcc
    v_mfma_f32_16x16x32_bf16 v[52:55], a[164:167], a[14:17], v[52:55]
    ds_read_b64_tr_b16 a[36:37], v64 offset:40968
    v_cndmask_b32 v168, v60, v62, s[44:45]
    v_mfma_f32_16x16x32_bf16 v[56:59], a[160:163], a[12:15], 0
    s_waitcnt lgkmcnt(9)
    s_add_u32 m0, s46, 0x17800
    ds_read_b64_tr_b16 a[38:39], v64 offset:46088
    v_cndmask_b32 v48, v48, v49, vcc
    v_cndmask_b32 v50, v50, v51, vcc
    v_mfma_f32_16x16x32_bf16 v[56:59], a[164:167], a[16:19], v[56:59]
    s_waitcnt lgkmcnt(8)
    buffer_load_dwordx4 v38, s[16:19], s52 offen lds
    v_cndmask_b32 v192, v48, v50, s[44:45]
    v_mfma_f32_16x16x32_bf16 v[60:63], a[168:171], a[20:23], 0
    s_waitcnt lgkmcnt(6)
    ds_read_b64_tr_b16 a[0:1], v65
    v_cndmask_b32 v52, v52, v53, vcc
    v_cndmask_b32 v54, v54, v55, vcc
    v_mfma_f32_16x16x32_bf16 v[60:63], a[172:175], a[24:27], v[60:63]
    ds_read_b64_tr_b16 a[2:3], v65 offset:5120
    v_cndmask_b32 v216, v52, v54, s[44:45]
    v_mfma_f32_16x16x32_bf16 v[48:51], a[168:171], a[22:25], 0
    s_waitcnt lgkmcnt(7)
    s_add_u32 m0, s47, 0xc800
    ds_read_b64_tr_b16 a[4:5], v65 offset:10240
    v_cndmask_b32 v56, v56, v57, vcc
    v_cndmask_b32 v58, v58, v59, vcc
    v_mfma_f32_16x16x32_bf16 v[48:51], a[172:175], a[26:29], v[48:51]
    buffer_load_dwordx4 v39, s[16:19], s55 offen lds
    v_cndmask_b32 v240, v56, v58, s[44:45]
    v_mfma_f32_16x16x32_bf16 v[52:55], a[168:171], a[24:27], 0
    s_waitcnt lgkmcnt(7)
    ds_read_b64_tr_b16 a[6:7], v65 offset:15360
    v_cndmask_b32 v60, v60, v61, vcc
    v_cndmask_b32 v62, v62, v63, vcc
    v_mfma_f32_16x16x32_bf16 v[52:55], a[172:175], a[28:31], v[52:55]
    s_mov_b32 s63, 0
    ds_read_b64_tr_b16 a[8:9], v65 offset:20480
    v_cndmask_b32 v97, v60, v62, s[44:45]
    v_mfma_f32_16x16x32_bf16 v[56:59], a[168:171], a[26:29], 0
    s_waitcnt lgkmcnt(8)
    buffer_load_dwordx4 v[4:7], v247, s[8:11], s63 offen
    v_cndmask_b32 v48, v48, v49, vcc
    v_cndmask_b32 v50, v50, v51, vcc
    v_mfma_f32_16x16x32_bf16 v[56:59], a[172:175], a[30:33], v[56:59]
    ds_read_b64_tr_b16 a[10:11], v65 offset:25600
    v_cndmask_b32 v121, v48, v50, s[44:45]
    v_mfma_f32_16x16x32_bf16 v[60:63], a[168:171], a[28:31], 0
    s_waitcnt lgkmcnt(8)
    ds_read_b64_tr_b16 a[12:13], v65 offset:30720
    v_cndmask_b32 v52, v52, v53, vcc
    v_cndmask_b32 v54, v54, v55, vcc
    v_mfma_f32_16x16x32_bf16 v[60:63], a[172:175], a[32:35], v[60:63]
    s_mov_b32 s63, 0x1000
    ds_read_b64_tr_b16 a[14:15], v65 offset:35840
    v_cndmask_b32 v145, v52, v54, s[44:45]
    v_mfma_f32_16x16x32_bf16 v[48:51], a[168:171], a[30:33], 0
    s_waitcnt lgkmcnt(9)
    buffer_load_dwordx4 v[20:23], v247, s[8:11], s63 offen
    v_cndmask_b32 v56, v56, v57, vcc
    v_cndmask_b32 v58, v58, v59, vcc
    v_mfma_f32_16x16x32_bf16 v[48:51], a[172:175], a[34:37], v[48:51]
    ds_read_b64_tr_b16 a[16:17], v65 offset:40960
    v_cndmask_b32 v169, v56, v58, s[44:45]
    v_mfma_f32_16x16x32_bf16 v[52:55], a[168:171], a[32:35], 0
    s_waitcnt lgkmcnt(9)
    s_mov_b32 s63, 0x2000
    ds_read_b64_tr_b16 a[18:19], v65 offset:46080
    v_cndmask_b32 v60, v60, v61, vcc
    v_cndmask_b32 v62, v62, v63, vcc
    v_mfma_f32_16x16x32_bf16 v[52:55], a[172:175], a[36:39], v[52:55]
    s_waitcnt lgkmcnt(8)
    buffer_load_dwordx4 v[24:27], v247, s[8:11], s63 offen
    v_cndmask_b32 v193, v60, v62, s[44:45]
    v_mfma_f32_16x16x32_bf16 v[56:59], a[176:179], a[0:3], 0
    s_waitcnt lgkmcnt(6)
    ds_read_b64_tr_b16 a[20:21], v65 offset:8
    v_cndmask_b32 v48, v48, v49, vcc
    v_cndmask_b32 v50, v50, v51, vcc
    v_mfma_f32_16x16x32_bf16 v[56:59], a[180:183], a[4:7], v[56:59]
    ds_read_b64_tr_b16 a[22:23], v65 offset:5128
    v_cndmask_b32 v217, v48, v50, s[44:45]
    v_mfma_f32_16x16x32_bf16 v[60:63], a[176:179], a[2:5], 0
    s_waitcnt lgkmcnt(7)
    s_mov_b32 s63, 0x3000
    ds_read_b64_tr_b16 a[24:25], v65 offset:10248
    v_cndmask_b32 v52, v52, v53, vcc
    v_cndmask_b32 v54, v54, v55, vcc
    v_mfma_f32_16x16x32_bf16 v[60:63], a[180:183], a[6:9], v[60:63]
    buffer_load_dwordx4 v[12:15], v247, s[8:11], s63 offen
    v_cndmask_b32 v241, v52, v54, s[44:45]
    v_mfma_f32_16x16x32_bf16 v[48:51], a[176:179], a[4:7], 0
    s_waitcnt lgkmcnt(7)
    ds_read_b64_tr_b16 a[26:27], v65 offset:15368
    v_cndmask_b32 v56, v56, v57, vcc
    v_cndmask_b32 v58, v58, v59, vcc
    v_mfma_f32_16x16x32_bf16 v[48:51], a[180:183], a[8:11], v[48:51]
    s_mov_b32 s63, 0x4000
    ds_read_b64_tr_b16 a[28:29], v65 offset:20488
    v_cndmask_b32 v98, v56, v58, s[44:45]
    v_mfma_f32_16x16x32_bf16 v[52:55], a[176:179], a[6:9], 0
    s_waitcnt lgkmcnt(8)
    buffer_load_dwordx4 v[0:3], v247, s[8:11], s63 offen
    v_cndmask_b32 v60, v60, v61, vcc
    v_cndmask_b32 v62, v62, v63, vcc
    v_mfma_f32_16x16x32_bf16 v[52:55], a[180:183], a[10:13], v[52:55]
    ds_read_b64_tr_b16 a[30:31], v65 offset:25608
    v_cndmask_b32 v122, v60, v62, s[44:45]
    v_mfma_f32_16x16x32_bf16 v[56:59], a[176:179], a[8:11], 0
    s_waitcnt lgkmcnt(8)
    ds_read_b64_tr_b16 a[32:33], v65 offset:30728
    v_cndmask_b32 v48, v48, v49, vcc
    v_cndmask_b32 v50, v50, v51, vcc
    v_mfma_f32_16x16x32_bf16 v[56:59], a[180:183], a[12:15], v[56:59]
    s_mov_b32 s63, 0x5000
    ds_read_b64_tr_b16 a[34:35], v65 offset:35848
    v_cndmask_b32 v146, v48, v50, s[44:45]
    v_mfma_f32_16x16x32_bf16 v[60:63], a[176:179], a[10:13], 0
    s_waitcnt lgkmcnt(9)
    buffer_load_dwordx4 v[8:11], v247, s[8:11], s63 offen
    v_cndmask_b32 v52, v52, v53, vcc
    v_cndmask_b32 v54, v54, v55, vcc
    v_mfma_f32_16x16x32_bf16 v[60:63], a[180:183], a[14:17], v[60:63]
    ds_read_b64_tr_b16 a[36:37], v65 offset:40968
    v_cndmask_b32 v170, v52, v54, s[44:45]
    v_mfma_f32_16x16x32_bf16 v[48:51], a[176:179], a[12:15], 0
    s_waitcnt lgkmcnt(9)
    s_mov_b32 s63, 0x6000
    ds_read_b64_tr_b16 a[38:39], v65 offset:46088
    v_cndmask_b32 v56, v56, v57, vcc
    v_cndmask_b32 v58, v58, v59, vcc
    v_mfma_f32_16x16x32_bf16 v[48:51], a[180:183], a[16:19], v[48:51]
    s_waitcnt lgkmcnt(8)
    buffer_load_dwordx4 v[16:19], v247, s[8:11], s63 offen
    v_cndmask_b32 v194, v56, v58, s[44:45]
    v_mfma_f32_16x16x32_bf16 v[52:55], a[184:187], a[20:23], 0
    s_waitcnt lgkmcnt(6)
    ds_read_b64_tr_b16 a[0:1], v66
    v_cndmask_b32 v60, v60, v61, vcc
    v_cndmask_b32 v62, v62, v63, vcc
    v_mfma_f32_16x16x32_bf16 v[52:55], a[188:191], a[24:27], v[52:55]
    ds_read_b64_tr_b16 a[2:3], v66 offset:5120
    v_cndmask_b32 v218, v60, v62, s[44:45]
    v_mfma_f32_16x16x32_bf16 v[56:59], a[184:187], a[22:25], 0
    s_waitcnt lgkmcnt(7)
    s_mov_b32 s63, 0x7000
    ds_read_b64_tr_b16 a[4:5], v66 offset:10240
    v_cndmask_b32 v48, v48, v49, vcc
    v_cndmask_b32 v50, v50, v51, vcc
    v_mfma_f32_16x16x32_bf16 v[56:59], a[188:191], a[26:29], v[56:59]
    buffer_load_dwordx4 v[28:31], v247, s[8:11], s63 offen
    v_cndmask_b32 v242, v48, v50, s[44:45]
    v_mfma_f32_16x16x32_bf16 v[60:63], a[184:187], a[24:27], 0
    s_waitcnt lgkmcnt(7)
    ds_read_b64_tr_b16 a[6:7], v66 offset:15360
    v_cndmask_b32 v52, v52, v53, vcc
    v_cndmask_b32 v54, v54, v55, vcc
    v_mfma_f32_16x16x32_bf16 v[60:63], a[188:191], a[28:31], v[60:63]
    s_mov_b32 s63, 0x8000
    ds_read_b64_tr_b16 a[8:9], v66 offset:20480
    v_cndmask_b32 v99, v52, v54, s[44:45]
    v_mfma_f32_16x16x32_bf16 v[48:51], a[184:187], a[26:29], 0
    s_waitcnt lgkmcnt(8)
    buffer_load_dwordx4 a[40:43], v247, s[8:11], s63 offen
    v_cndmask_b32 v56, v56, v57, vcc
    v_cndmask_b32 v58, v58, v59, vcc
    v_mfma_f32_16x16x32_bf16 v[48:51], a[188:191], a[30:33], v[48:51]
    ds_read_b64_tr_b16 a[10:11], v66 offset:25600
    v_cndmask_b32 v123, v56, v58, s[44:45]
    v_mfma_f32_16x16x32_bf16 v[52:55], a[184:187], a[28:31], 0
    s_waitcnt lgkmcnt(8)
    ds_read_b64_tr_b16 a[12:13], v66 offset:30720
    v_cndmask_b32 v60, v60, v61, vcc
    v_cndmask_b32 v62, v62, v63, vcc
    v_mfma_f32_16x16x32_bf16 v[52:55], a[188:191], a[32:35], v[52:55]
    s_mov_b32 s63, 0x9000
    ds_read_b64_tr_b16 a[14:15], v66 offset:35840
    v_cndmask_b32 v147, v60, v62, s[44:45]
    v_mfma_f32_16x16x32_bf16 v[56:59], a[184:187], a[30:33], 0
    s_waitcnt lgkmcnt(9)
    buffer_load_dwordx4 a[44:47], v247, s[8:11], s63 offen
    v_cndmask_b32 v48, v48, v49, vcc
    v_cndmask_b32 v50, v50, v51, vcc
    v_mfma_f32_16x16x32_bf16 v[56:59], a[188:191], a[34:37], v[56:59]
    ds_read_b64_tr_b16 a[16:17], v66 offset:40960
    v_cndmask_b32 v171, v48, v50, s[44:45]
    v_mfma_f32_16x16x32_bf16 v[60:63], a[184:187], a[32:35], 0
    s_waitcnt lgkmcnt(9)
    s_mov_b32 s63, 0xa000
    ds_read_b64_tr_b16 a[18:19], v66 offset:46080
    v_cndmask_b32 v52, v52, v53, vcc
    v_cndmask_b32 v54, v54, v55, vcc
    v_mfma_f32_16x16x32_bf16 v[60:63], a[188:191], a[36:39], v[60:63]
    s_waitcnt lgkmcnt(8)
    buffer_load_dwordx4 a[48:51], v247, s[8:11], s63 offen
    v_cndmask_b32 v195, v52, v54, s[44:45]
    v_mfma_f32_16x16x32_bf16 v[48:51], a[224:227], a[0:3], 0
    s_waitcnt lgkmcnt(6)
    ds_read_b64_tr_b16 a[20:21], v66 offset:8
    v_cndmask_b32 v56, v56, v57, vcc
    v_cndmask_b32 v58, v58, v59, vcc
    v_mfma_f32_16x16x32_bf16 v[48:51], a[228:231], a[4:7], v[48:51]
    ds_read_b64_tr_b16 a[22:23], v66 offset:5128
    v_cndmask_b32 v219, v56, v58, s[44:45]
    v_mfma_f32_16x16x32_bf16 v[52:55], a[224:227], a[2:5], 0
    s_waitcnt lgkmcnt(7)
    s_mov_b32 s63, 0xb000
    ds_read_b64_tr_b16 a[24:25], v66 offset:10248
    v_cndmask_b32 v60, v60, v61, vcc
    v_cndmask_b32 v62, v62, v63, vcc
    v_mfma_f32_16x16x32_bf16 v[52:55], a[228:231], a[6:9], v[52:55]
    buffer_load_dwordx4 a[52:55], v247, s[8:11], s63 offen
    v_cndmask_b32 v243, v60, v62, s[44:45]
    v_mfma_f32_16x16x32_bf16 v[56:59], a[224:227], a[4:7], 0
    s_waitcnt lgkmcnt(7)
    ds_read_b64_tr_b16 a[26:27], v66 offset:15368
    v_cndmask_b32 v48, v48, v49, vcc
    v_cndmask_b32 v50, v50, v51, vcc
    v_mfma_f32_16x16x32_bf16 v[56:59], a[228:231], a[8:11], v[56:59]
    s_mov_b32 s63, 0xc000
    ds_read_b64_tr_b16 a[28:29], v66 offset:20488
    v_cndmask_b32 v100, v48, v50, s[44:45]
    v_mfma_f32_16x16x32_bf16 v[60:63], a[224:227], a[6:9], 0
    s_waitcnt lgkmcnt(8)
    buffer_load_dwordx4 a[240:243], v247, s[8:11], s63 offen
    v_cndmask_b32 v52, v52, v53, vcc
    v_cndmask_b32 v54, v54, v55, vcc
    v_mfma_f32_16x16x32_bf16 v[60:63], a[228:231], a[10:13], v[60:63]
    ds_read_b64_tr_b16 a[30:31], v66 offset:25608
    v_cndmask_b32 v124, v52, v54, s[44:45]
    v_mfma_f32_16x16x32_bf16 v[48:51], a[224:227], a[8:11], 0
    s_waitcnt lgkmcnt(8)
    ds_read_b64_tr_b16 a[32:33], v66 offset:30728
    v_cndmask_b32 v56, v56, v57, vcc
    v_cndmask_b32 v58, v58, v59, vcc
    v_mfma_f32_16x16x32_bf16 v[48:51], a[228:231], a[12:15], v[48:51]
    s_mov_b32 s63, 0xd000
    ds_read_b64_tr_b16 a[34:35], v66 offset:35848
    v_cndmask_b32 v148, v56, v58, s[44:45]
    v_mfma_f32_16x16x32_bf16 v[52:55], a[224:227], a[10:13], 0
    s_waitcnt lgkmcnt(9)
    buffer_load_dwordx4 a[244:247], v247, s[8:11], s63 offen
    v_cndmask_b32 v60, v60, v61, vcc
    v_cndmask_b32 v62, v62, v63, vcc
    v_mfma_f32_16x16x32_bf16 v[52:55], a[228:231], a[14:17], v[52:55]
    ds_read_b64_tr_b16 a[36:37], v66 offset:40968
    v_cndmask_b32 v172, v60, v62, s[44:45]
    v_mfma_f32_16x16x32_bf16 v[56:59], a[224:227], a[12:15], 0
    s_waitcnt lgkmcnt(9)
    s_lshr_b32 s58, s2, 3
    s_lshl_b32 s58, s58, 7
    ds_read_b64_tr_b16 a[38:39], v66 offset:46088
    v_cndmask_b32 v48, v48, v49, vcc
    v_cndmask_b32 v50, v50, v51, vcc
    v_mfma_f32_16x16x32_bf16 v[56:59], a[228:231], a[16:19], v[56:59]
    s_waitcnt lgkmcnt(8)
    v_lshlrev_b32 v255, 8, v247
    v_cndmask_b32 v196, v48, v50, s[44:45]
    v_mfma_f32_16x16x32_bf16 v[60:63], a[232:235], a[20:23], 0
    s_waitcnt lgkmcnt(6)
    ds_read_b64_tr_b16 a[0:1], v67
    v_cndmask_b32 v52, v52, v53, vcc
    v_cndmask_b32 v54, v54, v55, vcc
    v_mfma_f32_16x16x32_bf16 v[60:63], a[236:239], a[24:27], v[60:63]
    ds_read_b64_tr_b16 a[2:3], v67 offset:5120
    v_cndmask_b32 v220, v52, v54, s[44:45]
    v_mfma_f32_16x16x32_bf16 v[48:51], a[232:235], a[22:25], 0
    s_waitcnt lgkmcnt(7)
    ds_read_b64_tr_b16 a[4:5], v67 offset:10240
    v_cndmask_b32 v56, v56, v57, vcc
    v_cndmask_b32 v58, v58, v59, vcc
    v_mfma_f32_16x16x32_bf16 v[48:51], a[236:239], a[26:29], v[48:51]
    buffer_load_dword a55, v255, s[24:27], s58 offen
    v_cndmask_b32 v244, v56, v58, s[44:45]
    v_mfma_f32_16x16x32_bf16 v[52:55], a[232:235], a[24:27], 0
    s_waitcnt lgkmcnt(7)
    ds_read_b64_tr_b16 a[6:7], v67 offset:15360
    v_cndmask_b32 v60, v60, v61, vcc
    v_cndmask_b32 v62, v62, v63, vcc
    v_mfma_f32_16x16x32_bf16 v[52:55], a[236:239], a[28:31], v[52:55]
    ds_read_b64_tr_b16 a[8:9], v67 offset:20480
    v_cndmask_b32 v101, v60, v62, s[44:45]
    v_mfma_f32_16x16x32_bf16 v[56:59], a[232:235], a[26:29], 0
    s_waitcnt lgkmcnt(8)
    buffer_load_dword a55, v255, s[28:31], s58 offen
    v_cndmask_b32 v48, v48, v49, vcc
    v_cndmask_b32 v50, v50, v51, vcc
    v_mfma_f32_16x16x32_bf16 v[56:59], a[236:239], a[30:33], v[56:59]
    ds_read_b64_tr_b16 a[10:11], v67 offset:25600
    v_cndmask_b32 v125, v48, v50, s[44:45]
    v_mfma_f32_16x16x32_bf16 v[60:63], a[232:235], a[28:31], 0
    s_waitcnt lgkmcnt(8)
    ds_read_b64_tr_b16 a[12:13], v67 offset:30720
    v_cndmask_b32 v52, v52, v53, vcc
    v_cndmask_b32 v54, v54, v55, vcc
    v_mfma_f32_16x16x32_bf16 v[60:63], a[236:239], a[32:35], v[60:63]
    ds_read_b64_tr_b16 a[14:15], v67 offset:35840
    v_cndmask_b32 v149, v52, v54, s[44:45]
    v_mfma_f32_16x16x32_bf16 v[48:51], a[232:235], a[30:33], 0
    s_waitcnt lgkmcnt(9)
    v_cndmask_b32 v56, v56, v57, vcc
    v_cndmask_b32 v58, v58, v59, vcc
    v_mfma_f32_16x16x32_bf16 v[48:51], a[236:239], a[34:37], v[48:51]
    ds_read_b64_tr_b16 a[16:17], v67 offset:40960
    v_cndmask_b32 v173, v56, v58, s[44:45]
    v_mfma_f32_16x16x32_bf16 v[52:55], a[232:235], a[32:35], 0
    s_waitcnt lgkmcnt(9)
    ds_read_b64_tr_b16 a[18:19], v67 offset:46080
    v_cndmask_b32 v60, v60, v61, vcc
    v_cndmask_b32 v62, v62, v63, vcc
    v_mfma_f32_16x16x32_bf16 v[52:55], a[236:239], a[36:39], v[52:55]
    s_waitcnt lgkmcnt(8)
    v_cndmask_b32 v197, v60, v62, s[44:45]
    v_mfma_f32_16x16x32_bf16 v[56:59], a[248:251], a[0:3], 0
    s_waitcnt lgkmcnt(6)
    ds_read_b64_tr_b16 a[20:21], v67 offset:8
    v_cndmask_b32 v48, v48, v49, vcc
    v_cndmask_b32 v50, v50, v51, vcc
    v_mfma_f32_16x16x32_bf16 v[56:59], a[252:255], a[4:7], v[56:59]
    ds_read_b64_tr_b16 a[22:23], v67 offset:5128
    v_cndmask_b32 v221, v48, v50, s[44:45]
    v_mfma_f32_16x16x32_bf16 v[60:63], a[248:251], a[2:5], 0
    s_waitcnt lgkmcnt(7)
    ds_read_b64_tr_b16 a[24:25], v67 offset:10248
    v_cndmask_b32 v52, v52, v53, vcc
    v_cndmask_b32 v54, v54, v55, vcc
    v_mfma_f32_16x16x32_bf16 v[60:63], a[252:255], a[6:9], v[60:63]
    v_cndmask_b32 v245, v52, v54, s[44:45]
    v_mfma_f32_16x16x32_bf16 v[48:51], a[248:251], a[4:7], 0
    s_waitcnt lgkmcnt(7)
    ds_read_b64_tr_b16 a[26:27], v67 offset:15368
    v_cndmask_b32 v56, v56, v57, vcc
    v_cndmask_b32 v58, v58, v59, vcc
    v_mfma_f32_16x16x32_bf16 v[48:51], a[252:255], a[8:11], v[48:51]
    ds_read_b64_tr_b16 a[28:29], v67 offset:20488
    v_cndmask_b32 v102, v56, v58, s[44:45]
    v_mfma_f32_16x16x32_bf16 v[52:55], a[248:251], a[6:9], 0
    s_waitcnt lgkmcnt(8)
    v_cndmask_b32 v60, v60, v61, vcc
    v_cndmask_b32 v62, v62, v63, vcc
    v_mfma_f32_16x16x32_bf16 v[52:55], a[252:255], a[10:13], v[52:55]
    ds_read_b64_tr_b16 a[30:31], v67 offset:25608
    v_cndmask_b32 v126, v60, v62, s[44:45]
    v_mfma_f32_16x16x32_bf16 v[56:59], a[248:251], a[8:11], 0
    s_waitcnt lgkmcnt(8)
    ds_read_b64_tr_b16 a[32:33], v67 offset:30728
    v_cndmask_b32 v48, v48, v49, vcc
    v_cndmask_b32 v50, v50, v51, vcc
    v_mfma_f32_16x16x32_bf16 v[56:59], a[252:255], a[12:15], v[56:59]
    ds_read_b64_tr_b16 a[34:35], v67 offset:35848
    v_cndmask_b32 v150, v48, v50, s[44:45]
    v_mfma_f32_16x16x32_bf16 v[60:63], a[248:251], a[10:13], 0
    s_waitcnt lgkmcnt(9)
    v_cndmask_b32 v52, v52, v53, vcc
    v_cndmask_b32 v54, v54, v55, vcc
    v_mfma_f32_16x16x32_bf16 v[60:63], a[252:255], a[14:17], v[60:63]
    ds_read_b64_tr_b16 a[36:37], v67 offset:40968
    v_cndmask_b32 v174, v52, v54, s[44:45]
    v_mfma_f32_16x16x32_bf16 v[48:51], a[248:251], a[12:15], 0
    s_waitcnt lgkmcnt(9)
    ds_read_b64_tr_b16 a[38:39], v67 offset:46088
    v_cndmask_b32 v56, v56, v57, vcc
    v_cndmask_b32 v58, v58, v59, vcc
    v_mfma_f32_16x16x32_bf16 v[48:51], a[252:255], a[16:19], v[48:51]
    s_waitcnt lgkmcnt(8)
    v_cndmask_b32 v198, v56, v58, s[44:45]
    v_mfma_f32_16x16x32_bf16 v[52:55], a[56:59], a[20:23], 0
    s_waitcnt vmcnt(14) lgkmcnt(6)
    ds_read_b128 a[96:99], v22
    v_cndmask_b32 v60, v60, v61, vcc
    v_cndmask_b32 v62, v62, v63, vcc
    v_mfma_f32_16x16x32_bf16 v[52:55], a[60:63], a[24:27], v[52:55]
    ds_read_b128 a[100:103], v5
    v_cndmask_b32 v222, v60, v62, s[44:45]
    v_mfma_f32_16x16x32_bf16 v[56:59], a[56:59], a[22:25], 0
    s_waitcnt lgkmcnt(7)
    ds_read_b128 a[104:107], v23
    v_cndmask_b32 v48, v48, v49, vcc
    v_cndmask_b32 v50, v50, v51, vcc
    v_mfma_f32_16x16x32_bf16 v[56:59], a[60:63], a[26:29], v[56:59]
    ds_read_b128 a[108:111], v6
    v_cndmask_b32 v246, v48, v50, s[44:45]
    v_mfma_f32_16x16x32_bf16 v[60:63], a[56:59], a[24:27], 0
    s_waitcnt vmcnt(13) lgkmcnt(8)
    ds_read_b128 a[112:115], v24
    v_cndmask_b32 v52, v52, v53, vcc
    v_cndmask_b32 v54, v54, v55, vcc
    v_mfma_f32_16x16x32_bf16 v[60:63], a[60:63], a[28:31], v[60:63]
    ds_read_b128 a[116:119], v7
    v_cndmask_b32 v103, v52, v54, s[44:45]
    v_mfma_f32_16x16x32_bf16 v[48:51], a[56:59], a[26:29], 0
    s_waitcnt lgkmcnt(9)
    v_add_u32 v22, 0xfffe4800, v22
    v_add_u32 v5, 0xfffe4800, v5
    v_add_u32 v23, 0xfffe4800, v23
    v_add_u32 v6, 0xfffe4800, v6
    v_add_u32 v24, 0xfffe4800, v24
    v_add_u32 v7, 0xfffe4800, v7
    v_cndmask_b32 v56, v56, v57, vcc
    v_cndmask_b32 v58, v58, v59, vcc
    v_mfma_f32_16x16x32_bf16 v[48:51], a[60:63], a[30:33], v[48:51]
    ds_read_b128 a[120:123], v22
    v_cndmask_b32 v127, v56, v58, s[44:45]
    v_mfma_f32_16x16x32_bf16 v[52:55], a[56:59], a[28:31], 0
    s_waitcnt lgkmcnt(9)
    ds_read_b128 a[124:127], v5
    v_cndmask_b32 v60, v60, v61, vcc
    v_cndmask_b32 v62, v62, v63, vcc
    v_mfma_f32_16x16x32_bf16 v[52:55], a[60:63], a[32:35], v[52:55]
    ds_read_b128 a[128:131], v23
    v_cndmask_b32 v151, v60, v62, s[44:45]
    v_mfma_f32_16x16x32_bf16 v[56:59], a[56:59], a[30:33], 0
    s_waitcnt lgkmcnt(10)
    ds_read_b128 a[132:135], v6
    v_cndmask_b32 v48, v48, v49, vcc
    v_cndmask_b32 v50, v50, v51, vcc
    v_mfma_f32_16x16x32_bf16 v[56:59], a[60:63], a[34:37], v[56:59]
    ds_read_b128 a[216:219], v24
    v_cndmask_b32 v175, v48, v50, s[44:45]
    v_mfma_f32_16x16x32_bf16 v[60:63], a[56:59], a[32:35], 0
    s_waitcnt lgkmcnt(11)
    ds_read_b128 a[220:223], v7
    v_cndmask_b32 v52, v52, v53, vcc
    v_cndmask_b32 v54, v54, v55, vcc
    v_mfma_f32_16x16x32_bf16 v[60:63], a[60:63], a[36:39], v[60:63]
    v_cndmask_b32 v199, v52, v54, s[44:45]
    v_cndmask_b32 v56, v56, v57, vcc
    v_cndmask_b32 v58, v58, v59, vcc
    v_cndmask_b32 v223, v56, v58, s[44:45]
    s_nop 3
    v_cndmask_b32 v60, v60, v61, vcc
    v_cndmask_b32 v62, v62, v63, vcc
    v_cndmask_b32 v247, v60, v62, s[44:45]
    v_add_u32 v64, 0xc800, v64
    v_add_u32 v65, 0xc800, v65
    v_add_u32 v66, 0xc800, v66
    v_add_u32 v67, 0xc800, v67
    s_waitcnt vmcnt(16) lgkmcnt(0)
    s_barrier
    ds_read_b64_tr_b16 a[0:1], v64
    ds_read_b64_tr_b16 a[2:3], v64 offset:5120
    ds_read_b64_tr_b16 a[4:5], v64 offset:10240
    ds_read_b64_tr_b16 a[6:7], v64 offset:15360
    ds_read_b64_tr_b16 a[8:9], v64 offset:20480
    ds_read_b64_tr_b16 a[10:11], v64 offset:25600
    ds_read_b64_tr_b16 a[12:13], v64 offset:30720
    ds_read_b64_tr_b16 a[14:15], v64 offset:35840
    ds_read_b64_tr_b16 a[16:17], v64 offset:40960
    ds_read_b64_tr_b16 a[18:19], v64 offset:46080
    v_pk_fma_f32 v[86:87], v[96:97], v[96:97], v[86:87]
    v_pk_add_f32 v[72:73], v[72:73], v[96:97]
    v_pk_fma_f32 v[68:69], v[120:121], v[120:121], v[68:69]
    v_pk_add_f32 v[74:75], v[74:75], v[120:121]
    v_pk_fma_f32 v[70:71], v[144:145], v[144:145], v[70:71]
    v_pk_add_f32 v[76:77], v[76:77], v[144:145]
    v_pk_fma_f32 v[46:47], v[168:169], v[168:169], v[46:47]
    v_pk_add_f32 v[78:79], v[78:79], v[168:169]
    v_pk_fma_f32 v[42:43], v[192:193], v[192:193], v[42:43]
    v_pk_add_f32 v[80:81], v[80:81], v[192:193]
    v_pk_fma_f32 v[44:45], v[216:217], v[216:217], v[44:45]
    v_pk_add_f32 v[82:83], v[82:83], v[216:217]
    v_pk_fma_f32 v[40:41], v[240:241], v[240:241], v[40:41]
    v_pk_add_f32 v[84:85], v[84:85], v[240:241]
    v_pk_fma_f32 v[86:87], v[98:99], v[98:99], v[86:87]
    v_pk_add_f32 v[72:73], v[72:73], v[98:99]
    v_pk_fma_f32 v[68:69], v[122:123], v[122:123], v[68:69]
    v_pk_add_f32 v[74:75], v[74:75], v[122:123]
    v_pk_fma_f32 v[70:71], v[146:147], v[146:147], v[70:71]
    v_pk_add_f32 v[76:77], v[76:77], v[146:147]
    v_pk_fma_f32 v[46:47], v[170:171], v[170:171], v[46:47]
    v_pk_add_f32 v[78:79], v[78:79], v[170:171]
    v_pk_fma_f32 v[42:43], v[194:195], v[194:195], v[42:43]
    v_pk_add_f32 v[80:81], v[80:81], v[194:195]
    v_pk_fma_f32 v[44:45], v[218:219], v[218:219], v[44:45]
    v_pk_add_f32 v[82:83], v[82:83], v[218:219]
    v_pk_fma_f32 v[40:41], v[242:243], v[242:243], v[40:41]
    v_pk_add_f32 v[84:85], v[84:85], v[242:243]
    v_pk_fma_f32 v[86:87], v[100:101], v[100:101], v[86:87]
    v_pk_add_f32 v[72:73], v[72:73], v[100:101]
    v_pk_fma_f32 v[68:69], v[124:125], v[124:125], v[68:69]
    v_pk_add_f32 v[74:75], v[74:75], v[124:125]
    v_pk_fma_f32 v[70:71], v[148:149], v[148:149], v[70:71]
    v_pk_add_f32 v[76:77], v[76:77], v[148:149]
    v_pk_fma_f32 v[46:47], v[172:173], v[172:173], v[46:47]
    v_pk_add_f32 v[78:79], v[78:79], v[172:173]
    v_pk_fma_f32 v[42:43], v[196:197], v[196:197], v[42:43]
    v_pk_add_f32 v[80:81], v[80:81], v[196:197]
    v_pk_fma_f32 v[44:45], v[220:221], v[220:221], v[44:45]
    v_pk_add_f32 v[82:83], v[82:83], v[220:221]
    v_pk_fma_f32 v[40:41], v[244:245], v[244:245], v[40:41]
    v_pk_add_f32 v[84:85], v[84:85], v[244:245]
    v_pk_fma_f32 v[86:87], v[102:103], v[102:103], v[86:87]
    v_pk_add_f32 v[72:73], v[72:73], v[102:103]
    v_pk_fma_f32 v[68:69], v[126:127], v[126:127], v[68:69]
    v_pk_add_f32 v[74:75], v[74:75], v[126:127]
    v_pk_fma_f32 v[70:71], v[150:151], v[150:151], v[70:71]
    v_pk_add_f32 v[76:77], v[76:77], v[150:151]
    v_pk_fma_f32 v[46:47], v[174:175], v[174:175], v[46:47]
    v_pk_add_f32 v[78:79], v[78:79], v[174:175]
    v_pk_fma_f32 v[42:43], v[198:199], v[198:199], v[42:43]
    v_pk_add_f32 v[80:81], v[80:81], v[198:199]
    v_pk_fma_f32 v[44:45], v[222:223], v[222:223], v[44:45]
    v_pk_add_f32 v[82:83], v[82:83], v[222:223]
    v_pk_fma_f32 v[40:41], v[246:247], v[246:247], v[40:41]
    v_pk_add_f32 v[84:85], v[84:85], v[246:247]
    s_waitcnt lgkmcnt(8)
    v_mfma_f32_16x16x32_bf16 v[48:51], a[64:67], a[0:3], 0
    s_waitcnt lgkmcnt(6)
    ds_read_b64_tr_b16 a[20:21], v64 offset:8
    v_mfma_f32_16x16x32_bf16 v[48:51], a[68:71], a[4:7], v[48:51]
    ds_read_b64_tr_b16 a[22:23], v64 offset:5128
    v_mfma_f32_16x16x32_bf16 v[52:55], a[64:67], a[2:5], 0
    s_waitcnt lgkmcnt(7)
    s_add_u32 m0, s65, 0x6000
    s_add_u32 s63, s61, 0
    ds_read_b64_tr_b16 a[24:25], v64 offset:10248
    v_mfma_f32_16x16x32_bf16 v[52:55], a[68:71], a[6:9], v[52:55]
    s_waitcnt vmcnt(12)
    buffer_load_dwordx4 v15, s[24:27], s63 offen lds
    v_mfma_f32_16x16x32_bf16 v[56:59], a[64:67], a[4:7], 0
    s_waitcnt lgkmcnt(7)
    ds_read_b64_tr_b16 a[26:27], v64 offset:15368
    v_cndmask_b32 v48, v48, v49, vcc
    v_cndmask_b32 v50, v50, v51, vcc
    v_mfma_f32_16x16x32_bf16 v[56:59], a[68:71], a[8:11], v[56:59]
    ds_read_b64_tr_b16 a[28:29], v64 offset:20488
    v_cndmask_b32 v104, v48, v50, s[44:45]
    v_mfma_f32_16x16x32_bf16 v[60:63], a[64:67], a[6:9], 0
    s_waitcnt lgkmcnt(8)
    v_cndmask_b32 v52, v52, v53, vcc
    v_cndmask_b32 v54, v54, v55, vcc
    v_mfma_f32_16x16x32_bf16 v[60:63], a[68:71], a[10:13], v[60:63]
    ds_read_b64_tr_b16 a[30:31], v64 offset:25608
    v_cndmask_b32 v128, v52, v54, s[44:45]
    v_mfma_f32_16x16x32_bf16 v[48:51], a[64:67], a[8:11], 0
    s_waitcnt lgkmcnt(8)
    ds_read_b64_tr_b16 a[32:33], v64 offset:30728
    v_cndmask_b32 v56, v56, v57, vcc
    v_cndmask_b32 v58, v58, v59, vcc
    v_mfma_f32_16x16x32_bf16 v[48:51], a[68:71], a[12:15], v[48:51]
    s_add_u32 s64, s61, 0x800
    ds_read_b64_tr_b16 a[34:35], v64 offset:35848
    v_cndmask_b32 v152, v56, v58, s[44:45]
    v_mfma_f32_16x16x32_bf16 v[52:55], a[64:67], a[10:13], 0
    s_waitcnt lgkmcnt(9)
    buffer_load_dwordx4 v15, s[24:27], s64 offen offset:1024 lds
    v_cndmask_b32 v60, v60, v61, vcc
    v_cndmask_b32 v62, v62, v63, vcc
    v_mfma_f32_16x16x32_bf16 v[52:55], a[68:71], a[14:17], v[52:55]
    ds_read_b64_tr_b16 a[36:37], v64 offset:40968
    v_cndmask_b32 v176, v60, v62, s[44:45]
    v_mfma_f32_16x16x32_bf16 v[56:59], a[64:67], a[12:15], 0
    s_waitcnt lgkmcnt(9)
    ds_read_b64_tr_b16 a[38:39], v64 offset:46088
    v_cndmask_b32 v48, v48, v49, vcc
    v_cndmask_b32 v50, v50, v51, vcc
    v_mfma_f32_16x16x32_bf16 v[56:59], a[68:71], a[16:19], v[56:59]
    s_waitcnt lgkmcnt(8)
    v_cndmask_b32 v200, v48, v50, s[44:45]
    v_mfma_f32_16x16x32_bf16 v[60:63], a[72:75], a[20:23], 0
    s_waitcnt lgkmcnt(6)
    ds_read_b64_tr_b16 a[0:1], v65
    v_cndmask_b32 v52, v52, v53, vcc
    v_cndmask_b32 v54, v54, v55, vcc
    v_mfma_f32_16x16x32_bf16 v[60:63], a[76:79], a[24:27], v[60:63]
    ds_read_b64_tr_b16 a[2:3], v65 offset:5120
    v_cndmask_b32 v224, v52, v54, s[44:45]
    v_mfma_f32_16x16x32_bf16 v[48:51], a[72:75], a[22:25], 0
    s_waitcnt lgkmcnt(7)
    s_add_u32 s68, s61, 0x5800
    ds_read_b64_tr_b16 a[4:5], v65 offset:10240
    v_cndmask_b32 v56, v56, v57, vcc
    v_cndmask_b32 v58, v58, v59, vcc
    v_mfma_f32_16x16x32_bf16 v[48:51], a[76:79], a[26:29], v[48:51]
    buffer_load_dwordx4 v15, s[24:27], s68 offen offset:2048 lds
    v_cndmask_b32 v248, v56, v58, s[44:45]
    v_mfma_f32_16x16x32_bf16 v[52:55], a[72:75], a[24:27], 0
    s_waitcnt lgkmcnt(7)
    ds_read_b64_tr_b16 a[6:7], v65 offset:15360
    v_cndmask_b32 v60, v60, v61, vcc
    v_cndmask_b32 v62, v62, v63, vcc
    v_mfma_f32_16x16x32_bf16 v[52:55], a[76:79], a[28:31], v[52:55]
    ds_read_b64_tr_b16 a[8:9], v65 offset:20480
    v_cndmask_b32 v105, v60, v62, s[44:45]
    v_mfma_f32_16x16x32_bf16 v[56:59], a[72:75], a[26:29], 0
    s_waitcnt lgkmcnt(8)
    v_cndmask_b32 v48, v48, v49, vcc
    v_cndmask_b32 v50, v50, v51, vcc
    v_mfma_f32_16x16x32_bf16 v[56:59], a[76:79], a[30:33], v[56:59]
    ds_read_b64_tr_b16 a[10:11], v65 offset:25600
    v_cndmask_b32 v129, v48, v50, s[44:45]
    v_mfma_f32_16x16x32_bf16 v[60:63], a[72:75], a[28:31], 0
    s_waitcnt lgkmcnt(8)
    ds_read_b64_tr_b16 a[12:13], v65 offset:30720
    v_cndmask_b32 v52, v52, v53, vcc
    v_cndmask_b32 v54, v54, v55, vcc
    v_mfma_f32_16x16x32_bf16 v[60:63], a[76:79], a[32:35], v[60:63]
    s_add_u32 s63, s61, 0x6000
    ds_read_b64_tr_b16 a[14:15], v65 offset:35840
    v_cndmask_b32 v153, v52, v54, s[44:45]
    v_mfma_f32_16x16x32_bf16 v[48:51], a[72:75], a[30:33], 0
    s_waitcnt lgkmcnt(9)
    buffer_load_dwordx4 v15, s[24:27], s63 offen offset:3072 lds
    v_cndmask_b32 v56, v56, v57, vcc
    v_cndmask_b32 v58, v58, v59, vcc
    v_mfma_f32_16x16x32_bf16 v[48:51], a[76:79], a[34:37], v[48:51]
    ds_read_b64_tr_b16 a[16:17], v65 offset:40960
    v_cndmask_b32 v177, v56, v58, s[44:45]
    v_mfma_f32_16x16x32_bf16 v[52:55], a[72:75], a[32:35], 0
    s_waitcnt lgkmcnt(9)
    ds_read_b64_tr_b16 a[18:19], v65 offset:46080
    v_cndmask_b32 v60, v60, v61, vcc
    v_cndmask_b32 v62, v62, v63, vcc
    v_mfma_f32_16x16x32_bf16 v[52:55], a[76:79], a[36:39], v[52:55]
    s_waitcnt lgkmcnt(8)
    v_cndmask_b32 v201, v60, v62, s[44:45]
    v_mfma_f32_16x16x32_bf16 v[56:59], a[80:83], a[0:3], 0
    s_waitcnt lgkmcnt(6)
    ds_read_b64_tr_b16 a[20:21], v65 offset:8
    v_cndmask_b32 v48, v48, v49, vcc
    v_cndmask_b32 v50, v50, v51, vcc
    v_mfma_f32_16x16x32_bf16 v[56:59], a[84:87], a[4:7], v[56:59]
    ds_read_b64_tr_b16 a[22:23], v65 offset:5128
    v_cndmask_b32 v225, v48, v50, s[44:45]
    v_mfma_f32_16x16x32_bf16 v[60:63], a[80:83], a[2:5], 0
    s_waitcnt lgkmcnt(7)
    s_add_u32 m0, s65, 0x7000
    s_add_u32 s64, s61, 0xc000
    ds_read_b64_tr_b16 a[24:25], v65 offset:10248
    v_cndmask_b32 v52, v52, v53, vcc
    v_cndmask_b32 v54, v54, v55, vcc
    v_mfma_f32_16x16x32_bf16 v[60:63], a[84:87], a[6:9], v[60:63]
    buffer_load_dwordx4 v15, s[24:27], s64 offen lds
    v_cndmask_b32 v249, v52, v54, s[44:45]
    v_mfma_f32_16x16x32_bf16 v[48:51], a[80:83], a[4:7], 0
    s_waitcnt lgkmcnt(7)
    ds_read_b64_tr_b16 a[26:27], v65 offset:15368
    v_cndmask_b32 v56, v56, v57, vcc
    v_cndmask_b32 v58, v58, v59, vcc
    v_mfma_f32_16x16x32_bf16 v[48:51], a[84:87], a[8:11], v[48:51]
    ds_read_b64_tr_b16 a[28:29], v65 offset:20488
    v_cndmask_b32 v106, v56, v58, s[44:45]
    v_mfma_f32_16x16x32_bf16 v[52:55], a[80:83], a[6:9], 0
    s_waitcnt lgkmcnt(8)
    v_cndmask_b32 v60, v60, v61, vcc
    v_cndmask_b32 v62, v62, v63, vcc
    v_mfma_f32_16x16x32_bf16 v[52:55], a[84:87], a[10:13], v[52:55]
    ds_read_b64_tr_b16 a[30:31], v65 offset:25608
    v_cndmask_b32 v130, v60, v62, s[44:45]
    v_mfma_f32_16x16x32_bf16 v[56:59], a[80:83], a[8:11], 0
    s_waitcnt lgkmcnt(8)
    ds_read_b64_tr_b16 a[32:33], v65 offset:30728
    v_cndmask_b32 v48, v48, v49, vcc
    v_cndmask_b32 v50, v50, v51, vcc
    v_mfma_f32_16x16x32_bf16 v[56:59], a[84:87], a[12:15], v[56:59]
    s_add_u32 s68, s61, 0xc800
    ds_read_b64_tr_b16 a[34:35], v65 offset:35848
    v_cndmask_b32 v154, v48, v50, s[44:45]
    v_mfma_f32_16x16x32_bf16 v[60:63], a[80:83], a[10:13], 0
    s_waitcnt lgkmcnt(9)
    buffer_load_dwordx4 v15, s[24:27], s68 offen offset:1024 lds
    s_add_u32 s61, s61, 0x80
    v_cndmask_b32 v52, v52, v53, vcc
    v_cndmask_b32 v54, v54, v55, vcc
    v_mfma_f32_16x16x32_bf16 v[60:63], a[84:87], a[14:17], v[60:63]
    ds_read_b64_tr_b16 a[36:37], v65 offset:40968
    v_cndmask_b32 v178, v52, v54, s[44:45]
    v_mfma_f32_16x16x32_bf16 v[48:51], a[80:83], a[12:15], 0
    s_waitcnt lgkmcnt(9)
    ds_read_b64_tr_b16 a[38:39], v65 offset:46088
    v_cndmask_b32 v56, v56, v57, vcc
    v_cndmask_b32 v58, v58, v59, vcc
    v_mfma_f32_16x16x32_bf16 v[48:51], a[84:87], a[16:19], v[48:51]
    s_waitcnt lgkmcnt(8)
    v_cndmask_b32 v202, v56, v58, s[44:45]
    v_mfma_f32_16x16x32_bf16 v[52:55], a[88:91], a[20:23], 0
    s_waitcnt lgkmcnt(6)
    ds_read_b64_tr_b16 a[0:1], v66
    v_cndmask_b32 v60, v60, v61, vcc
    v_cndmask_b32 v62, v62, v63, vcc
    v_mfma_f32_16x16x32_bf16 v[52:55], a[92:95], a[24:27], v[52:55]
    ds_read_b64_tr_b16 a[2:3], v66 offset:5120
    v_cndmask_b32 v226, v60, v62, s[44:45]
    v_mfma_f32_16x16x32_bf16 v[56:59], a[88:91], a[22:25], 0
    s_waitcnt lgkmcnt(7)
    s_add_u32 m0, s65, 0
    s_add_u32 s63, s61, 0
    ds_read_b64_tr_b16 a[4:5], v66 offset:10240
    v_cndmask_b32 v48, v48, v49, vcc
    v_cndmask_b32 v50, v50, v51, vcc
    v_mfma_f32_16x16x32_bf16 v[56:59], a[92:95], a[26:29], v[56:59]
    buffer_load_dwordx4 v15, s[24:27], s63 offen lds
    v_cndmask_b32 v250, v48, v50, s[44:45]
    v_mfma_f32_16x16x32_bf16 v[60:63], a[88:91], a[24:27], 0
    s_waitcnt lgkmcnt(7)
    ds_read_b64_tr_b16 a[6:7], v66 offset:15360
    v_cndmask_b32 v52, v52, v53, vcc
    v_cndmask_b32 v54, v54, v55, vcc
    v_mfma_f32_16x16x32_bf16 v[60:63], a[92:95], a[28:31], v[60:63]
    ds_read_b64_tr_b16 a[8:9], v66 offset:20480
    v_cndmask_b32 v107, v52, v54, s[44:45]
    v_mfma_f32_16x16x32_bf16 v[48:51], a[88:91], a[26:29], 0
    s_waitcnt lgkmcnt(8)
    v_cndmask_b32 v56, v56, v57, vcc
    v_cndmask_b32 v58, v58, v59, vcc
    v_mfma_f32_16x16x32_bf16 v[48:51], a[92:95], a[30:33], v[48:51]
    ds_read_b64_tr_b16 a[10:11], v66 offset:25600
    v_cndmask_b32 v131, v56, v58, s[44:45]
    v_mfma_f32_16x16x32_bf16 v[52:55], a[88:91], a[28:31], 0
    s_waitcnt lgkmcnt(8)
    ds_read_b64_tr_b16 a[12:13], v66 offset:30720
    v_cndmask_b32 v60, v60, v61, vcc
    v_cndmask_b32 v62, v62, v63, vcc
    v_mfma_f32_16x16x32_bf16 v[52:55], a[92:95], a[32:35], v[52:55]
    s_add_u32 s64, s61, 0x800
    ds_read_b64_tr_b16 a[14:15], v66 offset:35840
    v_cndmask_b32 v155, v60, v62, s[44:45]
    v_mfma_f32_16x16x32_bf16 v[56:59], a[88:91], a[30:33], 0
    s_waitcnt lgkmcnt(9)
    buffer_load_dwordx4 v15, s[24:27], s64 offen offset:1024 lds
    v_cndmask_b32 v48, v48, v49, vcc
    v_cndmask_b32 v50, v50, v51, vcc
    v_mfma_f32_16x16x32_bf16 v[56:59], a[92:95], a[34:37], v[56:59]
    ds_read_b64_tr_b16 a[16:17], v66 offset:40960
    v_cndmask_b32 v179, v48, v50, s[44:45]
    v_mfma_f32_16x16x32_bf16 v[60:63], a[88:91], a[32:35], 0
    s_waitcnt lgkmcnt(9)
    ds_read_b64_tr_b16 a[18:19], v66 offset:46080
    v_cndmask_b32 v52, v52, v53, vcc
    v_cndmask_b32 v54, v54, v55, vcc
    v_mfma_f32_16x16x32_bf16 v[60:63], a[92:95], a[36:39], v[60:63]
    s_waitcnt lgkmcnt(8)
    v_cndmask_b32 v203, v52, v54, s[44:45]
    v_mfma_f32_16x16x32_bf16 v[48:51], a[136:139], a[0:3], 0
    s_waitcnt lgkmcnt(6)
    ds_read_b64_tr_b16 a[20:21], v66 offset:8
    v_cndmask_b32 v56, v56, v57, vcc
    v_cndmask_b32 v58, v58, v59, vcc
    v_mfma_f32_16x16x32_bf16 v[48:51], a[140:143], a[4:7], v[48:51]
    ds_read_b64_tr_b16 a[22:23], v66 offset:5128
    v_cndmask_b32 v227, v56, v58, s[44:45]
    v_mfma_f32_16x16x32_bf16 v[52:55], a[136:139], a[2:5], 0
    s_waitcnt lgkmcnt(7)
    ds_read_b64_tr_b16 a[24:25], v66 offset:10248
    v_cndmask_b32 v60, v60, v61, vcc
    v_cndmask_b32 v62, v62, v63, vcc
    v_mfma_f32_16x16x32_bf16 v[52:55], a[140:143], a[6:9], v[52:55]
    v_cndmask_b32 v251, v60, v62, s[44:45]
    v_mfma_f32_16x16x32_bf16 v[56:59], a[136:139], a[4:7], 0
    s_waitcnt lgkmcnt(7)
    ds_read_b64_tr_b16 a[26:27], v66 offset:15368
    v_cndmask_b32 v48, v48, v49, vcc
    v_cndmask_b32 v50, v50, v51, vcc
    v_mfma_f32_16x16x32_bf16 v[56:59], a[140:143], a[8:11], v[56:59]
    s_add_u32 s68, s61, 0x5800
    ds_read_b64_tr_b16 a[28:29], v66 offset:20488
    v_cndmask_b32 v108, v48, v50, s[44:45]
    v_mfma_f32_16x16x32_bf16 v[60:63], a[136:139], a[6:9], 0
    s_waitcnt lgkmcnt(8)
    buffer_load_dwordx4 v15, s[24:27], s68 offen offset:2048 lds
    v_cndmask_b32 v52, v52, v53, vcc
    v_cndmask_b32 v54, v54, v55, vcc
    v_mfma_f32_16x16x32_bf16 v[60:63], a[140:143], a[10:13], v[60:63]
    ds_read_b64_tr_b16 a[30:31], v66 offset:25608
    v_cndmask_b32 v132, v52, v54, s[44:45]
    v_mfma_f32_16x16x32_bf16 v[48:51], a[136:139], a[8:11], 0
    s_waitcnt lgkmcnt(8)
    ds_read_b64_tr_b16 a[32:33], v66 offset:30728
    v_cndmask_b32 v56, v56, v57, vcc
    v_cndmask_b32 v58, v58, v59, vcc
    v_mfma_f32_16x16x32_bf16 v[48:51], a[140:143], a[12:15], v[48:51]
    ds_read_b64_tr_b16 a[34:35], v66 offset:35848
    v_cndmask_b32 v156, v56, v58, s[44:45]
    v_mfma_f32_16x16x32_bf16 v[52:55], a[136:139], a[10:13], 0
    s_waitcnt lgkmcnt(9)
    v_cndmask_b32 v60, v60, v61, vcc
    v_cndmask_b32 v62, v62, v63, vcc
    v_mfma_f32_16x16x32_bf16 v[52:55], a[140:143], a[14:17], v[52:55]
    ds_read_b64_tr_b16 a[36:37], v66 offset:40968
    v_cndmask_b32 v180, v60, v62, s[44:45]
    v_mfma_f32_16x16x32_bf16 v[56:59], a[136:139], a[12:15], 0
    s_waitcnt lgkmcnt(9)
    ds_read_b64_tr_b16 a[38:39], v66 offset:46088
    v_cndmask_b32 v48, v48, v49, vcc
    v_cndmask_b32 v50, v50, v51, vcc
    v_mfma_f32_16x16x32_bf16 v[56:59], a[140:143], a[16:19], v[56:59]
    s_waitcnt lgkmcnt(8)
    v_cndmask_b32 v204, v48, v50, s[44:45]
    v_mfma_f32_16x16x32_bf16 v[60:63], a[192:195], a[20:23], 0
    s_waitcnt lgkmcnt(6)
    ds_read_b64_tr_b16 a[0:1], v67
    v_cndmask_b32 v52, v52, v53, vcc
    v_cndmask_b32 v54, v54, v55, vcc
    v_mfma_f32_16x16x32_bf16 v[60:63], a[196:199], a[24:27], v[60:63]
    ds_read_b64_tr_b16 a[2:3], v67 offset:5120
    v_cndmask_b32 v228, v52, v54, s[44:45]
    v_mfma_f32_16x16x32_bf16 v[48:51], a[192:195], a[22:25], 0
    s_waitcnt lgkmcnt(7)
    s_add_u32 s63, s61, 0x6000
    ds_read_b64_tr_b16 a[4:5], v67 offset:10240
    v_cndmask_b32 v56, v56, v57, vcc
    v_cndmask_b32 v58, v58, v59, vcc
    v_mfma_f32_16x16x32_bf16 v[48:51], a[196:199], a[26:29], v[48:51]
    buffer_load_dwordx4 v15, s[24:27], s63 offen offset:3072 lds
    v_cndmask_b32 v252, v56, v58, s[44:45]
    v_mfma_f32_16x16x32_bf16 v[52:55], a[192:195], a[24:27], 0
    s_waitcnt lgkmcnt(7)
    ds_read_b64_tr_b16 a[6:7], v67 offset:15360
    v_cndmask_b32 v60, v60, v61, vcc
    v_cndmask_b32 v62, v62, v63, vcc
    v_mfma_f32_16x16x32_bf16 v[52:55], a[196:199], a[28:31], v[52:55]
    ds_read_b64_tr_b16 a[8:9], v67 offset:20480
    v_cndmask_b32 v109, v60, v62, s[44:45]
    v_mfma_f32_16x16x32_bf16 v[56:59], a[192:195], a[26:29], 0
    s_waitcnt lgkmcnt(8)
    v_cndmask_b32 v48, v48, v49, vcc
    v_cndmask_b32 v50, v50, v51, vcc
    v_mfma_f32_16x16x32_bf16 v[56:59], a[196:199], a[30:33], v[56:59]
    ds_read_b64_tr_b16 a[10:11], v67 offset:25600
    v_cndmask_b32 v133, v48, v50, s[44:45]
    v_mfma_f32_16x16x32_bf16 v[60:63], a[192:195], a[28:31], 0
    s_waitcnt lgkmcnt(8)
    ds_read_b64_tr_b16 a[12:13], v67 offset:30720
    v_cndmask_b32 v52, v52, v53, vcc
    v_cndmask_b32 v54, v54, v55, vcc
    v_mfma_f32_16x16x32_bf16 v[60:63], a[196:199], a[32:35], v[60:63]
    s_add_u32 m0, s65, 0x1000
    s_add_u32 s64, s61, 0xc000
    ds_read_b64_tr_b16 a[14:15], v67 offset:35840
    v_cndmask_b32 v157, v52, v54, s[44:45]
    v_mfma_f32_16x16x32_bf16 v[48:51], a[192:195], a[30:33], 0
    s_waitcnt lgkmcnt(9)
    buffer_load_dwordx4 v15, s[24:27], s64 offen lds
    v_cndmask_b32 v56, v56, v57, vcc
    v_cndmask_b32 v58, v58, v59, vcc
    v_mfma_f32_16x16x32_bf16 v[48:51], a[196:199], a[34:37], v[48:51]
    ds_read_b64_tr_b16 a[16:17], v67 offset:40960
    v_cndmask_b32 v181, v56, v58, s[44:45]
    v_mfma_f32_16x16x32_bf16 v[52:55], a[192:195], a[32:35], 0
    s_waitcnt lgkmcnt(9)
    ds_read_b64_tr_b16 a[18:19], v67 offset:46080
    v_cndmask_b32 v60, v60, v61, vcc
    v_cndmask_b32 v62, v62, v63, vcc
    v_mfma_f32_16x16x32_bf16 v[52:55], a[196:199], a[36:39], v[52:55]
    s_waitcnt lgkmcnt(8)
    v_cndmask_b32 v205, v60, v62, s[44:45]
    v_mfma_f32_16x16x32_bf16 v[56:59], a[200:203], a[0:3], 0
    s_waitcnt lgkmcnt(6)
    ds_read_b64_tr_b16 a[20:21], v67 offset:8
    v_cndmask_b32 v48, v48, v49, vcc
    v_cndmask_b32 v50, v50, v51, vcc
    v_mfma_f32_16x16x32_bf16 v[56:59], a[204:207], a[4:7], v[56:59]
    ds_read_b64_tr_b16 a[22:23], v67 offset:5128
    v_cndmask_b32 v229, v48, v50, s[44:45]
    v_mfma_f32_16x16x32_bf16 v[60:63], a[200:203], a[2:5], 0
    s_waitcnt lgkmcnt(7)
    ds_read_b64_tr_b16 a[24:25], v67 offset:10248
    v_cndmask_b32 v52, v52, v53, vcc
    v_cndmask_b32 v54, v54, v55, vcc
    v_mfma_f32_16x16x32_bf16 v[60:63], a[204:207], a[6:9], v[60:63]
    v_cndmask_b32 v253, v52, v54, s[44:45]
    v_mfma_f32_16x16x32_bf16 v[48:51], a[200:203], a[4:7], 0
    s_waitcnt lgkmcnt(7)
    ds_read_b64_tr_b16 a[26:27], v67 offset:15368
    v_cndmask_b32 v56, v56, v57, vcc
    v_cndmask_b32 v58, v58, v59, vcc
    v_mfma_f32_16x16x32_bf16 v[48:51], a[204:207], a[8:11], v[48:51]
    s_add_u32 s68, s61, 0xc800
    ds_read_b64_tr_b16 a[28:29], v67 offset:20488
    v_cndmask_b32 v110, v56, v58, s[44:45]
    v_mfma_f32_16x16x32_bf16 v[52:55], a[200:203], a[6:9], 0
    s_waitcnt lgkmcnt(8)
    buffer_load_dwordx4 v15, s[24:27], s68 offen offset:1024 lds
    s_add_u32 s61, s61, 0x80
    v_cndmask_b32 v60, v60, v61, vcc
    v_cndmask_b32 v62, v62, v63, vcc
    v_mfma_f32_16x16x32_bf16 v[52:55], a[204:207], a[10:13], v[52:55]
    ds_read_b64_tr_b16 a[30:31], v67 offset:25608
    v_cndmask_b32 v134, v60, v62, s[44:45]
    v_mfma_f32_16x16x32_bf16 v[56:59], a[200:203], a[8:11], 0
    s_waitcnt lgkmcnt(8)
    ds_read_b64_tr_b16 a[32:33], v67 offset:30728
    v_cndmask_b32 v48, v48, v49, vcc
    v_cndmask_b32 v50, v50, v51, vcc
    v_mfma_f32_16x16x32_bf16 v[56:59], a[204:207], a[12:15], v[56:59]
    ds_read_b64_tr_b16 a[34:35], v67 offset:35848
    v_cndmask_b32 v158, v48, v50, s[44:45]
    v_mfma_f32_16x16x32_bf16 v[60:63], a[200:203], a[10:13], 0
    s_waitcnt lgkmcnt(9)
    v_cndmask_b32 v52, v52, v53, vcc
    v_cndmask_b32 v54, v54, v55, vcc
    v_mfma_f32_16x16x32_bf16 v[60:63], a[204:207], a[14:17], v[60:63]
    ds_read_b64_tr_b16 a[36:37], v67 offset:40968
    v_cndmask_b32 v182, v52, v54, s[44:45]
    v_mfma_f32_16x16x32_bf16 v[48:51], a[200:203], a[12:15], 0
    s_waitcnt lgkmcnt(9)
    ds_read_b64_tr_b16 a[38:39], v67 offset:46088
    v_cndmask_b32 v56, v56, v57, vcc
    v_cndmask_b32 v58, v58, v59, vcc
    v_mfma_f32_16x16x32_bf16 v[48:51], a[204:207], a[16:19], v[48:51]
    s_waitcnt lgkmcnt(8)
    v_cndmask_b32 v206, v56, v58, s[44:45]
    v_mfma_f32_16x16x32_bf16 v[52:55], a[208:211], a[20:23], 0
    s_waitcnt lgkmcnt(6)
    ds_read_b128 a[224:227], v22 offset:51200
    v_cndmask_b32 v60, v60, v61, vcc
    v_cndmask_b32 v62, v62, v63, vcc
    v_mfma_f32_16x16x32_bf16 v[52:55], a[212:215], a[24:27], v[52:55]
    ds_read_b128 a[228:231], v5 offset:51200
    v_cndmask_b32 v230, v60, v62, s[44:45]
    v_mfma_f32_16x16x32_bf16 v[56:59], a[208:211], a[22:25], 0
    s_waitcnt lgkmcnt(7)
    ds_read_b128 a[232:235], v23 offset:51200
    v_cndmask_b32 v48, v48, v49, vcc
    v_cndmask_b32 v50, v50, v51, vcc
    v_mfma_f32_16x16x32_bf16 v[56:59], a[212:215], a[26:29], v[56:59]
    ds_read_b128 a[236:239], v6 offset:51200
    v_cndmask_b32 v254, v48, v50, s[44:45]
    v_mfma_f32_16x16x32_bf16 v[60:63], a[208:211], a[24:27], 0
    s_waitcnt lgkmcnt(8)
    ds_read_b128 a[248:251], v24 offset:51200
    v_cndmask_b32 v52, v52, v53, vcc
    v_cndmask_b32 v54, v54, v55, vcc
    v_mfma_f32_16x16x32_bf16 v[60:63], a[212:215], a[28:31], v[60:63]
    ds_read_b128 a[252:255], v7 offset:51200
    v_cndmask_b32 v111, v52, v54, s[44:45]
    v_mfma_f32_16x16x32_bf16 v[48:51], a[208:211], a[26:29], 0
    s_waitcnt lgkmcnt(9)
    v_cndmask_b32 v56, v56, v57, vcc
    v_cndmask_b32 v58, v58, v59, vcc
    v_mfma_f32_16x16x32_bf16 v[48:51], a[212:215], a[30:33], v[48:51]
    v_cndmask_b32 v135, v56, v58, s[44:45]
    v_mfma_f32_16x16x32_bf16 v[52:55], a[208:211], a[28:31], 0
    s_waitcnt lgkmcnt(8)
    v_cndmask_b32 v60, v60, v61, vcc
    v_cndmask_b32 v62, v62, v63, vcc
    v_mfma_f32_16x16x32_bf16 v[52:55], a[212:215], a[32:35], v[52:55]
    v_cndmask_b32 v159, v60, v62, s[44:45]
    v_mfma_f32_16x16x32_bf16 v[56:59], a[208:211], a[30:33], 0
    s_waitcnt lgkmcnt(7)
    v_cndmask_b32 v48, v48, v49, vcc
    v_cndmask_b32 v50, v50, v51, vcc
    v_mfma_f32_16x16x32_bf16 v[56:59], a[212:215], a[34:37], v[56:59]
    v_cndmask_b32 v183, v48, v50, s[44:45]
    v_mfma_f32_16x16x32_bf16 v[60:63], a[208:211], a[32:35], 0
    s_waitcnt lgkmcnt(6)
    v_cndmask_b32 v52, v52, v53, vcc
    v_cndmask_b32 v54, v54, v55, vcc
    v_mfma_f32_16x16x32_bf16 v[60:63], a[212:215], a[36:39], v[60:63]
    v_cndmask_b32 v207, v52, v54, s[44:45]
    s_nop 0
    v_cndmask_b32 v56, v56, v57, vcc
    v_cndmask_b32 v58, v58, v59, vcc
    v_cndmask_b32 v231, v56, v58, s[44:45]
    s_nop 2
    v_cndmask_b32 v60, v60, v61, vcc
    v_cndmask_b32 v62, v62, v63, vcc
    v_cndmask_b32 v255, v60, v62, s[44:45]
    s_waitcnt vmcnt(19)
    v_accvgpr_read_b32 v32, a40
    v_accvgpr_read_b32 v33, a41
    v_pk_fma_f32 v[86:87], v[104:105], v[104:105], v[86:87]
    v_pk_add_f32 v[72:73], v[72:73], v[104:105]
    v_pk_fma_f32 v[68:69], v[128:129], v[128:129], v[68:69]
    v_pk_add_f32 v[74:75], v[74:75], v[128:129]
    v_pk_fma_f32 v[70:71], v[152:153], v[152:153], v[70:71]
    v_pk_add_f32 v[76:77], v[76:77], v[152:153]
    v_pk_fma_f32 v[46:47], v[176:177], v[176:177], v[46:47]
    v_pk_add_f32 v[78:79], v[78:79], v[176:177]
    v_pk_fma_f32 v[42:43], v[200:201], v[200:201], v[42:43]
    v_pk_add_f32 v[80:81], v[80:81], v[200:201]
    v_pk_fma_f32 v[44:45], v[224:225], v[224:225], v[44:45]
    v_pk_add_f32 v[82:83], v[82:83], v[224:225]
    v_pk_fma_f32 v[40:41], v[248:249], v[248:249], v[40:41]
    v_pk_add_f32 v[84:85], v[84:85], v[248:249]
    v_pk_fma_f32 v[86:87], v[106:107], v[106:107], v[86:87]
    v_pk_add_f32 v[72:73], v[72:73], v[106:107]
    v_pk_fma_f32 v[68:69], v[130:131], v[130:131], v[68:69]
    v_pk_add_f32 v[74:75], v[74:75], v[130:131]
    v_pk_fma_f32 v[70:71], v[154:155], v[154:155], v[70:71]
    v_pk_add_f32 v[76:77], v[76:77], v[154:155]
    v_pk_fma_f32 v[46:47], v[178:179], v[178:179], v[46:47]
    v_pk_add_f32 v[78:79], v[78:79], v[178:179]
    v_pk_fma_f32 v[42:43], v[202:203], v[202:203], v[42:43]
    v_pk_add_f32 v[80:81], v[80:81], v[202:203]
    v_pk_fma_f32 v[44:45], v[226:227], v[226:227], v[44:45]
    v_pk_add_f32 v[82:83], v[82:83], v[226:227]
    v_pk_fma_f32 v[40:41], v[250:251], v[250:251], v[40:41]
    v_pk_add_f32 v[84:85], v[84:85], v[250:251]
    v_pk_fma_f32 v[86:87], v[108:109], v[108:109], v[86:87]
    v_pk_add_f32 v[72:73], v[72:73], v[108:109]
    v_pk_fma_f32 v[68:69], v[132:133], v[132:133], v[68:69]
    v_pk_add_f32 v[74:75], v[74:75], v[132:133]
    v_pk_fma_f32 v[70:71], v[156:157], v[156:157], v[70:71]
    v_pk_add_f32 v[76:77], v[76:77], v[156:157]
    v_pk_fma_f32 v[46:47], v[180:181], v[180:181], v[46:47]
    v_pk_add_f32 v[78:79], v[78:79], v[180:181]
    v_pk_fma_f32 v[42:43], v[204:205], v[204:205], v[42:43]
    v_pk_add_f32 v[80:81], v[80:81], v[204:205]
    v_pk_fma_f32 v[44:45], v[228:229], v[228:229], v[44:45]
    v_pk_add_f32 v[82:83], v[82:83], v[228:229]
    v_pk_fma_f32 v[40:41], v[252:253], v[252:253], v[40:41]
    v_pk_add_f32 v[84:85], v[84:85], v[252:253]
    v_pk_fma_f32 v[86:87], v[110:111], v[110:111], v[86:87]
    v_pk_add_f32 v[72:73], v[72:73], v[110:111]
    v_pk_fma_f32 v[68:69], v[134:135], v[134:135], v[68:69]
    v_pk_add_f32 v[74:75], v[74:75], v[134:135]
    v_pk_fma_f32 v[70:71], v[158:159], v[158:159], v[70:71]
    v_pk_add_f32 v[76:77], v[76:77], v[158:159]
    v_pk_fma_f32 v[46:47], v[182:183], v[182:183], v[46:47]
    v_pk_add_f32 v[78:79], v[78:79], v[182:183]
    v_pk_fma_f32 v[42:43], v[206:207], v[206:207], v[42:43]
    v_pk_add_f32 v[80:81], v[80:81], v[206:207]
    v_pk_fma_f32 v[44:45], v[230:231], v[230:231], v[44:45]
    v_pk_add_f32 v[82:83], v[82:83], v[230:231]
    v_pk_fma_f32 v[40:41], v[254:255], v[254:255], v[40:41]
    v_pk_add_f32 v[84:85], v[84:85], v[254:255]
    v_add_f32 v72, v72, v73
    v_add_f32 v73, v86, v87
    v_add_f32 v74, v74, v75
    v_add_f32 v75, v68, v69
    v_add_f32 v76, v76, v77
    v_add_f32 v77, v70, v71
    v_add_f32 v78, v78, v79
    v_add_f32 v79, v46, v47
    v_add_f32 v80, v80, v81
    v_add_f32 v81, v42, v43
    v_add_f32 v82, v82, v83
    v_add_f32 v83, v44, v45
    v_add_f32 v84, v84, v85
    v_add_f32 v85, v40, v41
    v_add_f32_dpp v72, v72, v72 quad_perm:[1,0,3,2] row_mask:0xf bank_mask:0xf
    v_add_f32_dpp v73, v73, v73 quad_perm:[1,0,3,2] row_mask:0xf bank_mask:0xf
    v_add_f32_dpp v74, v74, v74 quad_perm:[1,0,3,2] row_mask:0xf bank_mask:0xf
    v_add_f32_dpp v75, v75, v75 quad_perm:[1,0,3,2] row_mask:0xf bank_mask:0xf
    v_add_f32_dpp v76, v76, v76 quad_perm:[1,0,3,2] row_mask:0xf bank_mask:0xf
    v_add_f32_dpp v77, v77, v77 quad_perm:[1,0,3,2] row_mask:0xf bank_mask:0xf
    v_add_f32_dpp v78, v78, v78 quad_perm:[1,0,3,2] row_mask:0xf bank_mask:0xf
    v_add_f32_dpp v79, v79, v79 quad_perm:[1,0,3,2] row_mask:0xf bank_mask:0xf
    v_add_f32_dpp v80, v80, v80 quad_perm:[1,0,3,2] row_mask:0xf bank_mask:0xf
    v_add_f32_dpp v81, v81, v81 quad_perm:[1,0,3,2] row_mask:0xf bank_mask:0xf
    v_add_f32_dpp v82, v82, v82 quad_perm:[1,0,3,2] row_mask:0xf bank_mask:0xf
    v_add_f32_dpp v83, v83, v83 quad_perm:[1,0,3,2] row_mask:0xf bank_mask:0xf
    v_add_f32_dpp v84, v84, v84 quad_perm:[1,0,3,2] row_mask:0xf bank_mask:0xf
    v_add_f32_dpp v85, v85, v85 quad_perm:[1,0,3,2] row_mask:0xf bank_mask:0xf
    v_add_f32_dpp v72, v72, v72 quad_perm:[2,3,0,1] row_mask:0xf bank_mask:0xf
    v_add_f32_dpp v73, v73, v73 quad_perm:[2,3,0,1] row_mask:0xf bank_mask:0xf
    v_add_f32_dpp v74, v74, v74 quad_perm:[2,3,0,1] row_mask:0xf bank_mask:0xf
    v_add_f32_dpp v75, v75, v75 quad_perm:[2,3,0,1] row_mask:0xf bank_mask:0xf
    v_add_f32_dpp v76, v76, v76 quad_perm:[2,3,0,1] row_mask:0xf bank_mask:0xf
    v_add_f32_dpp v77, v77, v77 quad_perm:[2,3,0,1] row_mask:0xf bank_mask:0xf
    v_add_f32_dpp v78, v78, v78 quad_perm:[2,3,0,1] row_mask:0xf bank_mask:0xf
    v_add_f32_dpp v79, v79, v79 quad_perm:[2,3,0,1] row_mask:0xf bank_mask:0xf
    v_add_f32_dpp v80, v80, v80 quad_perm:[2,3,0,1] row_mask:0xf bank_mask:0xf
    v_add_f32_dpp v81, v81, v81 quad_perm:[2,3,0,1] row_mask:0xf bank_mask:0xf
    v_add_f32_dpp v82, v82, v82 quad_perm:[2,3,0,1] row_mask:0xf bank_mask:0xf
    v_add_f32_dpp v83, v83, v83 quad_perm:[2,3,0,1] row_mask:0xf bank_mask:0xf
    v_add_f32_dpp v84, v84, v84 quad_perm:[2,3,0,1] row_mask:0xf bank_mask:0xf
    v_add_f32_dpp v85, v85, v85 quad_perm:[2,3,0,1] row_mask:0xf bank_mask:0xf
    ds_write_b128 v32, v[72:75]
    ds_write_b128 v32, v[76:79] offset:16
    ds_write_b128 v32, v[80:83] offset:32
    ds_write_b64 v32, v[84:85] offset:48
    s_waitcnt vmcnt(6) lgkmcnt(0)
    s_barrier
    ds_read_b128 v[48:51], v33
    ds_read_b128 v[52:55], v33 offset:16
    ds_read_b128 v[56:59], v33 offset:32
    ds_read_b128 v[60:63], v33 offset:48
    ds_read_b64_tr_b16 a[144:145], v1 offset:24576
    ds_read_b64_tr_b16 a[146:147], v1 offset:26624
    ds_read_b64_tr_b16 a[148:149], v1 offset:25600
    ds_read_b64_tr_b16 a[150:151], v1 offset:27648
    ds_read_b64_tr_b16 a[152:153], v1 offset:28672
    ds_read_b64_tr_b16 a[154:155], v1 offset:30720
    ds_read_b64_tr_b16 a[156:157], v1 offset:29696
    ds_read_b64_tr_b16 a[158:159], v1 offset:31744
    ds_read_b64_tr_b16 a[160:161], v1 offset:32768
    ds_read_b64_tr_b16 a[162:163], v1 offset:34816
    ds_read_b64_tr_b16 a[164:165], v1 offset:33792
    ds_read_b64_tr_b16 a[166:167], v1 offset:35840
    ds_read_b64_tr_b16 a[168:169], v2 offset:36864
    ds_read_b64_tr_b16 a[170:171], v2 offset:38912
    ds_read_b64_tr_b16 a[172:173], v2 offset:37888
    ds_read_b64_tr_b16 a[174:175], v2 offset:39936
    ds_read_b64_tr_b16 a[176:177], v2 offset:40960
    ds_read_b64_tr_b16 a[178:179], v2 offset:43008
    ds_read_b64_tr_b16 a[180:181], v2 offset:41984
    ds_read_b64_tr_b16 a[182:183], v2 offset:44032
    ds_read_b64_tr_b16 a[184:185], v2 offset:45056
    ds_read_b64_tr_b16 a[186:187], v2 offset:47104
    ds_read_b64_tr_b16 a[188:189], v2 offset:46080
    ds_read_b64_tr_b16 a[190:191], v2 offset:48128
    v_mov_b64 v[64:65], 0
    v_mov_b64 v[66:67], 0
    v_lshlrev_b32 v32, 4, v0
    ds_write_b128 v32, v[64:67] offset:58368
    v_accvgpr_read_b32 v33, a42
    v_accvgpr_read_b32 v34, a43
    v_accvgpr_read_b32 v35, a44
    v_accvgpr_read_b32 v36, a45
    v_accvgpr_read_b32 v37, a46
    v_accvgpr_read_b32 v38, a47
    v_accvgpr_read_b32 v39, a48
    s_waitcnt lgkmcnt(15)
    v_pk_add_f32 v[72:73], v[72:73], v[48:49]
    v_pk_add_f32 v[74:75], v[74:75], v[50:51]
    v_pk_add_f32 v[76:77], v[76:77], v[52:53]
    v_pk_add_f32 v[78:79], v[78:79], v[54:55]
    v_pk_add_f32 v[80:81], v[80:81], v[56:57]
    v_pk_add_f32 v[82:83], v[82:83], v[58:59]
    v_pk_add_f32 v[84:85], v[84:85], v[60:61]
    s_mov_b32 s64, 0x3baaaaab
    s_mov_b32 s68, 0x3727c5ac
    v_mov_b32 v67, s68
    s_mov_b32 s56, 0x3baaaaab
    s_mov_b32 s57, 0x3baaaaab
    v_pk_fma_f32 v[72:73], v[72:73], s[56:57], v[66:67]
    v_pk_fma_f32 v[74:75], v[74:75], s[56:57], v[66:67]
    v_pk_fma_f32 v[76:77], v[76:77], s[56:57], v[66:67]
    v_pk_fma_f32 v[78:79], v[78:79], s[56:57], v[66:67]
    v_pk_fma_f32 v[80:81], v[80:81], s[56:57], v[66:67]
    v_pk_fma_f32 v[82:83], v[82:83], s[56:57], v[66:67]
    v_pk_fma_f32 v[84:85], v[84:85], s[56:57], v[66:67]
    v_fma_f32 v86, -v72, v72, v73
    v_fma_f32 v68, -v74, v74, v75
    v_fma_f32 v70, -v76, v76, v77
    v_fma_f32 v46, -v78, v78, v79
    v_fma_f32 v42, -v80, v80, v81
    v_fma_f32 v44, -v82, v82, v83
    v_fma_f32 v40, -v84, v84, v85
    v_max_f32 v86, s68, v86
    v_max_f32 v68, s68, v68
    v_max_f32 v70, s68, v70
    v_max_f32 v46, s68, v46
    v_max_f32 v42, s68, v42
    v_max_f32 v44, s68, v44
    v_max_f32 v40, s68, v40
    v_rsq_f32 v86, v86
    v_rsq_f32 v68, v68
    v_rsq_f32 v70, v70
    v_rsq_f32 v46, v46
    v_rsq_f32 v42, v42
    v_rsq_f32 v44, v44
    v_rsq_f32 v40, v40
    v_mul_f32 v86, v8, v86
    v_mul_f32 v68, v8, v68
    v_mul_f32 v70, v8, v70
    v_mul_f32 v46, v8, v46
    v_mul_f32 v42, v8, v42
    v_mul_f32 v44, v8, v44
    v_mul_f32 v40, v8, v40
    v_mul_f32_e64 v87, -v72, v86
    v_mul_f32_e64 v69, -v74, v68
    v_mul_f32_e64 v71, -v76, v70
    v_mul_f32_e64 v47, -v78, v46
    v_mul_f32_e64 v43, -v80, v42
    v_mul_f32_e64 v45, -v82, v44
    v_mul_f32_e64 v41, -v84, v40
    v_pk_fma_f32 v[88:89], v[88:89], v[86:87], v[86:87] op_sel:[0,0,1] op_sel_hi:[1,0,1]
    v_pk_fma_f32 v[90:91], v[90:91], v[86:87], v[86:87] op_sel:[0,0,1] op_sel_hi:[1,0,1]
    v_pk_fma_f32 v[92:93], v[92:93], v[86:87], v[86:87] op_sel:[0,0,1] op_sel_hi:[1,0,1]
    v_pk_fma_f32 v[94:95], v[94:95], v[86:87], v[86:87] op_sel:[0,0,1] op_sel_hi:[1,0,1]
    v_cvt_pk_bf16_f32 v88, v88, v89
    v_cvt_pk_bf16_f32 v89, v90, v91
    v_cvt_pk_bf16_f32 v90, v92, v93
    v_cvt_pk_bf16_f32 v91, v94, v95
    ds_write_b128 v33, v[88:91]
    v_pk_fma_f32 v[96:97], v[96:97], v[86:87], v[86:87] op_sel:[0,0,1] op_sel_hi:[1,0,1]
    v_pk_fma_f32 v[98:99], v[98:99], v[86:87], v[86:87] op_sel:[0,0,1] op_sel_hi:[1,0,1]
    v_pk_fma_f32 v[100:101], v[100:101], v[86:87], v[86:87] op_sel:[0,0,1] op_sel_hi:[1,0,1]
    v_pk_fma_f32 v[102:103], v[102:103], v[86:87], v[86:87] op_sel:[0,0,1] op_sel_hi:[1,0,1]
    v_cvt_pk_bf16_f32 v96, v96, v97
    v_cvt_pk_bf16_f32 v97, v98, v99
    v_cvt_pk_bf16_f32 v98, v100, v101
    v_cvt_pk_bf16_f32 v99, v102, v103
    ds_write_b128 v33, v[96:99] offset:4096
    v_pk_fma_f32 v[104:105], v[104:105], v[86:87], v[86:87] op_sel:[0,0,1] op_sel_hi:[1,0,1]
    v_pk_fma_f32 v[106:107], v[106:107], v[86:87], v[86:87] op_sel:[0,0,1] op_sel_hi:[1,0,1]
    v_pk_fma_f32 v[108:109], v[108:109], v[86:87], v[86:87] op_sel:[0,0,1] op_sel_hi:[1,0,1]
    v_pk_fma_f32 v[110:111], v[110:111], v[86:87], v[86:87] op_sel:[0,0,1] op_sel_hi:[1,0,1]
    v_cvt_pk_bf16_f32 v104, v104, v105
    v_cvt_pk_bf16_f32 v105, v106, v107
    v_cvt_pk_bf16_f32 v106, v108, v109
    v_cvt_pk_bf16_f32 v107, v110, v111
    ds_write_b128 v33, v[104:107] offset:8192
    v_pk_fma_f32 v[112:113], v[112:113], v[68:69], v[68:69] op_sel:[0,0,1] op_sel_hi:[1,0,1]
    v_pk_fma_f32 v[114:115], v[114:115], v[68:69], v[68:69] op_sel:[0,0,1] op_sel_hi:[1,0,1]
    v_pk_fma_f32 v[116:117], v[116:117], v[68:69], v[68:69] op_sel:[0,0,1] op_sel_hi:[1,0,1]
    v_pk_fma_f32 v[118:119], v[118:119], v[68:69], v[68:69] op_sel:[0,0,1] op_sel_hi:[1,0,1]
    v_cvt_pk_bf16_f32 v112, v112, v113
    v_cvt_pk_bf16_f32 v113, v114, v115
    v_cvt_pk_bf16_f32 v114, v116, v117
    v_cvt_pk_bf16_f32 v115, v118, v119
    ds_write_b128 v34, v[112:115]
    v_pk_fma_f32 v[120:121], v[120:121], v[68:69], v[68:69] op_sel:[0,0,1] op_sel_hi:[1,0,1]
    v_pk_fma_f32 v[122:123], v[122:123], v[68:69], v[68:69] op_sel:[0,0,1] op_sel_hi:[1,0,1]
    v_pk_fma_f32 v[124:125], v[124:125], v[68:69], v[68:69] op_sel:[0,0,1] op_sel_hi:[1,0,1]
    v_pk_fma_f32 v[126:127], v[126:127], v[68:69], v[68:69] op_sel:[0,0,1] op_sel_hi:[1,0,1]
    v_cvt_pk_bf16_f32 v120, v120, v121
    v_cvt_pk_bf16_f32 v121, v122, v123
    v_cvt_pk_bf16_f32 v122, v124, v125
    v_cvt_pk_bf16_f32 v123, v126, v127
    ds_write_b128 v34, v[120:123] offset:4096
    v_pk_fma_f32 v[128:129], v[128:129], v[68:69], v[68:69] op_sel:[0,0,1] op_sel_hi:[1,0,1]
    v_pk_fma_f32 v[130:131], v[130:131], v[68:69], v[68:69] op_sel:[0,0,1] op_sel_hi:[1,0,1]
    v_pk_fma_f32 v[132:133], v[132:133], v[68:69], v[68:69] op_sel:[0,0,1] op_sel_hi:[1,0,1]
    v_pk_fma_f32 v[134:135], v[134:135], v[68:69], v[68:69] op_sel:[0,0,1] op_sel_hi:[1,0,1]
    v_cvt_pk_bf16_f32 v128, v128, v129
    v_cvt_pk_bf16_f32 v129, v130, v131
    v_cvt_pk_bf16_f32 v130, v132, v133
    v_cvt_pk_bf16_f32 v131, v134, v135
    ds_write_b128 v34, v[128:131] offset:8192
    v_pk_fma_f32 v[136:137], v[136:137], v[70:71], v[70:71] op_sel:[0,0,1] op_sel_hi:[1,0,1]
    v_pk_fma_f32 v[138:139], v[138:139], v[70:71], v[70:71] op_sel:[0,0,1] op_sel_hi:[1,0,1]
    v_pk_fma_f32 v[140:141], v[140:141], v[70:71], v[70:71] op_sel:[0,0,1] op_sel_hi:[1,0,1]
    v_pk_fma_f32 v[142:143], v[142:143], v[70:71], v[70:71] op_sel:[0,0,1] op_sel_hi:[1,0,1]
    v_cvt_pk_bf16_f32 v136, v136, v137
    v_cvt_pk_bf16_f32 v137, v138, v139
    v_cvt_pk_bf16_f32 v138, v140, v141
    v_cvt_pk_bf16_f32 v139, v142, v143
    ds_write_b128 v35, v[136:139]
    v_pk_fma_f32 v[144:145], v[144:145], v[70:71], v[70:71] op_sel:[0,0,1] op_sel_hi:[1,0,1]
    v_pk_fma_f32 v[146:147], v[146:147], v[70:71], v[70:71] op_sel:[0,0,1] op_sel_hi:[1,0,1]
    v_pk_fma_f32 v[148:149], v[148:149], v[70:71], v[70:71] op_sel:[0,0,1] op_sel_hi:[1,0,1]
    v_pk_fma_f32 v[150:151], v[150:151], v[70:71], v[70:71] op_sel:[0,0,1] op_sel_hi:[1,0,1]
    v_cvt_pk_bf16_f32 v144, v144, v145
    v_cvt_pk_bf16_f32 v145, v146, v147
    v_cvt_pk_bf16_f32 v146, v148, v149
    v_cvt_pk_bf16_f32 v147, v150, v151
    ds_write_b128 v35, v[144:147] offset:4096
    v_pk_fma_f32 v[152:153], v[152:153], v[70:71], v[70:71] op_sel:[0,0,1] op_sel_hi:[1,0,1]
    v_pk_fma_f32 v[154:155], v[154:155], v[70:71], v[70:71] op_sel:[0,0,1] op_sel_hi:[1,0,1]
    v_pk_fma_f32 v[156:157], v[156:157], v[70:71], v[70:71] op_sel:[0,0,1] op_sel_hi:[1,0,1]
    v_pk_fma_f32 v[158:159], v[158:159], v[70:71], v[70:71] op_sel:[0,0,1] op_sel_hi:[1,0,1]
    v_cvt_pk_bf16_f32 v152, v152, v153
    v_cvt_pk_bf16_f32 v153, v154, v155
    v_cvt_pk_bf16_f32 v154, v156, v157
    v_cvt_pk_bf16_f32 v155, v158, v159
    ds_write_b128 v35, v[152:155] offset:8192
    v_pk_fma_f32 v[160:161], v[160:161], v[46:47], v[46:47] op_sel:[0,0,1] op_sel_hi:[1,0,1]
    v_pk_fma_f32 v[162:163], v[162:163], v[46:47], v[46:47] op_sel:[0,0,1] op_sel_hi:[1,0,1]
    v_pk_fma_f32 v[164:165], v[164:165], v[46:47], v[46:47] op_sel:[0,0,1] op_sel_hi:[1,0,1]
    v_pk_fma_f32 v[166:167], v[166:167], v[46:47], v[46:47] op_sel:[0,0,1] op_sel_hi:[1,0,1]
    v_cvt_pk_bf16_f32 v160, v160, v161
    v_cvt_pk_bf16_f32 v161, v162, v163
    v_cvt_pk_bf16_f32 v162, v164, v165
    v_cvt_pk_bf16_f32 v163, v166, v167
    ds_write_b128 v36, v[160:163]
    v_pk_fma_f32 v[168:169], v[168:169], v[46:47], v[46:47] op_sel:[0,0,1] op_sel_hi:[1,0,1]
    v_pk_fma_f32 v[170:171], v[170:171], v[46:47], v[46:47] op_sel:[0,0,1] op_sel_hi:[1,0,1]
    v_pk_fma_f32 v[172:173], v[172:173], v[46:47], v[46:47] op_sel:[0,0,1] op_sel_hi:[1,0,1]
    v_pk_fma_f32 v[174:175], v[174:175], v[46:47], v[46:47] op_sel:[0,0,1] op_sel_hi:[1,0,1]
    v_cvt_pk_bf16_f32 v168, v168, v169
    v_cvt_pk_bf16_f32 v169, v170, v171
    v_cvt_pk_bf16_f32 v170, v172, v173
    v_cvt_pk_bf16_f32 v171, v174, v175
    ds_write_b128 v36, v[168:171] offset:4096
    v_pk_fma_f32 v[176:177], v[176:177], v[46:47], v[46:47] op_sel:[0,0,1] op_sel_hi:[1,0,1]
    v_pk_fma_f32 v[178:179], v[178:179], v[46:47], v[46:47] op_sel:[0,0,1] op_sel_hi:[1,0,1]
    v_pk_fma_f32 v[180:181], v[180:181], v[46:47], v[46:47] op_sel:[0,0,1] op_sel_hi:[1,0,1]
    v_pk_fma_f32 v[182:183], v[182:183], v[46:47], v[46:47] op_sel:[0,0,1] op_sel_hi:[1,0,1]
    v_cvt_pk_bf16_f32 v176, v176, v177
    v_cvt_pk_bf16_f32 v177, v178, v179
    v_cvt_pk_bf16_f32 v178, v180, v181
    v_cvt_pk_bf16_f32 v179, v182, v183
    ds_write_b128 v36, v[176:179] offset:8192
    v_pk_fma_f32 v[184:185], v[184:185], v[42:43], v[42:43] op_sel:[0,0,1] op_sel_hi:[1,0,1]
    v_pk_fma_f32 v[186:187], v[186:187], v[42:43], v[42:43] op_sel:[0,0,1] op_sel_hi:[1,0,1]
    v_pk_fma_f32 v[188:189], v[188:189], v[42:43], v[42:43] op_sel:[0,0,1] op_sel_hi:[1,0,1]
    v_pk_fma_f32 v[190:191], v[190:191], v[42:43], v[42:43] op_sel:[0,0,1] op_sel_hi:[1,0,1]
    v_cvt_pk_bf16_f32 v184, v184, v185
    v_cvt_pk_bf16_f32 v185, v186, v187
    v_cvt_pk_bf16_f32 v186, v188, v189
    v_cvt_pk_bf16_f32 v187, v190, v191
    ds_write_b128 v37, v[184:187]
    v_pk_fma_f32 v[192:193], v[192:193], v[42:43], v[42:43] op_sel:[0,0,1] op_sel_hi:[1,0,1]
    v_pk_fma_f32 v[194:195], v[194:195], v[42:43], v[42:43] op_sel:[0,0,1] op_sel_hi:[1,0,1]
    v_pk_fma_f32 v[196:197], v[196:197], v[42:43], v[42:43] op_sel:[0,0,1] op_sel_hi:[1,0,1]
    v_pk_fma_f32 v[198:199], v[198:199], v[42:43], v[42:43] op_sel:[0,0,1] op_sel_hi:[1,0,1]
    v_cvt_pk_bf16_f32 v192, v192, v193
    v_cvt_pk_bf16_f32 v193, v194, v195
    v_cvt_pk_bf16_f32 v194, v196, v197
    v_cvt_pk_bf16_f32 v195, v198, v199
    ds_write_b128 v37, v[192:195] offset:4096
    v_pk_fma_f32 v[200:201], v[200:201], v[42:43], v[42:43] op_sel:[0,0,1] op_sel_hi:[1,0,1]
    v_pk_fma_f32 v[202:203], v[202:203], v[42:43], v[42:43] op_sel:[0,0,1] op_sel_hi:[1,0,1]
    v_pk_fma_f32 v[204:205], v[204:205], v[42:43], v[42:43] op_sel:[0,0,1] op_sel_hi:[1,0,1]
    v_pk_fma_f32 v[206:207], v[206:207], v[42:43], v[42:43] op_sel:[0,0,1] op_sel_hi:[1,0,1]
    v_cvt_pk_bf16_f32 v200, v200, v201
    v_cvt_pk_bf16_f32 v201, v202, v203
    v_cvt_pk_bf16_f32 v202, v204, v205
    v_cvt_pk_bf16_f32 v203, v206, v207
    ds_write_b128 v37, v[200:203] offset:8192
    v_pk_fma_f32 v[208:209], v[208:209], v[44:45], v[44:45] op_sel:[0,0,1] op_sel_hi:[1,0,1]
    v_pk_fma_f32 v[210:211], v[210:211], v[44:45], v[44:45] op_sel:[0,0,1] op_sel_hi:[1,0,1]
    v_pk_fma_f32 v[212:213], v[212:213], v[44:45], v[44:45] op_sel:[0,0,1] op_sel_hi:[1,0,1]
    v_pk_fma_f32 v[214:215], v[214:215], v[44:45], v[44:45] op_sel:[0,0,1] op_sel_hi:[1,0,1]
    v_cvt_pk_bf16_f32 v208, v208, v209
    v_cvt_pk_bf16_f32 v209, v210, v211
    v_cvt_pk_bf16_f32 v210, v212, v213
    v_cvt_pk_bf16_f32 v211, v214, v215
    ds_write_b128 v38, v[208:211]
    v_pk_fma_f32 v[216:217], v[216:217], v[44:45], v[44:45] op_sel:[0,0,1] op_sel_hi:[1,0,1]
    v_pk_fma_f32 v[218:219], v[218:219], v[44:45], v[44:45] op_sel:[0,0,1] op_sel_hi:[1,0,1]
    v_pk_fma_f32 v[220:221], v[220:221], v[44:45], v[44:45] op_sel:[0,0,1] op_sel_hi:[1,0,1]
    v_pk_fma_f32 v[222:223], v[222:223], v[44:45], v[44:45] op_sel:[0,0,1] op_sel_hi:[1,0,1]
    v_cvt_pk_bf16_f32 v216, v216, v217
    v_cvt_pk_bf16_f32 v217, v218, v219
    v_cvt_pk_bf16_f32 v218, v220, v221
    v_cvt_pk_bf16_f32 v219, v222, v223
    ds_write_b128 v38, v[216:219] offset:4096
    v_pk_fma_f32 v[224:225], v[224:225], v[44:45], v[44:45] op_sel:[0,0,1] op_sel_hi:[1,0,1]
    v_pk_fma_f32 v[226:227], v[226:227], v[44:45], v[44:45] op_sel:[0,0,1] op_sel_hi:[1,0,1]
    v_pk_fma_f32 v[228:229], v[228:229], v[44:45], v[44:45] op_sel:[0,0,1] op_sel_hi:[1,0,1]
    v_pk_fma_f32 v[230:231], v[230:231], v[44:45], v[44:45] op_sel:[0,0,1] op_sel_hi:[1,0,1]
    v_cvt_pk_bf16_f32 v224, v224, v225
    v_cvt_pk_bf16_f32 v225, v226, v227
    v_cvt_pk_bf16_f32 v226, v228, v229
    v_cvt_pk_bf16_f32 v227, v230, v231
    ds_write_b128 v38, v[224:227] offset:8192
    v_pk_fma_f32 v[232:233], v[232:233], v[40:41], v[40:41] op_sel:[0,0,1] op_sel_hi:[1,0,1]
    v_pk_fma_f32 v[234:235], v[234:235], v[40:41], v[40:41] op_sel:[0,0,1] op_sel_hi:[1,0,1]
    v_pk_fma_f32 v[236:237], v[236:237], v[40:41], v[40:41] op_sel:[0,0,1] op_sel_hi:[1,0,1]
    v_pk_fma_f32 v[238:239], v[238:239], v[40:41], v[40:41] op_sel:[0,0,1] op_sel_hi:[1,0,1]
    v_cvt_pk_bf16_f32 v232, v232, v233
    v_cvt_pk_bf16_f32 v233, v234, v235
    v_cvt_pk_bf16_f32 v234, v236, v237
    v_cvt_pk_bf16_f32 v235, v238, v239
    ds_write_b128 v39, v[232:235]
    v_pk_fma_f32 v[240:241], v[240:241], v[40:41], v[40:41] op_sel:[0,0,1] op_sel_hi:[1,0,1]
    v_pk_fma_f32 v[242:243], v[242:243], v[40:41], v[40:41] op_sel:[0,0,1] op_sel_hi:[1,0,1]
    v_pk_fma_f32 v[244:245], v[244:245], v[40:41], v[40:41] op_sel:[0,0,1] op_sel_hi:[1,0,1]
    v_pk_fma_f32 v[246:247], v[246:247], v[40:41], v[40:41] op_sel:[0,0,1] op_sel_hi:[1,0,1]
    v_cvt_pk_bf16_f32 v240, v240, v241
    v_cvt_pk_bf16_f32 v241, v242, v243
    v_cvt_pk_bf16_f32 v242, v244, v245
    v_cvt_pk_bf16_f32 v243, v246, v247
    ds_write_b128 v39, v[240:243] offset:4096
    v_pk_fma_f32 v[248:249], v[248:249], v[40:41], v[40:41] op_sel:[0,0,1] op_sel_hi:[1,0,1]
    v_pk_fma_f32 v[250:251], v[250:251], v[40:41], v[40:41] op_sel:[0,0,1] op_sel_hi:[1,0,1]
    v_pk_fma_f32 v[252:253], v[252:253], v[40:41], v[40:41] op_sel:[0,0,1] op_sel_hi:[1,0,1]
    v_pk_fma_f32 v[254:255], v[254:255], v[40:41], v[40:41] op_sel:[0,0,1] op_sel_hi:[1,0,1]
    v_cvt_pk_bf16_f32 v248, v248, v249
    v_cvt_pk_bf16_f32 v249, v250, v251
    v_cvt_pk_bf16_f32 v250, v252, v253
    v_cvt_pk_bf16_f32 v251, v254, v255
    ds_write_b128 v39, v[248:251] offset:8192
    v_accvgpr_read_b32 v108, a49
    v_accvgpr_read_b32 v109, a51
    v_accvgpr_read_b32 v110, a50
    v_accvgpr_read_b32 v111, a52
    v_accvgpr_read_b32 v96, a53
    s_waitcnt lgkmcnt(0)
    s_barrier
    ds_read_b128 a[0:3], v108
    ds_read_b128 a[4:7], v110 offset:1024
    ds_read_b128 a[8:11], v108 offset:2048
    ds_read_b128 a[12:15], v110 offset:3072
    ds_read_b128 a[16:19], v108 offset:4096
    ds_read_b128 a[20:23], v110 offset:5120
    s_waitcnt lgkmcnt(5)
    v_mfma_f32_32x32x16_bf16 v[48:63], a[144:147], a[0:3], 0
    s_waitcnt lgkmcnt(4)
    ds_read_b128 a[24:27], v109
    ds_read_b128 a[28:31], v111 offset:1024
    v_mfma_f32_32x32x16_bf16 v[48:63], a[148:151], a[4:7], v[48:63]
    s_waitcnt lgkmcnt(5)
    ds_read_b128 a[32:35], v109 offset:2048
    ds_read_b128 a[36:39], v111 offset:3072
    v_mfma_f32_32x32x16_bf16 v[48:63], a[152:155], a[8:11], v[48:63]
    s_waitcnt lgkmcnt(6)
    ds_read_b128 a[40:43], v109 offset:4096
    ds_read_b128 a[44:47], v111 offset:5120
    v_mfma_f32_32x32x16_bf16 v[48:63], a[156:159], a[12:15], v[48:63]
    s_waitcnt lgkmcnt(7)
    ds_read_b128 a[192:195], v96
    ds_read_b128 a[196:199], v96 offset:1024
    v_mfma_f32_32x32x16_bf16 v[48:63], a[160:163], a[16:19], v[48:63]
    s_waitcnt lgkmcnt(8)
    ds_read_b128 a[200:203], v96 offset:2048
    ds_read_b128 a[204:207], v96 offset:3072
    v_mfma_f32_32x32x16_bf16 v[48:63], a[164:167], a[20:23], v[48:63]
    s_waitcnt lgkmcnt(9)
    ds_read_b128 a[208:211], v96 offset:4096
    ds_read_b128 a[212:215], v96 offset:5120
    v_mfma_f32_32x32x16_bf16 v[48:63], a[168:171], a[24:27], v[48:63]
    s_waitcnt lgkmcnt(10)
    ds_read_b128 a[48:51], v108 offset:24576
    ds_read_b128 a[52:55], v110 offset:25600
    v_mfma_f32_32x32x16_bf16 v[48:63], a[172:175], a[28:31], v[48:63]
    s_waitcnt lgkmcnt(11)
    ds_read_b128 a[56:59], v108 offset:26624
    ds_read_b128 a[60:63], v110 offset:27648
    v_mfma_f32_32x32x16_bf16 v[48:63], a[176:179], a[32:35], v[48:63]
    s_waitcnt lgkmcnt(12)
    ds_read_b128 a[64:67], v108 offset:28672
    ds_read_b128 a[68:71], v110 offset:29696
    v_mfma_f32_32x32x16_bf16 v[48:63], a[180:183], a[36:39], v[48:63]
    s_waitcnt lgkmcnt(13)
    v_mfma_f32_32x32x16_bf16 v[48:63], a[184:187], a[40:43], v[48:63]
    s_waitcnt lgkmcnt(12)
    v_mfma_f32_32x32x16_bf16 v[48:63], a[188:191], a[44:47], v[48:63]
    s_waitcnt lgkmcnt(11)
    v_mfma_f32_16x16x32_bf16 v[80:83], a[144:147], a[192:195], 0
    s_waitcnt lgkmcnt(10)
    v_mfma_f32_16x16x32_bf16 v[80:83], a[148:151], a[196:199], v[80:83]
    s_waitcnt lgkmcnt(9)
    v_mfma_f32_16x16x32_bf16 v[80:83], a[152:155], a[200:203], v[80:83]
    s_waitcnt lgkmcnt(8)
    v_mfma_f32_16x16x32_bf16 v[80:83], a[156:159], a[204:207], v[80:83]
    s_waitcnt lgkmcnt(7)
    v_mfma_f32_16x16x32_bf16 v[80:83], a[160:163], a[208:211], v[80:83]
    s_waitcnt lgkmcnt(6)
    s_nop 0
    v_cvt_pk_f16_f32 v32, v48, v49
    v_cvt_pk_f16_f32 v33, v50, v51
    v_pk_fma_f16 v34, v32, v32, s59
    v_pk_fma_f16 v35, v33, v33, s59
    v_pk_mul_f16 v34, v34, v32
    v_pk_mul_f16 v35, v35, v33
    v_exp_f16 v32, v34
    v_exp_f16 v33, v35
    v_exp_f16_sdwa v32, v34 dst_sel:WORD_1 dst_unused:UNUSED_PRESERVE src0_sel:WORD_1
    v_exp_f16_sdwa v33, v35 dst_sel:WORD_1 dst_unused:UNUSED_PRESERVE src0_sel:WORD_1
    v_pk_fma_f16 v32, v32, s73, s73
    v_pk_fma_f16 v33, v33, s73, s73
    v_rcp_f16 v34, v32
    v_mfma_f32_16x16x32_bf16 v[80:83], a[164:167], a[212:215], v[80:83]
    v_rcp_f16 v35, v33
    v_rcp_f16_sdwa v34, v32 dst_sel:WORD_1 dst_unused:UNUSED_PRESERVE src0_sel:WORD_1
    v_rcp_f16_sdwa v35, v33 dst_sel:WORD_1 dst_unused:UNUSED_PRESERVE src0_sel:WORD_1
    v_fma_mix_f32 v48, v48, v34, 0 op_sel:[0,0,0] op_sel_hi:[0,1,0]
    v_fma_mix_f32 v49, v49, v34, 0 op_sel:[0,1,0] op_sel_hi:[0,1,0]
    v_fma_mix_f32 v50, v50, v35, 0 op_sel:[0,0,0] op_sel_hi:[0,1,0]
    v_fma_mix_f32 v51, v51, v35, 0 op_sel:[0,1,0] op_sel_hi:[0,1,0]
    v_cvt_pk_bf16_f32 v40, v48, v49
    v_cvt_pk_bf16_f32 v41, v50, v51
    ds_write_b128 v11, v[80:83] offset:49152
    s_waitcnt vmcnt(0) lgkmcnt(0)
    s_barrier
    v_mfma_f32_32x32x16_bf16 v[64:79], a[144:147], a[48:51], 0
    s_add_u32 m0, s65, 0x6000
    ds_read_b128 a[72:75], v109 offset:24576
    ds_read2st64_b32 v[96:97], v12 offset0:0 offset1:4
    v_mov_b64 v[84:85], 0
    v_mov_b64 v[86:87], 0
    v_mov_b64 v[88:89], 0
    v_mov_b64 v[90:91], 0
    v_mov_b64 v[92:93], 0
    v_mov_b64 v[94:95], 0
    v_cvt_pk_f16_f32 v36, v52, v53
    v_mfma_f32_32x32x16_bf16 v[64:79], a[148:151], a[52:55], v[64:79]
    s_add_u32 s63, s61, 0
    buffer_load_dwordx4 v15, s[24:27], s63 offen lds
    ds_read_b128 a[76:79], v111 offset:25600
    v_cvt_pk_f16_f32 v37, v54, v55
    v_pk_fma_f16 v38, v36, v36, s59
    v_pk_fma_f16 v39, v37, v37, s59
    v_pk_mul_f16 v38, v38, v36
    v_pk_mul_f16 v39, v39, v37
    v_mfma_f32_32x32x16_bf16 v[64:79], a[152:155], a[56:59], v[64:79]
    ds_read_b128 a[80:83], v109 offset:26624
    v_exp_f16 v36, v38
    v_exp_f16 v37, v39
    v_exp_f16_sdwa v36, v38 dst_sel:WORD_1 dst_unused:UNUSED_PRESERVE src0_sel:WORD_1
    v_exp_f16_sdwa v37, v39 dst_sel:WORD_1 dst_unused:UNUSED_PRESERVE src0_sel:WORD_1
    v_mfma_f32_32x32x16_bf16 v[64:79], a[156:159], a[60:63], v[64:79]
    ds_read_b128 a[84:87], v111 offset:27648
    v_pk_fma_f16 v36, v36, s73, s73
    v_pk_fma_f16 v37, v37, s73, s73
    v_rcp_f16 v38, v36
    v_rcp_f16 v39, v37
    v_rcp_f16_sdwa v38, v36 dst_sel:WORD_1 dst_unused:UNUSED_PRESERVE src0_sel:WORD_1
    v_mfma_f32_32x32x16_bf16 v[64:79], a[160:163], a[64:67], v[64:79]
    s_add_u32 s64, s61, 0x800
    buffer_load_dwordx4 v15, s[24:27], s64 offen offset:1024 lds
    v_rcp_f16_sdwa v39, v37 dst_sel:WORD_1 dst_unused:UNUSED_PRESERVE src0_sel:WORD_1
    v_fma_mix_f32 v52, v52, v38, 0 op_sel:[0,0,0] op_sel_hi:[0,1,0]
    v_fma_mix_f32 v53, v53, v38, 0 op_sel:[0,1,0] op_sel_hi:[0,1,0]
    v_fma_mix_f32 v54, v54, v39, 0 op_sel:[0,0,0] op_sel_hi:[0,1,0]
    v_fma_mix_f32 v55, v55, v39, 0 op_sel:[0,1,0] op_sel_hi:[0,1,0]
    v_cvt_pk_bf16_f32 v42, v52, v53
    v_mfma_f32_32x32x16_bf16 v[64:79], a[164:167], a[68:71], v[64:79]
    s_waitcnt lgkmcnt(3)
    ds_read_b128 a[88:91], v109 offset:28672
    v_cvt_pk_bf16_f32 v43, v54, v55
    v_add_f32 v96, v96, v97
    v_cvt_pk_f16_f32 v32, v56, v57
    v_cvt_pk_f16_f32 v33, v58, v59
    v_fmaak_f32 v97, v96, v96, 0x409d2a01
    v_pk_fma_f16 v34, v32, v32, s59
    v_pk_fma_f16 v35, v33, v33, s59
    v_mul_f32 v97, v97, v96
    v_mfma_f32_32x32x16_bf16 v[64:79], a[168:171], a[72:75], v[64:79]
    s_waitcnt lgkmcnt(3)
    ds_write_b128 v9, v[40:43] offset:24576
    ds_read_b128 a[92:95], v111 offset:29696
    v_pk_mul_f16 v34, v34, v32
    v_pk_mul_f16 v35, v35, v33
    v_mfma_f32_32x32x16_bf16 v[64:79], a[172:175], a[76:79], v[64:79]
    s_waitcnt lgkmcnt(4)
    s_add_u32 s68, s61, 0x5800
    buffer_load_dwordx4 v15, s[24:27], s68 offen offset:2048 lds
    v_exp_f16 v32, v34
    v_exp_f16 v33, v35
    v_exp_f16_sdwa v32, v34 dst_sel:WORD_1 dst_unused:UNUSED_PRESERVE src0_sel:WORD_1
    v_mfma_f32_32x32x16_bf16 v[64:79], a[176:179], a[80:83], v[64:79]
    s_waitcnt lgkmcnt(3)
    ds_read_b128 a[136:139], v109 offset:63488
    v_exp_f16_sdwa v33, v35 dst_sel:WORD_1 dst_unused:UNUSED_PRESERVE src0_sel:WORD_1
    v_exp_f32 v97, v97
    v_pk_fma_f16 v32, v32, s73, s73
    v_pk_fma_f16 v33, v33, s73, s73
    v_fma_f32 v97, v97, s67, s67
    v_mfma_f32_32x32x16_bf16 v[64:79], a[180:183], a[84:87], v[64:79]
    s_waitcnt lgkmcnt(3)
    ds_read_b128 a[140:143], v111 offset:64512
    v_rcp_f16 v34, v32
    v_rcp_f16 v35, v33
    v_rcp_f16_sdwa v34, v32 dst_sel:WORD_1 dst_unused:UNUSED_PRESERVE src0_sel:WORD_1
    v_rcp_f16_sdwa v35, v33 dst_sel:WORD_1 dst_unused:UNUSED_PRESERVE src0_sel:WORD_1
    v_mfma_f32_32x32x16_bf16 v[64:79], a[184:187], a[88:91], v[64:79]
    s_waitcnt lgkmcnt(2)
    s_add_u32 s63, s61, 0x6000
    buffer_load_dwordx4 v15, s[24:27], s63 offen offset:3072 lds
    v_rcp_f32 v97, v97
    v_fma_mix_f32 v56, v56, v34, 0 op_sel:[0,0,0] op_sel_hi:[0,1,0]
    v_fma_mix_f32 v57, v57, v34, 0 op_sel:[0,1,0] op_sel_hi:[0,1,0]
    v_fma_mix_f32 v58, v58, v35, 0 op_sel:[0,0,0] op_sel_hi:[0,1,0]
    v_fma_mix_f32 v59, v59, v35, 0 op_sel:[0,1,0] op_sel_hi:[0,1,0]
    v_mul_f32 v97, v97, v96
    v_mfma_f32_32x32x16_bf16 v[64:79], a[188:191], a[92:95], v[64:79]
    v_cvt_pk_bf16_f32 v44, v56, v57
    v_cvt_pk_bf16_f32 v45, v58, v59
    v_cvt_pk_bf16_f32 v97, v97, v97
    v_cvt_pk_f16_f32 v36, v60, v61
    v_cvt_pk_f16_f32 v37, v62, v63
    v_pk_fma_f16 v38, v36, v36, s59
    v_pk_fma_f16 v39, v37, v37, s59
    v_pk_mul_f16 v38, v38, v36
    v_pk_mul_f16 v39, v39, v37
    v_mfma_f32_32x32x16_bf16 v[112:127], a[240:243], a[96:99], 0
    s_add_u32 m0, s65, 0x7000
    ds_write_b16 v13, v97
    v_exp_f16 v36, v38
    v_exp_f16 v37, v39
    v_exp_f16_sdwa v36, v38 dst_sel:WORD_1 dst_unused:UNUSED_PRESERVE src0_sel:WORD_1
    v_mfma_f32_32x32x16_bf16 v[112:127], a[244:247], a[100:103], v[112:127]
    s_add_u32 s64, s61, 0xc000
    buffer_load_dwordx4 v15, s[24:27], s64 offen lds
    v_exp_f16_sdwa v37, v39 dst_sel:WORD_1 dst_unused:UNUSED_PRESERVE src0_sel:WORD_1
    v_pk_fma_f16 v36, v36, s73, s73
    v_pk_fma_f16 v37, v37, s73, s73
    v_rcp_f16 v38, v36
    v_mfma_f32_32x32x16_bf16 v[160:175], a[240:243], a[104:107], 0
    ds_read_b128 a[96:99], v108 offset:59392
    v_rcp_f16 v39, v37
    v_rcp_f16_sdwa v38, v36 dst_sel:WORD_1 dst_unused:UNUSED_PRESERVE src0_sel:WORD_1
    v_rcp_f16_sdwa v39, v37 dst_sel:WORD_1 dst_unused:UNUSED_PRESERVE src0_sel:WORD_1
    v_fma_mix_f32 v60, v60, v38, 0 op_sel:[0,0,0] op_sel_hi:[0,1,0]
    v_fma_mix_f32 v61, v61, v38, 0 op_sel:[0,1,0] op_sel_hi:[0,1,0]
    v_mfma_f32_32x32x16_bf16 v[160:175], a[244:247], a[108:111], v[160:175]
    ds_read_b128 a[100:103], v110 offset:60416
    v_fma_mix_f32 v62, v62, v39, 0 op_sel:[0,0,0] op_sel_hi:[0,1,0]
    v_fma_mix_f32 v63, v63, v39, 0 op_sel:[0,1,0] op_sel_hi:[0,1,0]
    v_cvt_pk_bf16_f32 v46, v60, v61
    v_cvt_pk_bf16_f32 v47, v62, v63
    v_cvt_pk_f16_f32 v32, v64, v65
    v_cvt_pk_f16_f32 v33, v66, v67
    v_pk_fma_f16 v34, v32, v32, s59
    v_pk_fma_f16 v35, v33, v33, s59
    v_mfma_f32_32x32x16_bf16 v[208:223], a[240:243], a[112:115], 0
    s_add_u32 s68, s61, 0xc800
    ds_write_b128 v9, v[44:47] offset:25600
    buffer_load_dwordx4 v15, s[24:27], s68 offen offset:1024 lds
    v_pk_mul_f16 v34, v34, v32
    v_mfma_f32_32x32x16_bf16 v[208:223], a[244:247], a[116:119], v[208:223]
    s_add_u32 s61, s61, 0x80
    v_pk_mul_f16 v35, v35, v33
    v_exp_f16 v32, v34
    v_exp_f16 v33, v35
    v_exp_f16_sdwa v32, v34 dst_sel:WORD_1 dst_unused:UNUSED_PRESERVE src0_sel:WORD_1
    v_exp_f16_sdwa v33, v35 dst_sel:WORD_1 dst_unused:UNUSED_PRESERVE src0_sel:WORD_1
    v_mfma_f32_32x32x16_bf16 v[128:143], a[240:243], a[120:123], 0
    s_add_u32 m0, s66, 0
    ds_read_b128 a[104:107], v108 offset:61440
    v_pk_fma_f16 v32, v32, s73, s73
    v_pk_fma_f16 v33, v33, s73, s73
    v_rcp_f16 v34, v32
    v_rcp_f16 v35, v33
    v_rcp_f16_sdwa v34, v32 dst_sel:WORD_1 dst_unused:UNUSED_PRESERVE src0_sel:WORD_1
    v_mfma_f32_32x32x16_bf16 v[128:143], a[244:247], a[124:127], v[128:143]
    buffer_load_dwordx4 v16, s[28:31], s62 offen lds
    ds_read_b128 a[108:111], v110 offset:62464
    v_rcp_f16_sdwa v35, v33 dst_sel:WORD_1 dst_unused:UNUSED_PRESERVE src0_sel:WORD_1
    v_fma_mix_f32 v64, v64, v34, 0 op_sel:[0,0,0] op_sel_hi:[0,1,0]
    v_fma_mix_f32 v65, v65, v34, 0 op_sel:[0,1,0] op_sel_hi:[0,1,0]
    v_fma_mix_f32 v66, v66, v35, 0 op_sel:[0,0,0] op_sel_hi:[0,1,0]
    v_mfma_f32_32x32x16_bf16 v[176:191], a[240:243], a[128:131], 0
    ds_read_b128 a[112:115], v108 offset:63488
    v_fma_mix_f32 v67, v67, v35, 0 op_sel:[0,1,0] op_sel_hi:[0,1,0]
    v_cvt_pk_bf16_f32 v40, v64, v65
    v_cvt_pk_bf16_f32 v41, v66, v67
    v_cvt_pk_f16_f32 v36, v68, v69
    v_cvt_pk_f16_f32 v37, v70, v71
    v_pk_fma_f16 v38, v36, v36, s59
    v_pk_fma_f16 v39, v37, v37, s59
    v_mfma_f32_32x32x16_bf16 v[176:191], a[244:247], a[132:135], v[176:191]
    s_waitcnt lgkmcnt(5)
    ds_read_b128 a[116:119], v110 offset:64512
    v_pk_mul_f16 v38, v38, v36
    v_pk_mul_f16 v39, v39, v37
    v_exp_f16 v36, v38
    v_exp_f16 v37, v39
    v_exp_f16_sdwa v36, v38 dst_sel:WORD_1 dst_unused:UNUSED_PRESERVE src0_sel:WORD_1
    v_mfma_f32_32x32x16_bf16 v[48:63], a[144:147], a[96:99], 0
    s_waitcnt lgkmcnt(5)
    buffer_load_dwordx4 v17, s[28:31], s62 offen offset:1024 lds
    v_exp_f16_sdwa v37, v39 dst_sel:WORD_1 dst_unused:UNUSED_PRESERVE src0_sel:WORD_1
    v_pk_fma_f16 v36, v36, s73, s73
    v_pk_fma_f16 v37, v37, s73, s73
    v_rcp_f16 v38, v36
    v_mfma_f32_32x32x16_bf16 v[48:63], a[148:151], a[100:103], v[48:63]
    s_waitcnt lgkmcnt(3)
    ds_read_b128 a[120:123], v109 offset:59392
    v_rcp_f16 v39, v37
    v_rcp_f16_sdwa v38, v36 dst_sel:WORD_1 dst_unused:UNUSED_PRESERVE src0_sel:WORD_1
    v_rcp_f16_sdwa v39, v37 dst_sel:WORD_1 dst_unused:UNUSED_PRESERVE src0_sel:WORD_1
    v_fma_mix_f32 v68, v68, v38, 0 op_sel:[0,0,0] op_sel_hi:[0,1,0]
    v_fma_mix_f32 v69, v69, v38, 0 op_sel:[0,1,0] op_sel_hi:[0,1,0]
    v_mfma_f32_32x32x16_bf16 v[48:63], a[152:155], a[104:107], v[48:63]
    s_waitcnt lgkmcnt(3)
    ds_read_b128 a[124:127], v111 offset:60416
    v_fma_mix_f32 v70, v70, v39, 0 op_sel:[0,0,0] op_sel_hi:[0,1,0]
    v_fma_mix_f32 v71, v71, v39, 0 op_sel:[0,1,0] op_sel_hi:[0,1,0]
    v_cvt_pk_bf16_f32 v42, v68, v69
    v_cvt_pk_bf16_f32 v43, v70, v71
    v_cvt_pk_f16_f32 v32, v72, v73
    v_cvt_pk_f16_f32 v33, v74, v75
    v_pk_fma_f16 v34, v32, v32, s59
    v_mfma_f32_32x32x16_bf16 v[48:63], a[156:159], a[108:111], v[48:63]
    s_waitcnt lgkmcnt(3)
    ds_write_b128 v9, v[40:43] offset:28672
    buffer_load_dwordx4 v18, s[28:31], s62 offen offset:2048 lds
    v_pk_fma_f16 v35, v33, v33, s59
    v_pk_mul_f16 v34, v34, v32
    v_mfma_f32_32x32x16_bf16 v[48:63], a[160:163], a[112:115], v[48:63]
    s_waitcnt lgkmcnt(3)
    ds_read_b128 a[128:131], v109 offset:61440
    v_pk_mul_f16 v35, v35, v33
    v_exp_f16 v32, v34
    v_exp_f16 v33, v35
    v_exp_f16_sdwa v32, v34 dst_sel:WORD_1 dst_unused:UNUSED_PRESERVE src0_sel:WORD_1
    v_mfma_f32_32x32x16_bf16 v[48:63], a[164:167], a[116:119], v[48:63]
    s_waitcnt lgkmcnt(3)
    ds_read_b128 a[132:135], v111 offset:62464
    v_exp_f16_sdwa v33, v35 dst_sel:WORD_1 dst_unused:UNUSED_PRESERVE src0_sel:WORD_1
    v_pk_fma_f16 v32, v32, s73, s73
    v_pk_fma_f16 v33, v33, s73, s73
    v_rcp_f16 v34, v32
    v_rcp_f16 v35, v33
    v_mfma_f32_32x32x16_bf16 v[48:63], a[168:171], a[120:123], v[48:63]
    s_waitcnt lgkmcnt(3)
    buffer_load_dwordx4 v16, s[28:31], s62 offen offset:3072 lds
    v_rcp_f16_sdwa v34, v32 dst_sel:WORD_1 dst_unused:UNUSED_PRESERVE src0_sel:WORD_1
    v_rcp_f16_sdwa v35, v33 dst_sel:WORD_1 dst_unused:UNUSED_PRESERVE src0_sel:WORD_1
    v_fma_mix_f32 v72, v72, v34, 0 op_sel:[0,0,0] op_sel_hi:[0,1,0]
    v_fma_mix_f32 v73, v73, v34, 0 op_sel:[0,1,0] op_sel_hi:[0,1,0]
    v_mfma_f32_32x32x16_bf16 v[48:63], a[172:175], a[124:127], v[48:63]
    s_waitcnt lgkmcnt(1)
    ds_read_b64_tr_b16 a[144:145], v1
    v_fma_mix_f32 v74, v74, v35, 0 op_sel:[0,0,0] op_sel_hi:[0,1,0]
    v_fma_mix_f32 v75, v75, v35, 0 op_sel:[0,1,0] op_sel_hi:[0,1,0]
    v_cvt_pk_bf16_f32 v44, v72, v73
    v_cvt_pk_bf16_f32 v45, v74, v75
    v_cvt_pk_f16_f32 v36, v76, v77
    v_cvt_pk_f16_f32 v37, v78, v79
    v_pk_fma_f16 v38, v36, v36, s59
    v_pk_fma_f16 v39, v37, v37, s59
    v_mfma_f32_32x32x16_bf16 v[48:63], a[176:179], a[128:131], v[48:63]
    s_waitcnt lgkmcnt(1)
    s_add_u32 m0, s66, 0x1000
    ds_read_b64_tr_b16 a[146:147], v1 offset:2048
    v_pk_mul_f16 v38, v38, v36
    v_pk_mul_f16 v39, v39, v37
    v_exp_f16 v36, v38
    v_exp_f16 v37, v39
    v_exp_f16_sdwa v36, v38 dst_sel:WORD_1 dst_unused:UNUSED_PRESERVE src0_sel:WORD_1
    v_mfma_f32_32x32x16_bf16 v[48:63], a[180:183], a[132:135], v[48:63]
    s_add_u32 s62, s62, 0x1000
    buffer_load_dwordx4 v17, s[28:31], s62 offen lds
    v_exp_f16_sdwa v37, v39 dst_sel:WORD_1 dst_unused:UNUSED_PRESERVE src0_sel:WORD_1
    v_pk_fma_f16 v36, v36, s73, s73
    v_pk_fma_f16 v37, v37, s73, s73
    v_rcp_f16 v38, v36
    v_mfma_f32_32x32x16_bf16 v[48:63], a[184:187], a[136:139], v[48:63]
    ds_read_b64_tr_b16 a[148:149], v1 offset:1024
    v_rcp_f16 v39, v37
    v_rcp_f16_sdwa v38, v36 dst_sel:WORD_1 dst_unused:UNUSED_PRESERVE src0_sel:WORD_1
    v_rcp_f16_sdwa v39, v37 dst_sel:WORD_1 dst_unused:UNUSED_PRESERVE src0_sel:WORD_1
    v_fma_mix_f32 v76, v76, v38, 0 op_sel:[0,0,0] op_sel_hi:[0,1,0]
    v_mfma_f32_32x32x16_bf16 v[48:63], a[188:191], a[140:143], v[48:63]
    ds_read_b64_tr_b16 a[150:151], v1 offset:3072
    v_fma_mix_f32 v77, v77, v38, 0 op_sel:[0,1,0] op_sel_hi:[0,1,0]
    v_fma_mix_f32 v78, v78, v39, 0 op_sel:[0,0,0] op_sel_hi:[0,1,0]
    v_fma_mix_f32 v79, v79, v39, 0 op_sel:[0,1,0] op_sel_hi:[0,1,0]
    v_cvt_pk_bf16_f32 v46, v76, v77
    v_cvt_pk_bf16_f32 v47, v78, v79
    v_mfma_f32_32x32x16_bf16 v[224:239], a[240:243], a[216:219], 0
    ds_write_b128 v9, v[44:47] offset:29696
    buffer_load_dwordx4 v18, s[28:31], s62 offen offset:1024 lds
    v_mfma_f32_32x32x16_bf16 v[224:239], a[244:247], a[220:223], v[224:239]
    s_add_u32 s62, s62, 0x5000
    ds_read_b64_tr_b16 a[152:153], v1 offset:4096
    ds_read_b64_tr_b16 a[154:155], v1 offset:6144
    v_mfma_f32_32x32x16_bf16 v[144:159], a[240:243], a[224:227], 0
    ds_read_b64_tr_b16 a[156:157], v1 offset:5120
    v_cvt_pk_f16_f32 v32, v48, v49
    v_cvt_pk_f16_f32 v33, v50, v51
    v_pk_fma_f16 v34, v32, v32, s59
    v_pk_fma_f16 v35, v33, v33, s59
    v_pk_mul_f16 v34, v34, v32
    v_pk_mul_f16 v35, v35, v33
    v_exp_f16 v32, v34
    v_mfma_f32_32x32x16_bf16 v[144:159], a[244:247], a[228:231], v[144:159]
    s_waitcnt lgkmcnt(6)
    ds_read_b64_tr_b16 a[158:159], v1 offset:7168
    v_exp_f16 v33, v35
    v_exp_f16_sdwa v32, v34 dst_sel:WORD_1 dst_unused:UNUSED_PRESERVE src0_sel:WORD_1
    v_exp_f16_sdwa v33, v35 dst_sel:WORD_1 dst_unused:UNUSED_PRESERVE src0_sel:WORD_1
    v_pk_fma_f16 v32, v32, s73, s73
    v_pk_fma_f16 v33, v33, s73, s73
    v_mfma_f32_32x32x16_bf16 v[64:79], a[144:147], a[0:3], 0
    s_waitcnt lgkmcnt(5)
    ds_read_b64_tr_b16 a[160:161], v1 offset:8192
    ds_read_b64_tr_b16 a[162:163], v1 offset:10240
    v_rcp_f16 v34, v32
    v_rcp_f16 v35, v33
    v_rcp_f16_sdwa v34, v32 dst_sel:WORD_1 dst_unused:UNUSED_PRESERVE src0_sel:WORD_1
    v_rcp_f16_sdwa v35, v33 dst_sel:WORD_1 dst_unused:UNUSED_PRESERVE src0_sel:WORD_1
    v_mfma_f32_32x32x16_bf16 v[64:79], a[148:151], a[4:7], v[64:79]
    ds_read_b64_tr_b16 a[164:165], v1 offset:9216
    v_fma_mix_f32 v48, v48, v34, 0 op_sel:[0,0,0] op_sel_hi:[0,1,0]
    v_fma_mix_f32 v49, v49, v34, 0 op_sel:[0,1,0] op_sel_hi:[0,1,0]
    v_fma_mix_f32 v50, v50, v35, 0 op_sel:[0,0,0] op_sel_hi:[0,1,0]
    v_fma_mix_f32 v51, v51, v35, 0 op_sel:[0,1,0] op_sel_hi:[0,1,0]
    v_cvt_pk_bf16_f32 v40, v48, v49
    v_cvt_pk_bf16_f32 v41, v50, v51
    v_cvt_pk_f16_f32 v36, v52, v53
    v_cvt_pk_f16_f32 v37, v54, v55
    v_mfma_f32_16x16x32_bf16 v[80:83], a[144:147], a[192:195], 0
    s_waitcnt lgkmcnt(5)
    ds_read_b64_tr_b16 a[166:167], v1 offset:11264
    v_pk_fma_f16 v38, v36, v36, s59
    v_pk_fma_f16 v39, v37, v37, s59
    v_mfma_f32_32x32x16_bf16 v[64:79], a[152:155], a[8:11], v[64:79]
    s_waitcnt lgkmcnt(4)
    ds_read_b64_tr_b16 a[168:169], v2 offset:12288
    ds_read_b64_tr_b16 a[170:171], v2 offset:14336
    v_pk_mul_f16 v38, v38, v36
    v_pk_mul_f16 v39, v39, v37
    v_exp_f16 v36, v38
    v_exp_f16 v37, v39
    v_mfma_f32_32x32x16_bf16 v[64:79], a[156:159], a[12:15], v[64:79]
    ds_read_b64_tr_b16 a[172:173], v2 offset:13312
    v_exp_f16_sdwa v36, v38 dst_sel:WORD_1 dst_unused:UNUSED_PRESERVE src0_sel:WORD_1
    v_exp_f16_sdwa v37, v39 dst_sel:WORD_1 dst_unused:UNUSED_PRESERVE src0_sel:WORD_1
    v_pk_fma_f16 v36, v36, s73, s73
    v_pk_fma_f16 v37, v37, s73, s73
    v_rcp_f16 v38, v36
    v_mfma_f32_16x16x32_bf16 v[80:83], a[148:151], a[196:199], v[80:83]
    s_waitcnt lgkmcnt(5)
    ds_read_b64_tr_b16 a[174:175], v2 offset:15360
    v_rcp_f16 v39, v37
    v_mfma_f32_32x32x16_bf16 v[64:79], a[160:163], a[16:19], v[64:79]
    s_waitcnt lgkmcnt(4)
    ds_read_b64_tr_b16 a[176:177], v2 offset:16384
    ds_read_b64_tr_b16 a[178:179], v2 offset:18432
    v_rcp_f16_sdwa v38, v36 dst_sel:WORD_1 dst_unused:UNUSED_PRESERVE src0_sel:WORD_1
    v_rcp_f16_sdwa v39, v37 dst_sel:WORD_1 dst_unused:UNUSED_PRESERVE src0_sel:WORD_1
    v_fma_mix_f32 v52, v52, v38, 0 op_sel:[0,0,0] op_sel_hi:[0,1,0]
    v_fma_mix_f32 v53, v53, v38, 0 op_sel:[0,1,0] op_sel_hi:[0,1,0]
    v_fma_mix_f32 v54, v54, v39, 0 op_sel:[0,0,0] op_sel_hi:[0,1,0]
    v_mfma_f32_32x32x16_bf16 v[64:79], a[164:167], a[20:23], v[64:79]
    ds_read_b64_tr_b16 a[180:181], v2 offset:17408
    v_fma_mix_f32 v55, v55, v39, 0 op_sel:[0,1,0] op_sel_hi:[0,1,0]
    v_cvt_pk_bf16_f32 v42, v52, v53
    v_cvt_pk_bf16_f32 v43, v54, v55
    v_cvt_pk_f16_f32 v32, v56, v57
    v_cvt_pk_f16_f32 v33, v58, v59
    v_pk_fma_f16 v34, v32, v32, s59
    v_pk_fma_f16 v35, v33, v33, s59
    v_pk_mul_f16 v34, v34, v32
    v_mfma_f32_16x16x32_bf16 v[80:83], a[152:155], a[200:203], v[80:83]
    s_waitcnt lgkmcnt(5)
    ds_write_b128 v9, v[40:43] offset:32768
    ds_read_b64_tr_b16 a[182:183], v2 offset:19456
    v_mfma_f32_32x32x16_bf16 v[64:79], a[168:171], a[24:27], v[64:79]
    s_waitcnt lgkmcnt(5)
    ds_read_b64_tr_b16 a[184:185], v2 offset:20480
    v_pk_mul_f16 v35, v35, v33
    v_exp_f16 v32, v34
    v_exp_f16 v33, v35
    v_exp_f16_sdwa v32, v34 dst_sel:WORD_1 dst_unused:UNUSED_PRESERVE src0_sel:WORD_1
    v_mfma_f32_32x32x16_bf16 v[64:79], a[172:175], a[28:31], v[64:79]
    ds_read_b64_tr_b16 a[186:187], v2 offset:22528
    v_exp_f16_sdwa v33, v35 dst_sel:WORD_1 dst_unused:UNUSED_PRESERVE src0_sel:WORD_1
    v_pk_fma_f16 v32, v32, s73, s73
    v_pk_fma_f16 v33, v33, s73, s73
    v_rcp_f16 v34, v32
    v_rcp_f16 v35, v33
    v_mfma_f32_16x16x32_bf16 v[80:83], a[156:159], a[204:207], v[80:83]
    s_waitcnt lgkmcnt(5)
    ds_read_b64_tr_b16 a[188:189], v2 offset:21504
    v_rcp_f16_sdwa v34, v32 dst_sel:WORD_1 dst_unused:UNUSED_PRESERVE src0_sel:WORD_1
    v_mfma_f32_32x32x16_bf16 v[64:79], a[176:179], a[32:35], v[64:79]
    s_waitcnt lgkmcnt(3)
    ds_read_b64_tr_b16 a[190:191], v2 offset:23552
    v_rcp_f16_sdwa v35, v33 dst_sel:WORD_1 dst_unused:UNUSED_PRESERVE src0_sel:WORD_1
    v_fma_mix_f32 v56, v56, v34, 0 op_sel:[0,0,0] op_sel_hi:[0,1,0]
    v_fma_mix_f32 v57, v57, v34, 0 op_sel:[0,1,0] op_sel_hi:[0,1,0]
    v_fma_mix_f32 v58, v58, v35, 0 op_sel:[0,0,0] op_sel_hi:[0,1,0]
    v_fma_mix_f32 v59, v59, v35, 0 op_sel:[0,1,0] op_sel_hi:[0,1,0]
    v_cvt_pk_bf16_f32 v44, v56, v57
    v_cvt_pk_bf16_f32 v45, v58, v59
    v_mfma_f32_32x32x16_bf16 v[64:79], a[180:183], a[36:39], v[64:79]
    v_cvt_pk_f16_f32 v36, v60, v61
    v_cvt_pk_f16_f32 v37, v62, v63
    v_pk_fma_f16 v38, v36, v36, s59
    v_pk_fma_f16 v39, v37, v37, s59
    v_pk_mul_f16 v38, v38, v36
    v_pk_mul_f16 v39, v39, v37
    v_exp_f16 v36, v38
    v_exp_f16 v37, v39
    v_mfma_f32_16x16x32_bf16 v[80:83], a[160:163], a[208:211], v[80:83]
    s_waitcnt lgkmcnt(2)
    v_exp_f16_sdwa v36, v38 dst_sel:WORD_1 dst_unused:UNUSED_PRESERVE src0_sel:WORD_1
    v_exp_f16_sdwa v37, v39 dst_sel:WORD_1 dst_unused:UNUSED_PRESERVE src0_sel:WORD_1
    v_mfma_f32_32x32x16_bf16 v[64:79], a[184:187], a[40:43], v[64:79]
    s_waitcnt lgkmcnt(0)
    v_pk_fma_f16 v36, v36, s73, s73
    v_pk_fma_f16 v37, v37, s73, s73
    v_rcp_f16 v38, v36
    v_rcp_f16 v39, v37
    v_rcp_f16_sdwa v38, v36 dst_sel:WORD_1 dst_unused:UNUSED_PRESERVE src0_sel:WORD_1
    v_mfma_f32_32x32x16_bf16 v[64:79], a[188:191], a[44:47], v[64:79]
    v_rcp_f16_sdwa v39, v37 dst_sel:WORD_1 dst_unused:UNUSED_PRESERVE src0_sel:WORD_1
    v_fma_mix_f32 v60, v60, v38, 0 op_sel:[0,0,0] op_sel_hi:[0,1,0]
    v_fma_mix_f32 v61, v61, v38, 0 op_sel:[0,1,0] op_sel_hi:[0,1,0]
    v_fma_mix_f32 v62, v62, v39, 0 op_sel:[0,0,0] op_sel_hi:[0,1,0]
    v_fma_mix_f32 v63, v63, v39, 0 op_sel:[0,1,0] op_sel_hi:[0,1,0]
    v_cvt_pk_bf16_f32 v46, v60, v61
    v_cvt_pk_bf16_f32 v47, v62, v63
    v_mfma_f32_16x16x32_bf16 v[80:83], a[164:167], a[212:215], v[80:83]
    ds_write_b128 v9, v[44:47] offset:33792
    v_mfma_f32_32x32x16_bf16 v[192:207], a[240:243], a[232:235], 0
    v_mfma_f32_32x32x16_bf16 v[192:207], a[244:247], a[236:239], v[192:207]
    v_mfma_f32_32x32x16_bf16 v[240:255], a[240:243], a[248:251], 0
    s_nop 3
    ds_write_b128 v11, v[80:83] offset:53248
    v_cvt_pk_f16_f32 v32, v64, v65
    v_cvt_pk_f16_f32 v33, v66, v67
    v_pk_fma_f16 v34, v32, v32, s59
    v_pk_fma_f16 v35, v33, v33, s59
    v_pk_mul_f16 v34, v34, v32
    v_pk_mul_f16 v35, v35, v33
    v_exp_f16 v32, v34
    v_exp_f16 v33, v35
    v_exp_f16_sdwa v32, v34 dst_sel:WORD_1 dst_unused:UNUSED_PRESERVE src0_sel:WORD_1
    v_mfma_f32_32x32x16_bf16 v[240:255], a[244:247], a[252:255], v[240:255]
    v_exp_f16_sdwa v33, v35 dst_sel:WORD_1 dst_unused:UNUSED_PRESERVE src0_sel:WORD_1
    v_pk_fma_f16 v32, v32, s73, s73
    v_pk_fma_f16 v33, v33, s73, s73
    v_rcp_f16 v34, v32
    v_rcp_f16 v35, v33
    v_rcp_f16_sdwa v34, v32 dst_sel:WORD_1 dst_unused:UNUSED_PRESERVE src0_sel:WORD_1
    v_rcp_f16_sdwa v35, v33 dst_sel:WORD_1 dst_unused:UNUSED_PRESERVE src0_sel:WORD_1
    v_fma_mix_f32 v64, v64, v34, 0 op_sel:[0,0,0] op_sel_hi:[0,1,0]
    v_fma_mix_f32 v65, v65, v34, 0 op_sel:[0,1,0] op_sel_hi:[0,1,0]
    v_fma_mix_f32 v66, v66, v35, 0 op_sel:[0,0,0] op_sel_hi:[0,1,0]
    v_fma_mix_f32 v67, v67, v35, 0 op_sel:[0,1,0] op_sel_hi:[0,1,0]
    v_cvt_pk_bf16_f32 v40, v64, v65
    v_cvt_pk_bf16_f32 v41, v66, v67
    s_waitcnt vmcnt(0) lgkmcnt(0)
    s_barrier
    s_mov_b32 s60, 5
.p2align 6
L_LOOP:
    v_mfma_f32_32x32x16_bf16 v[48:63], a[144:147], a[48:51], 0
    s_add_u32 m0, s65, 0
    ds_read2st64_b32 v[96:97], v12 offset0:16 offset1:20
    v_cvt_pk_f16_f32 v36, v68, v69
    v_cvt_pk_f16_f32 v37, v70, v71
    v_pk_fma_f16 v38, v36, v36, s59
    v_pk_fma_f16 v39, v37, v37, s59
    v_pk_mul_f16 v38, v38, v36
    v_mfma_f32_32x32x16_bf16 v[48:63], a[148:151], a[52:55], v[48:63]
    s_add_u32 s63, s61, 0
    buffer_load_dwordx4 v15, s[24:27], s63 offen lds
    v_pk_mul_f16 v39, v39, v37
    v_exp_f16 v36, v38
    v_exp_f16 v37, v39
    v_mfma_f32_32x32x16_bf16 v[48:63], a[152:155], a[56:59], v[48:63]
    ds_read_b64_tr_b16 a[240:241], v3
    v_exp_f16_sdwa v36, v38 dst_sel:WORD_1 dst_unused:UNUSED_PRESERVE src0_sel:WORD_1
    v_exp_f16_sdwa v37, v39 dst_sel:WORD_1 dst_unused:UNUSED_PRESERVE src0_sel:WORD_1
    v_pk_fma_f16 v36, v36, s73, s73
    v_mfma_f32_32x32x16_bf16 v[48:63], a[156:159], a[60:63], v[48:63]
    ds_read_b64_tr_b16 a[242:243], v3 offset:3072
    v_pk_fma_f16 v37, v37, s73, s73
    v_rcp_f16 v38, v36
    v_rcp_f16 v39, v37
    v_mfma_f32_32x32x16_bf16 v[48:63], a[160:163], a[64:67], v[48:63]
    ds_read_b128 a[216:219], v10 offset:24576
    v_rcp_f16_sdwa v38, v36 dst_sel:WORD_1 dst_unused:UNUSED_PRESERVE src0_sel:WORD_1
    v_rcp_f16_sdwa v39, v37 dst_sel:WORD_1 dst_unused:UNUSED_PRESERVE src0_sel:WORD_1
    v_fma_mix_f32 v68, v68, v38, 0 op_sel:[0,0,0] op_sel_hi:[0,1,0]
    v_fma_mix_f32 v69, v69, v38, 0 op_sel:[0,1,0] op_sel_hi:[0,1,0]
    v_mfma_f32_32x32x16_bf16 v[48:63], a[164:167], a[68:71], v[48:63]
    s_waitcnt lgkmcnt(3)
    ds_read_b128 a[220:223], v10 offset:28672
    v_fma_mix_f32 v70, v70, v39, 0 op_sel:[0,0,0] op_sel_hi:[0,1,0]
    v_fma_mix_f32 v71, v71, v39, 0 op_sel:[0,1,0] op_sel_hi:[0,1,0]
    v_cvt_pk_bf16_f32 v42, v68, v69
    v_cvt_pk_bf16_f32 v43, v70, v71
    v_add_f32 v96, v96, v97
    v_mfma_f32_32x32x16_bf16 v[48:63], a[168:171], a[72:75], v[48:63]
    s_add_u32 s64, s61, 0x800
    ds_write_b128 v9, v[40:43]
    buffer_load_dwordx4 v15, s[24:27], s64 offen offset:1024 lds
    v_mfma_f32_32x32x16_bf16 v[48:63], a[172:175], a[76:79], v[48:63]
    v_cvt_pk_f16_f32 v32, v72, v73
    v_cvt_pk_f16_f32 v33, v74, v75
    v_fmaak_f32 v97, v96, v96, 0x409d2a01
    v_pk_fma_f16 v34, v32, v32, s59
    v_pk_fma_f16 v35, v33, v33, s59
    v_mul_f32 v97, v97, v96
    v_mfma_f32_32x32x16_bf16 v[48:63], a[176:179], a[80:83], v[48:63]
    ds_read_b128 v[100:103], v14
    v_pk_mul_f16 v34, v34, v32
    v_pk_mul_f16 v35, v35, v33
    v_exp_f16 v32, v34
    v_exp_f16 v33, v35
    v_mfma_f32_32x32x16_bf16 v[48:63], a[180:183], a[84:87], v[48:63]
    ds_read_b128 a[224:227], v10 offset:32768
    v_exp_f16_sdwa v32, v34 dst_sel:WORD_1 dst_unused:UNUSED_PRESERVE src0_sel:WORD_1
    v_exp_f16_sdwa v33, v35 dst_sel:WORD_1 dst_unused:UNUSED_PRESERVE src0_sel:WORD_1
    v_exp_f32 v97, v97
    v_mfma_f32_32x32x16_bf16 v[48:63], a[184:187], a[88:91], v[48:63]
    ds_read_b64_tr_b16 a[244:245], v3 offset:128
    v_pk_fma_f16 v32, v32, s73, s73
    v_pk_fma_f16 v33, v33, s73, s73
    v_fma_f32 v97, v97, s67, s67
    v_rcp_f16 v34, v32
    v_mfma_f32_32x32x16_bf16 v[48:63], a[188:191], a[92:95], v[48:63]
    s_waitcnt lgkmcnt(5)
    s_add_u32 s68, s61, 0x5800
    buffer_load_dwordx4 v15, s[24:27], s68 offen offset:2048 lds
    v_rcp_f16 v35, v33
    v_rcp_f16_sdwa v34, v32 dst_sel:WORD_1 dst_unused:UNUSED_PRESERVE src0_sel:WORD_1
    v_mfma_f32_32x32x16_bf16 v[112:127], a[240:243], a[216:219], v[112:127]
    s_waitcnt lgkmcnt(4)
    ds_read_b64_tr_b16 a[246:247], v3 offset:3200
    v_rcp_f16_sdwa v35, v33 dst_sel:WORD_1 dst_unused:UNUSED_PRESERVE src0_sel:WORD_1
    v_rcp_f32 v97, v97
    v_fma_mix_f32 v72, v72, v34, 0 op_sel:[0,0,0] op_sel_hi:[0,1,0]
    v_fma_mix_f32 v73, v73, v34, 0 op_sel:[0,1,0] op_sel_hi:[0,1,0]
    v_mfma_f32_32x32x16_bf16 v[160:175], a[240:243], a[220:223], v[160:175]
    s_waitcnt lgkmcnt(3)
    ds_read_b64_tr_b16 a[248:249], v3 offset:256
    v_fma_mix_f32 v74, v74, v35, 0 op_sel:[0,0,0] op_sel_hi:[0,1,0]
    v_fma_mix_f32 v75, v75, v35, 0 op_sel:[0,1,0] op_sel_hi:[0,1,0]
    v_mul_f32 v97, v97, v96
    v_cvt_pk_bf16_f32 v44, v72, v73
    v_cvt_pk_bf16_f32 v45, v74, v75
    v_mfma_f32_16x16x32_bf16 v[84:87], a[240:243], v[100:103], v[84:87]
    s_waitcnt lgkmcnt(3)
    ds_read_b64_tr_b16 a[250:251], v3 offset:3328
    v_cvt_pk_bf16_f32 v97, v97, v97
    v_mfma_f32_32x32x16_bf16 v[208:223], a[240:243], a[224:227], v[208:223]
    s_waitcnt lgkmcnt(2)
    ds_write_b16 v13, v97 offset:512
    v_cvt_pk_f16_f32 v36, v76, v77
    v_cvt_pk_f16_f32 v37, v78, v79
    v_pk_fma_f16 v38, v36, v36, s59
    v_pk_fma_f16 v39, v37, v37, s59
    v_pk_mul_f16 v38, v38, v36
    v_mfma_f32_32x32x16_bf16 v[128:143], a[244:247], a[216:219], v[128:143]
    s_add_u32 s63, s61, 0x6000
    buffer_load_dwordx4 v15, s[24:27], s63 offen offset:3072 lds
    v_pk_mul_f16 v39, v39, v37
    v_exp_f16 v36, v38
    v_exp_f16 v37, v39
    v_mfma_f32_32x32x16_bf16 v[176:191], a[244:247], a[220:223], v[176:191]
    ds_read_b64_tr_b16 a[252:253], v3 offset:6144
    v_exp_f16_sdwa v36, v38 dst_sel:WORD_1 dst_unused:UNUSED_PRESERVE src0_sel:WORD_1
    v_exp_f16_sdwa v37, v39 dst_sel:WORD_1 dst_unused:UNUSED_PRESERVE src0_sel:WORD_1
    v_pk_fma_f16 v36, v36, s73, s73
    v_mfma_f32_16x16x32_bf16 v[88:91], a[244:247], v[100:103], v[88:91]
    ds_read_b64_tr_b16 a[254:255], v3 offset:9216
    v_pk_fma_f16 v37, v37, s73, s73
    v_mfma_f32_32x32x16_bf16 v[224:239], a[244:247], a[224:227], v[224:239]
    s_waitcnt lgkmcnt(3)
    ds_read_b128 a[228:231], v10 offset:25600
    v_rcp_f16 v38, v36
    v_rcp_f16 v39, v37
    v_rcp_f16_sdwa v38, v36 dst_sel:WORD_1 dst_unused:UNUSED_PRESERVE src0_sel:WORD_1
    v_mfma_f32_32x32x16_bf16 v[144:159], a[248:251], a[216:219], v[144:159]
    s_add_u32 m0, s65, 0x1000
    ds_read_b128 a[232:235], v10 offset:29696
    v_rcp_f16_sdwa v39, v37 dst_sel:WORD_1 dst_unused:UNUSED_PRESERVE src0_sel:WORD_1
    v_fma_mix_f32 v76, v76, v38, 0 op_sel:[0,0,0] op_sel_hi:[0,1,0]
    v_fma_mix_f32 v77, v77, v38, 0 op_sel:[0,1,0] op_sel_hi:[0,1,0]
    v_fma_mix_f32 v78, v78, v39, 0 op_sel:[0,0,0] op_sel_hi:[0,1,0]
    v_mfma_f32_32x32x16_bf16 v[192:207], a[248:251], a[220:223], v[192:207]
    s_add_u32 s64, s61, 0xc000
    buffer_load_dwordx4 v15, s[24:27], s64 offen lds
    v_fma_mix_f32 v79, v79, v39, 0 op_sel:[0,1,0] op_sel_hi:[0,1,0]
    v_cvt_pk_bf16_f32 v46, v76, v77
    v_cvt_pk_bf16_f32 v47, v78, v79
    v_cvt_pk_f16_f32 v32, v48, v49
    v_cvt_pk_f16_f32 v33, v50, v51
    v_mfma_f32_16x16x32_bf16 v[92:95], a[248:251], v[100:103], v[92:95]
    ds_write_b128 v9, v[44:47] offset:1024
    ds_read_b128 v[104:107], v14 offset:128
    v_mfma_f32_32x32x16_bf16 v[240:255], a[248:251], a[224:227], v[240:255]
    s_waitcnt lgkmcnt(3)
    ds_read_b128 a[236:239], v10 offset:33792
    v_pk_fma_f16 v34, v32, v32, s59
    v_pk_fma_f16 v35, v33, v33, s59
    v_pk_mul_f16 v34, v34, v32
    v_pk_mul_f16 v35, v35, v33
    v_exp_f16 v32, v34
    v_mfma_f32_32x32x16_bf16 v[112:127], a[252:255], a[228:231], v[112:127]
    s_waitcnt lgkmcnt(3)
    ds_read_b64_tr_b16 a[240:241], v3 offset:6272
    v_exp_f16 v33, v35
    v_exp_f16_sdwa v32, v34 dst_sel:WORD_1 dst_unused:UNUSED_PRESERVE src0_sel:WORD_1
    v_exp_f16_sdwa v33, v35 dst_sel:WORD_1 dst_unused:UNUSED_PRESERVE src0_sel:WORD_1
    v_mfma_f32_32x32x16_bf16 v[160:175], a[252:255], a[232:235], v[160:175]
    s_waitcnt lgkmcnt(2)
    ds_read_b64_tr_b16 a[242:243], v3 offset:9344
    v_pk_fma_f16 v32, v32, s73, s73
    v_pk_fma_f16 v33, v33, s73, s73
    v_rcp_f16 v34, v32
    v_rcp_f16 v35, v33
    v_mfma_f32_16x16x32_bf16 v[84:87], a[252:255], v[104:107], v[84:87]
    s_waitcnt lgkmcnt(2)
    s_add_u32 s68, s61, 0xc800
    buffer_load_dwordx4 v15, s[24:27], s68 offen offset:1024 lds
    v_mfma_f32_32x32x16_bf16 v[208:223], a[252:255], a[236:239], v[208:223]
    s_add_u32 s61, s61, 0x80
    ds_read_b64_tr_b16 a[244:245], v3 offset:6400
    v_rcp_f16_sdwa v34, v32 dst_sel:WORD_1 dst_unused:UNUSED_PRESERVE src0_sel:WORD_1
    v_rcp_f16_sdwa v35, v33 dst_sel:WORD_1 dst_unused:UNUSED_PRESERVE src0_sel:WORD_1
    v_fma_mix_f32 v48, v48, v34, 0 op_sel:[0,0,0] op_sel_hi:[0,1,0]
    v_mfma_f32_32x32x16_bf16 v[64:79], a[144:147], a[96:99], 0
    ds_read_b64_tr_b16 a[246:247], v3 offset:9472
    v_fma_mix_f32 v49, v49, v34, 0 op_sel:[0,1,0] op_sel_hi:[0,1,0]
    v_fma_mix_f32 v50, v50, v35, 0 op_sel:[0,0,0] op_sel_hi:[0,1,0]
    v_fma_mix_f32 v51, v51, v35, 0 op_sel:[0,1,0] op_sel_hi:[0,1,0]
    v_cvt_pk_bf16_f32 v40, v48, v49
    v_cvt_pk_bf16_f32 v41, v50, v51
    v_mfma_f32_32x32x16_bf16 v[64:79], a[148:151], a[100:103], v[64:79]
    ds_read_b64_tr_b16 a[248:249], v4
    v_cvt_pk_f16_f32 v36, v52, v53
    v_cvt_pk_f16_f32 v37, v54, v55
    v_pk_fma_f16 v38, v36, v36, s59
    v_pk_fma_f16 v39, v37, v37, s59
    v_pk_mul_f16 v38, v38, v36
    v_mfma_f32_32x32x16_bf16 v[64:79], a[152:155], a[104:107], v[64:79]
    s_add_u32 m0, s66, 0x6000
    ds_read_b64_tr_b16 a[250:251], v4 offset:3072
    v_pk_mul_f16 v39, v39, v37
    v_exp_f16 v36, v38
    v_exp_f16 v37, v39
    v_mfma_f32_32x32x16_bf16 v[64:79], a[156:159], a[108:111], v[64:79]
    buffer_load_dwordx4 v16, s[28:31], s62 offen lds
    v_exp_f16_sdwa v36, v38 dst_sel:WORD_1 dst_unused:UNUSED_PRESERVE src0_sel:WORD_1
    v_exp_f16_sdwa v37, v39 dst_sel:WORD_1 dst_unused:UNUSED_PRESERVE src0_sel:WORD_1
    v_mfma_f32_32x32x16_bf16 v[64:79], a[160:163], a[112:115], v[64:79]
    ds_read_b128 a[216:219], v10 offset:26624
    v_pk_fma_f16 v36, v36, s73, s73
    v_pk_fma_f16 v37, v37, s73, s73
    v_rcp_f16 v38, v36
    v_rcp_f16 v39, v37
    v_mfma_f32_32x32x16_bf16 v[64:79], a[164:167], a[116:119], v[64:79]
    ds_read_b128 a[220:223], v10 offset:30720
    v_rcp_f16_sdwa v38, v36 dst_sel:WORD_1 dst_unused:UNUSED_PRESERVE src0_sel:WORD_1
    v_rcp_f16_sdwa v39, v37 dst_sel:WORD_1 dst_unused:UNUSED_PRESERVE src0_sel:WORD_1
    v_fma_mix_f32 v52, v52, v38, 0 op_sel:[0,0,0] op_sel_hi:[0,1,0]
    v_mfma_f32_32x32x16_bf16 v[64:79], a[168:171], a[120:123], v[64:79]
    ds_read_b128 a[224:227], v10 offset:34816
    v_fma_mix_f32 v53, v53, v38, 0 op_sel:[0,1,0] op_sel_hi:[0,1,0]
    v_fma_mix_f32 v54, v54, v39, 0 op_sel:[0,0,0] op_sel_hi:[0,1,0]
    v_fma_mix_f32 v55, v55, v39, 0 op_sel:[0,1,0] op_sel_hi:[0,1,0]
    v_cvt_pk_bf16_f32 v42, v52, v53
    v_cvt_pk_bf16_f32 v43, v54, v55
    v_mfma_f32_32x32x16_bf16 v[64:79], a[172:175], a[124:127], v[64:79]
    ds_write_b128 v9, v[40:43] offset:4096
    v_cvt_pk_f16_f32 v32, v56, v57
    v_mfma_f32_32x32x16_bf16 v[64:79], a[176:179], a[128:131], v[64:79]
    buffer_load_dwordx4 v17, s[28:31], s62 offen offset:1024 lds
    v_cvt_pk_f16_f32 v33, v58, v59
    v_pk_fma_f16 v34, v32, v32, s59
    v_pk_fma_f16 v35, v33, v33, s59
    v_pk_mul_f16 v34, v34, v32
    v_mfma_f32_32x32x16_bf16 v[64:79], a[180:183], a[132:135], v[64:79]
    ds_read_b64_tr_b16 a[252:253], v4 offset:128
    v_pk_mul_f16 v35, v35, v33
    v_exp_f16 v32, v34
    v_exp_f16 v33, v35
    v_mfma_f32_32x32x16_bf16 v[64:79], a[184:187], a[136:139], v[64:79]
    ds_read_b64_tr_b16 a[254:255], v4 offset:3200
    v_exp_f16_sdwa v32, v34 dst_sel:WORD_1 dst_unused:UNUSED_PRESERVE src0_sel:WORD_1
    v_exp_f16_sdwa v33, v35 dst_sel:WORD_1 dst_unused:UNUSED_PRESERVE src0_sel:WORD_1
    v_pk_fma_f16 v32, v32, s73, s73
    v_mfma_f32_32x32x16_bf16 v[64:79], a[188:191], a[140:143], v[64:79]
    s_waitcnt lgkmcnt(10)
    ds_read_b64_tr_b16 a[144:145], v1 offset:24576
    v_pk_fma_f16 v33, v33, s73, s73
    v_rcp_f16 v34, v32
    v_rcp_f16 v35, v33
    v_mfma_f32_32x32x16_bf16 v[128:143], a[240:243], a[228:231], v[128:143]
    ds_read_b64_tr_b16 a[146:147], v1 offset:26624
    v_rcp_f16_sdwa v34, v32 dst_sel:WORD_1 dst_unused:UNUSED_PRESERVE src0_sel:WORD_1
    v_rcp_f16_sdwa v35, v33 dst_sel:WORD_1 dst_unused:UNUSED_PRESERVE src0_sel:WORD_1
    v_fma_mix_f32 v56, v56, v34, 0 op_sel:[0,0,0] op_sel_hi:[0,1,0]
    v_fma_mix_f32 v57, v57, v34, 0 op_sel:[0,1,0] op_sel_hi:[0,1,0]
    v_mfma_f32_32x32x16_bf16 v[176:191], a[240:243], a[232:235], v[176:191]
    buffer_load_dwordx4 v18, s[28:31], s62 offen offset:2048 lds
    v_fma_mix_f32 v58, v58, v35, 0 op_sel:[0,0,0] op_sel_hi:[0,1,0]
    v_fma_mix_f32 v59, v59, v35, 0 op_sel:[0,1,0] op_sel_hi:[0,1,0]
    v_cvt_pk_bf16_f32 v44, v56, v57
    v_cvt_pk_bf16_f32 v45, v58, v59
    v_mfma_f32_16x16x32_bf16 v[88:91], a[240:243], v[104:107], v[88:91]
    ds_read_b64_tr_b16 a[148:149], v1 offset:25600
    v_cvt_pk_f16_f32 v36, v60, v61
    v_mfma_f32_32x32x16_bf16 v[224:239], a[240:243], a[236:239], v[224:239]
    s_waitcnt lgkmcnt(11)
    ds_read_b64_tr_b16 a[150:151], v1 offset:27648
    v_cvt_pk_f16_f32 v37, v62, v63
    v_pk_fma_f16 v38, v36, v36, s59
    v_pk_fma_f16 v39, v37, v37, s59
    v_pk_mul_f16 v38, v38, v36
    v_pk_mul_f16 v39, v39, v37
    v_mfma_f32_32x32x16_bf16 v[144:159], a[244:247], a[228:231], v[144:159]
    ds_read_b64_tr_b16 a[152:153], v1 offset:28672
    v_exp_f16 v36, v38
    v_exp_f16 v37, v39
    v_exp_f16_sdwa v36, v38 dst_sel:WORD_1 dst_unused:UNUSED_PRESERVE src0_sel:WORD_1
    v_mfma_f32_32x32x16_bf16 v[192:207], a[244:247], a[232:235], v[192:207]
    ds_read_b64_tr_b16 a[154:155], v1 offset:30720
    v_exp_f16_sdwa v37, v39 dst_sel:WORD_1 dst_unused:UNUSED_PRESERVE src0_sel:WORD_1
    v_pk_fma_f16 v36, v36, s73, s73
    v_pk_fma_f16 v37, v37, s73, s73
    v_rcp_f16 v38, v36
    v_mfma_f32_16x16x32_bf16 v[92:95], a[244:247], v[104:107], v[92:95]
    buffer_load_dwordx4 v16, s[28:31], s62 offen offset:3072 lds
    v_mfma_f32_32x32x16_bf16 v[240:255], a[244:247], a[236:239], v[240:255]
    s_waitcnt lgkmcnt(11)
    ds_read_b64_tr_b16 a[156:157], v1 offset:29696
    v_rcp_f16 v39, v37
    v_rcp_f16_sdwa v38, v36 dst_sel:WORD_1 dst_unused:UNUSED_PRESERVE src0_sel:WORD_1
    v_rcp_f16_sdwa v39, v37 dst_sel:WORD_1 dst_unused:UNUSED_PRESERVE src0_sel:WORD_1
    v_mfma_f32_32x32x16_bf16 v[112:127], a[248:251], a[216:219], v[112:127]
    s_waitcnt lgkmcnt(11)
    ds_read_b64_tr_b16 a[158:159], v1 offset:31744
    v_fma_mix_f32 v60, v60, v38, 0 op_sel:[0,0,0] op_sel_hi:[0,1,0]
    v_fma_mix_f32 v61, v61, v38, 0 op_sel:[0,1,0] op_sel_hi:[0,1,0]
    v_fma_mix_f32 v62, v62, v39, 0 op_sel:[0,0,0] op_sel_hi:[0,1,0]
    v_fma_mix_f32 v63, v63, v39, 0 op_sel:[0,1,0] op_sel_hi:[0,1,0]
    v_cvt_pk_bf16_f32 v46, v60, v61
    v_mfma_f32_32x32x16_bf16 v[160:175], a[248:251], a[220:223], v[160:175]
    s_waitcnt lgkmcnt(11)
    ds_read_b64_tr_b16 a[160:161], v1 offset:32768
    v_cvt_pk_bf16_f32 v47, v62, v63
    v_cvt_pk_f16_f32 v32, v64, v65
    v_cvt_pk_f16_f32 v33, v66, v67
    v_pk_fma_f16 v34, v32, v32, s59
    v_pk_fma_f16 v35, v33, v33, s59
    v_pk_mul_f16 v34, v34, v32
    v_mfma_f32_32x32x16_bf16 v[208:223], a[248:251], a[224:227], v[208:223]
    s_waitcnt lgkmcnt(9)
    s_add_u32 m0, s66, 0x7000
    ds_write_b128 v9, v[44:47] offset:5120
    v_pk_mul_f16 v35, v35, v33
    v_mfma_f32_32x32x16_bf16 v[128:143], a[252:255], a[216:219], v[128:143]
    s_add_u32 s62, s62, 0x1000
    buffer_load_dwordx4 v17, s[28:31], s62 offen lds
    v_exp_f16 v32, v34
    v_exp_f16 v33, v35
    v_mfma_f32_32x32x16_bf16 v[176:191], a[252:255], a[220:223], v[176:191]
    ds_read_b64_tr_b16 a[162:163], v1 offset:34816
    v_exp_f16_sdwa v32, v34 dst_sel:WORD_1 dst_unused:UNUSED_PRESERVE src0_sel:WORD_1
    v_exp_f16_sdwa v33, v35 dst_sel:WORD_1 dst_unused:UNUSED_PRESERVE src0_sel:WORD_1
    v_pk_fma_f16 v32, v32, s73, s73
    v_pk_fma_f16 v33, v33, s73, s73
    v_mfma_f32_32x32x16_bf16 v[224:239], a[252:255], a[224:227], v[224:239]
    s_waitcnt lgkmcnt(9)
    ds_read_b64_tr_b16 a[164:165], v1 offset:33792
    v_rcp_f16 v34, v32
    v_rcp_f16 v35, v33
    v_rcp_f16_sdwa v34, v32 dst_sel:WORD_1 dst_unused:UNUSED_PRESERVE src0_sel:WORD_1
    v_mfma_f32_32x32x16_bf16 v[48:63], a[144:147], a[0:3], 0
    s_waitcnt lgkmcnt(8)
    ds_read_b64_tr_b16 a[166:167], v1 offset:35840
    v_rcp_f16_sdwa v35, v33 dst_sel:WORD_1 dst_unused:UNUSED_PRESERVE src0_sel:WORD_1
    v_fma_mix_f32 v64, v64, v34, 0 op_sel:[0,0,0] op_sel_hi:[0,1,0]
    v_fma_mix_f32 v65, v65, v34, 0 op_sel:[0,1,0] op_sel_hi:[0,1,0]
    v_fma_mix_f32 v66, v66, v35, 0 op_sel:[0,0,0] op_sel_hi:[0,1,0]
    v_mfma_f32_32x32x16_bf16 v[48:63], a[148:151], a[4:7], v[48:63]
    ds_read_b64_tr_b16 a[168:169], v2 offset:36864
    v_fma_mix_f32 v67, v67, v35, 0 op_sel:[0,1,0] op_sel_hi:[0,1,0]
    v_cvt_pk_bf16_f32 v40, v64, v65
    v_cvt_pk_bf16_f32 v41, v66, v67
    v_cvt_pk_f16_f32 v36, v68, v69
    v_cvt_pk_f16_f32 v37, v70, v71
    v_pk_fma_f16 v38, v36, v36, s59
    v_mfma_f32_16x16x32_bf16 v[80:83], a[144:147], a[192:195], 0
    s_waitcnt lgkmcnt(8)
    buffer_load_dwordx4 v18, s[28:31], s62 offen offset:1024 lds
    v_mfma_f32_32x32x16_bf16 v[48:63], a[152:155], a[8:11], v[48:63]
    s_waitcnt lgkmcnt(6)
    s_add_u32 s62, s62, 0x5000
    ds_read_b64_tr_b16 a[170:171], v2 offset:38912
    v_pk_fma_f16 v39, v37, v37, s59
    v_pk_mul_f16 v38, v38, v36
    v_pk_mul_f16 v39, v39, v37
    v_exp_f16 v36, v38
    v_mfma_f32_32x32x16_bf16 v[48:63], a[156:159], a[12:15], v[48:63]
    ds_read_b64_tr_b16 a[172:173], v2 offset:37888
    v_exp_f16 v37, v39
    v_exp_f16_sdwa v36, v38 dst_sel:WORD_1 dst_unused:UNUSED_PRESERVE src0_sel:WORD_1
    v_exp_f16_sdwa v37, v39 dst_sel:WORD_1 dst_unused:UNUSED_PRESERVE src0_sel:WORD_1
    v_mfma_f32_16x16x32_bf16 v[80:83], a[148:151], a[196:199], v[80:83]
    s_waitcnt lgkmcnt(5)
    ds_read_b64_tr_b16 a[174:175], v2 offset:39936
    v_pk_fma_f16 v36, v36, s73, s73
    v_mfma_f32_32x32x16_bf16 v[48:63], a[160:163], a[16:19], v[48:63]
    s_waitcnt lgkmcnt(4)
    ds_read_b64_tr_b16 a[176:177], v2 offset:40960
    ds_read_b64_tr_b16 a[178:179], v2 offset:43008
    v_pk_fma_f16 v37, v37, s73, s73
    v_rcp_f16 v38, v36
    v_rcp_f16 v39, v37
    v_mfma_f32_32x32x16_bf16 v[48:63], a[164:167], a[20:23], v[48:63]
    ds_read_b64_tr_b16 a[180:181], v2 offset:41984
    v_rcp_f16_sdwa v38, v36 dst_sel:WORD_1 dst_unused:UNUSED_PRESERVE src0_sel:WORD_1
    v_rcp_f16_sdwa v39, v37 dst_sel:WORD_1 dst_unused:UNUSED_PRESERVE src0_sel:WORD_1
    v_fma_mix_f32 v68, v68, v38, 0 op_sel:[0,0,0] op_sel_hi:[0,1,0]
    v_mfma_f32_16x16x32_bf16 v[80:83], a[152:155], a[200:203], v[80:83]
    s_waitcnt lgkmcnt(5)
    ds_read_b64_tr_b16 a[182:183], v2 offset:44032
    v_fma_mix_f32 v69, v69, v38, 0 op_sel:[0,1,0] op_sel_hi:[0,1,0]
    v_mfma_f32_32x32x16_bf16 v[48:63], a[168:171], a[24:27], v[48:63]
    s_waitcnt lgkmcnt(4)
    ds_read_b64_tr_b16 a[184:185], v2 offset:45056
    v_fma_mix_f32 v70, v70, v39, 0 op_sel:[0,0,0] op_sel_hi:[0,1,0]
    v_fma_mix_f32 v71, v71, v39, 0 op_sel:[0,1,0] op_sel_hi:[0,1,0]
    v_cvt_pk_bf16_f32 v42, v68, v69
    v_cvt_pk_bf16_f32 v43, v70, v71
    v_cvt_pk_f16_f32 v32, v72, v73
    v_cvt_pk_f16_f32 v33, v74, v75
    v_mfma_f32_32x32x16_bf16 v[48:63], a[172:175], a[28:31], v[48:63]
    ds_write_b128 v9, v[40:43] offset:8192
    ds_read_b64_tr_b16 a[186:187], v2 offset:47104
    v_mfma_f32_16x16x32_bf16 v[80:83], a[156:159], a[204:207], v[80:83]
    s_waitcnt lgkmcnt(5)
    ds_read_b64_tr_b16 a[188:189], v2 offset:46080
    v_pk_fma_f16 v34, v32, v32, s59
    v_mfma_f32_32x32x16_bf16 v[48:63], a[176:179], a[32:35], v[48:63]
    s_waitcnt lgkmcnt(4)
    ds_read_b64_tr_b16 a[190:191], v2 offset:48128
    v_pk_fma_f16 v35, v33, v33, s59
    v_pk_mul_f16 v34, v34, v32
    v_pk_mul_f16 v35, v35, v33
    v_exp_f16 v32, v34
    v_mfma_f32_32x32x16_bf16 v[48:63], a[180:183], a[36:39], v[48:63]
    ds_read_b64_tr_b16 a[240:241], v4 offset:256
    v_exp_f16 v33, v35
    v_exp_f16_sdwa v32, v34 dst_sel:WORD_1 dst_unused:UNUSED_PRESERVE src0_sel:WORD_1
    v_exp_f16_sdwa v33, v35 dst_sel:WORD_1 dst_unused:UNUSED_PRESERVE src0_sel:WORD_1
    v_mfma_f32_16x16x32_bf16 v[80:83], a[160:163], a[208:211], v[80:83]
    s_waitcnt lgkmcnt(3)
    ds_read_b64_tr_b16 a[242:243], v4 offset:3328
    ds_read_b64_tr_b16 a[244:245], v4 offset:6144
    v_mfma_f32_32x32x16_bf16 v[48:63], a[184:187], a[40:43], v[48:63]
    s_waitcnt lgkmcnt(3)
    ds_read_b64_tr_b16 a[246:247], v4 offset:9216
    v_pk_fma_f16 v32, v32, s73, s73
    v_pk_fma_f16 v33, v33, s73, s73
    v_rcp_f16 v34, v32
    v_rcp_f16 v35, v33
    v_mfma_f32_32x32x16_bf16 v[48:63], a[188:191], a[44:47], v[48:63]
    ds_read_b128 a[228:231], v10 offset:27648
    v_rcp_f16_sdwa v34, v32 dst_sel:WORD_1 dst_unused:UNUSED_PRESERVE src0_sel:WORD_1
    v_rcp_f16_sdwa v35, v33 dst_sel:WORD_1 dst_unused:UNUSED_PRESERVE src0_sel:WORD_1
    v_fma_mix_f32 v72, v72, v34, 0 op_sel:[0,0,0] op_sel_hi:[0,1,0]
    v_fma_mix_f32 v73, v73, v34, 0 op_sel:[0,1,0] op_sel_hi:[0,1,0]
    v_mfma_f32_16x16x32_bf16 v[80:83], a[164:167], a[212:215], v[80:83]
    s_waitcnt lgkmcnt(3)
    ds_read_b128 a[232:235], v10 offset:31744
    v_fma_mix_f32 v74, v74, v35, 0 op_sel:[0,0,0] op_sel_hi:[0,1,0]
    v_mfma_f32_32x32x16_bf16 v[144:159], a[240:243], a[216:219], v[144:159]
    ds_read_b128 a[236:239], v10 offset:35840
    v_fma_mix_f32 v75, v75, v35, 0 op_sel:[0,1,0] op_sel_hi:[0,1,0]
    v_cvt_pk_bf16_f32 v44, v72, v73
    v_cvt_pk_bf16_f32 v45, v74, v75
    v_cvt_pk_f16_f32 v36, v76, v77
    v_cvt_pk_f16_f32 v37, v78, v79
    v_pk_fma_f16 v38, v36, v36, s59
    v_mfma_f32_32x32x16_bf16 v[192:207], a[240:243], a[220:223], v[192:207]
    ds_read_b64_tr_b16 a[248:249], v4 offset:6272
    v_pk_fma_f16 v39, v37, v37, s59
    v_pk_mul_f16 v38, v38, v36
    v_pk_mul_f16 v39, v39, v37
    v_exp_f16 v36, v38
    v_mfma_f32_32x32x16_bf16 v[240:255], a[240:243], a[224:227], v[240:255]
    s_waitcnt lgkmcnt(3)
    ds_write_b128 v11, v[80:83] offset:49152
    ds_read_b64_tr_b16 a[250:251], v4 offset:9344
    v_mfma_f32_32x32x16_bf16 v[112:127], a[244:247], a[228:231], v[112:127]
    s_waitcnt lgkmcnt(4)
    v_exp_f16 v37, v39
    v_exp_f16_sdwa v36, v38 dst_sel:WORD_1 dst_unused:UNUSED_PRESERVE src0_sel:WORD_1
    v_exp_f16_sdwa v37, v39 dst_sel:WORD_1 dst_unused:UNUSED_PRESERVE src0_sel:WORD_1
    v_pk_fma_f16 v36, v36, s73, s73
    v_mfma_f32_32x32x16_bf16 v[160:175], a[244:247], a[232:235], v[160:175]
    s_waitcnt lgkmcnt(3)
    ds_read_b64_tr_b16 a[252:253], v4 offset:6400
    v_pk_fma_f16 v37, v37, s73, s73
    v_rcp_f16 v38, v36
    v_rcp_f16 v39, v37
    v_mfma_f32_32x32x16_bf16 v[208:223], a[244:247], a[236:239], v[208:223]
    s_waitcnt lgkmcnt(1)
    ds_read_b64_tr_b16 a[254:255], v4 offset:9472
    v_rcp_f16_sdwa v38, v36 dst_sel:WORD_1 dst_unused:UNUSED_PRESERVE src0_sel:WORD_1
    v_rcp_f16_sdwa v39, v37 dst_sel:WORD_1 dst_unused:UNUSED_PRESERVE src0_sel:WORD_1
    v_fma_mix_f32 v76, v76, v38, 0 op_sel:[0,0,0] op_sel_hi:[0,1,0]
    v_fma_mix_f32 v77, v77, v38, 0 op_sel:[0,1,0] op_sel_hi:[0,1,0]
    v_mfma_f32_32x32x16_bf16 v[128:143], a[248:251], a[228:231], v[128:143]
    v_fma_mix_f32 v78, v78, v39, 0 op_sel:[0,0,0] op_sel_hi:[0,1,0]
    v_fma_mix_f32 v79, v79, v39, 0 op_sel:[0,1,0] op_sel_hi:[0,1,0]
    v_cvt_pk_bf16_f32 v46, v76, v77
    v_cvt_pk_bf16_f32 v47, v78, v79
    v_cvt_pk_f16_f32 v32, v48, v49
    v_cvt_pk_f16_f32 v33, v50, v51
    v_pk_fma_f16 v34, v32, v32, s59
    v_mfma_f32_32x32x16_bf16 v[176:191], a[248:251], a[232:235], v[176:191]
    ds_write_b128 v9, v[44:47] offset:9216
    v_pk_fma_f16 v35, v33, v33, s59
    v_mfma_f32_32x32x16_bf16 v[224:239], a[248:251], a[236:239], v[224:239]
    s_waitcnt lgkmcnt(1)
    v_pk_mul_f16 v34, v34, v32
    v_pk_mul_f16 v35, v35, v33
    v_exp_f16 v32, v34
    v_exp_f16 v33, v35
    v_mfma_f32_32x32x16_bf16 v[144:159], a[252:255], a[228:231], v[144:159]
    v_exp_f16_sdwa v32, v34 dst_sel:WORD_1 dst_unused:UNUSED_PRESERVE src0_sel:WORD_1
    v_exp_f16_sdwa v33, v35 dst_sel:WORD_1 dst_unused:UNUSED_PRESERVE src0_sel:WORD_1
    v_pk_fma_f16 v32, v32, s73, s73
    v_pk_fma_f16 v33, v33, s73, s73
    v_mfma_f32_32x32x16_bf16 v[192:207], a[252:255], a[232:235], v[192:207]
    v_rcp_f16 v34, v32
    v_rcp_f16 v35, v33
    v_rcp_f16_sdwa v34, v32 dst_sel:WORD_1 dst_unused:UNUSED_PRESERVE src0_sel:WORD_1
    v_rcp_f16_sdwa v35, v33 dst_sel:WORD_1 dst_unused:UNUSED_PRESERVE src0_sel:WORD_1
    v_mfma_f32_32x32x16_bf16 v[240:255], a[252:255], a[236:239], v[240:255]
    v_fma_mix_f32 v48, v48, v34, 0 op_sel:[0,0,0] op_sel_hi:[0,1,0]
    v_fma_mix_f32 v49, v49, v34, 0 op_sel:[0,1,0] op_sel_hi:[0,1,0]
    v_fma_mix_f32 v50, v50, v35, 0 op_sel:[0,0,0] op_sel_hi:[0,1,0]
    v_fma_mix_f32 v51, v51, v35, 0 op_sel:[0,1,0] op_sel_hi:[0,1,0]
    v_cvt_pk_bf16_f32 v40, v48, v49
    v_cvt_pk_bf16_f32 v41, v50, v51
    s_waitcnt vmcnt(0) lgkmcnt(0)
    s_barrier
    v_mfma_f32_32x32x16_bf16 v[64:79], a[144:147], a[48:51], 0
    s_add_u32 m0, s65, 0x6000
    ds_read2st64_b32 v[96:97], v12 offset0:0 offset1:4
    v_cvt_pk_f16_f32 v36, v52, v53
    v_cvt_pk_f16_f32 v37, v54, v55
    v_pk_fma_f16 v38, v36, v36, s59
    v_pk_fma_f16 v39, v37, v37, s59
    v_pk_mul_f16 v38, v38, v36
    v_mfma_f32_32x32x16_bf16 v[64:79], a[148:151], a[52:55], v[64:79]
    s_add_u32 s63, s61, 0
    buffer_load_dwordx4 v15, s[24:27], s63 offen lds
    v_pk_mul_f16 v39, v39, v37
    v_exp_f16 v36, v38
    v_exp_f16 v37, v39
    v_mfma_f32_32x32x16_bf16 v[64:79], a[152:155], a[56:59], v[64:79]
    ds_read_b64_tr_b16 a[240:241], v3 offset:24576
    v_exp_f16_sdwa v36, v38 dst_sel:WORD_1 dst_unused:UNUSED_PRESERVE src0_sel:WORD_1
    v_exp_f16_sdwa v37, v39 dst_sel:WORD_1 dst_unused:UNUSED_PRESERVE src0_sel:WORD_1
    v_pk_fma_f16 v36, v36, s73, s73
    v_mfma_f32_32x32x16_bf16 v[64:79], a[156:159], a[60:63], v[64:79]
    ds_read_b64_tr_b16 a[242:243], v3 offset:27648
    v_pk_fma_f16 v37, v37, s73, s73
    v_rcp_f16 v38, v36
    v_rcp_f16 v39, v37
    v_mfma_f32_32x32x16_bf16 v[64:79], a[160:163], a[64:67], v[64:79]
    ds_read_b128 a[216:219], v10
    v_rcp_f16_sdwa v38, v36 dst_sel:WORD_1 dst_unused:UNUSED_PRESERVE src0_sel:WORD_1
    v_rcp_f16_sdwa v39, v37 dst_sel:WORD_1 dst_unused:UNUSED_PRESERVE src0_sel:WORD_1
    v_fma_mix_f32 v52, v52, v38, 0 op_sel:[0,0,0] op_sel_hi:[0,1,0]
    v_fma_mix_f32 v53, v53, v38, 0 op_sel:[0,1,0] op_sel_hi:[0,1,0]
    v_mfma_f32_32x32x16_bf16 v[64:79], a[164:167], a[68:71], v[64:79]
    s_waitcnt lgkmcnt(3)
    ds_read_b128 a[220:223], v10 offset:4096
    v_fma_mix_f32 v54, v54, v39, 0 op_sel:[0,0,0] op_sel_hi:[0,1,0]
    v_fma_mix_f32 v55, v55, v39, 0 op_sel:[0,1,0] op_sel_hi:[0,1,0]
    v_cvt_pk_bf16_f32 v42, v52, v53
    v_cvt_pk_bf16_f32 v43, v54, v55
    v_add_f32 v96, v96, v97
    v_mfma_f32_32x32x16_bf16 v[64:79], a[168:171], a[72:75], v[64:79]
    s_add_u32 s64, s61, 0x800
    ds_write_b128 v9, v[40:43] offset:24576
    buffer_load_dwordx4 v15, s[24:27], s64 offen offset:1024 lds
    v_mfma_f32_32x32x16_bf16 v[64:79], a[172:175], a[76:79], v[64:79]
    v_cvt_pk_f16_f32 v32, v56, v57
    v_cvt_pk_f16_f32 v33, v58, v59
    v_fmaak_f32 v97, v96, v96, 0x409d2a01
    v_pk_fma_f16 v34, v32, v32, s59
    v_pk_fma_f16 v35, v33, v33, s59
    v_mul_f32 v97, v97, v96
    v_mfma_f32_32x32x16_bf16 v[64:79], a[176:179], a[80:83], v[64:79]
    ds_read_b128 v[100:103], v14 offset:512
    v_pk_mul_f16 v34, v34, v32
    v_pk_mul_f16 v35, v35, v33
    v_exp_f16 v32, v34
    v_exp_f16 v33, v35
    v_mfma_f32_32x32x16_bf16 v[64:79], a[180:183], a[84:87], v[64:79]
    ds_read_b128 a[224:227], v10 offset:8192
    v_exp_f16_sdwa v32, v34 dst_sel:WORD_1 dst_unused:UNUSED_PRESERVE src0_sel:WORD_1
    v_exp_f16_sdwa v33, v35 dst_sel:WORD_1 dst_unused:UNUSED_PRESERVE src0_sel:WORD_1
    v_exp_f32 v97, v97
    v_mfma_f32_32x32x16_bf16 v[64:79], a[184:187], a[88:91], v[64:79]
    ds_read_b64_tr_b16 a[244:245], v3 offset:24704
    v_pk_fma_f16 v32, v32, s73, s73
    v_pk_fma_f16 v33, v33, s73, s73
    v_fma_f32 v97, v97, s67, s67
    v_rcp_f16 v34, v32
    v_mfma_f32_32x32x16_bf16 v[64:79], a[188:191], a[92:95], v[64:79]
    s_waitcnt lgkmcnt(5)
    s_add_u32 s68, s61, 0x5800
    buffer_load_dwordx4 v15, s[24:27], s68 offen offset:2048 lds
    v_rcp_f16 v35, v33
    v_rcp_f16_sdwa v34, v32 dst_sel:WORD_1 dst_unused:UNUSED_PRESERVE src0_sel:WORD_1
    v_mfma_f32_32x32x16_bf16 v[112:127], a[240:243], a[216:219], v[112:127]
    s_waitcnt lgkmcnt(4)
    ds_read_b64_tr_b16 a[246:247], v3 offset:27776
    v_rcp_f16_sdwa v35, v33 dst_sel:WORD_1 dst_unused:UNUSED_PRESERVE src0_sel:WORD_1
    v_rcp_f32 v97, v97
    v_fma_mix_f32 v56, v56, v34, 0 op_sel:[0,0,0] op_sel_hi:[0,1,0]
    v_fma_mix_f32 v57, v57, v34, 0 op_sel:[0,1,0] op_sel_hi:[0,1,0]
    v_mfma_f32_32x32x16_bf16 v[160:175], a[240:243], a[220:223], v[160:175]
    s_waitcnt lgkmcnt(3)
    ds_read_b64_tr_b16 a[248:249], v3 offset:24832
    v_fma_mix_f32 v58, v58, v35, 0 op_sel:[0,0,0] op_sel_hi:[0,1,0]
    v_fma_mix_f32 v59, v59, v35, 0 op_sel:[0,1,0] op_sel_hi:[0,1,0]
    v_mul_f32 v97, v97, v96
    v_cvt_pk_bf16_f32 v44, v56, v57
    v_cvt_pk_bf16_f32 v45, v58, v59
    v_mfma_f32_16x16x32_bf16 v[84:87], a[240:243], v[100:103], v[84:87]
    s_waitcnt lgkmcnt(3)
    ds_read_b64_tr_b16 a[250:251], v3 offset:27904
    v_cvt_pk_bf16_f32 v97, v97, v97
    v_mfma_f32_32x32x16_bf16 v[208:223], a[240:243], a[224:227], v[208:223]
    s_waitcnt lgkmcnt(2)
    ds_write_b16 v13, v97
    v_cvt_pk_f16_f32 v36, v60, v61
    v_cvt_pk_f16_f32 v37, v62, v63
    v_pk_fma_f16 v38, v36, v36, s59
    v_pk_fma_f16 v39, v37, v37, s59
    v_pk_mul_f16 v38, v38, v36
    v_mfma_f32_32x32x16_bf16 v[128:143], a[244:247], a[216:219], v[128:143]
    s_add_u32 s63, s61, 0x6000
    buffer_load_dwordx4 v15, s[24:27], s63 offen offset:3072 lds
    v_pk_mul_f16 v39, v39, v37
    v_exp_f16 v36, v38
    v_exp_f16 v37, v39
    v_mfma_f32_32x32x16_bf16 v[176:191], a[244:247], a[220:223], v[176:191]
    ds_read_b64_tr_b16 a[252:253], v3 offset:30720
    v_exp_f16_sdwa v36, v38 dst_sel:WORD_1 dst_unused:UNUSED_PRESERVE src0_sel:WORD_1
    v_exp_f16_sdwa v37, v39 dst_sel:WORD_1 dst_unused:UNUSED_PRESERVE src0_sel:WORD_1
    v_pk_fma_f16 v36, v36, s73, s73
    v_mfma_f32_16x16x32_bf16 v[88:91], a[244:247], v[100:103], v[88:91]
    ds_read_b64_tr_b16 a[254:255], v3 offset:33792
    v_pk_fma_f16 v37, v37, s73, s73
    v_mfma_f32_32x32x16_bf16 v[224:239], a[244:247], a[224:227], v[224:239]
    s_waitcnt lgkmcnt(3)
    ds_read_b128 a[228:231], v10 offset:1024
    v_rcp_f16 v38, v36
    v_rcp_f16 v39, v37
    v_rcp_f16_sdwa v38, v36 dst_sel:WORD_1 dst_unused:UNUSED_PRESERVE src0_sel:WORD_1
    v_mfma_f32_32x32x16_bf16 v[144:159], a[248:251], a[216:219], v[144:159]
    s_add_u32 m0, s65, 0x7000
    ds_read_b128 a[232:235], v10 offset:5120
    v_rcp_f16_sdwa v39, v37 dst_sel:WORD_1 dst_unused:UNUSED_PRESERVE src0_sel:WORD_1
    v_fma_mix_f32 v60, v60, v38, 0 op_sel:[0,0,0] op_sel_hi:[0,1,0]
    v_fma_mix_f32 v61, v61, v38, 0 op_sel:[0,1,0] op_sel_hi:[0,1,0]
    v_fma_mix_f32 v62, v62, v39, 0 op_sel:[0,0,0] op_sel_hi:[0,1,0]
    v_mfma_f32_32x32x16_bf16 v[192:207], a[248:251], a[220:223], v[192:207]
    s_add_u32 s64, s61, 0xc000
    buffer_load_dwordx4 v15, s[24:27], s64 offen lds
    v_fma_mix_f32 v63, v63, v39, 0 op_sel:[0,1,0] op_sel_hi:[0,1,0]
    v_cvt_pk_bf16_f32 v46, v60, v61
    v_cvt_pk_bf16_f32 v47, v62, v63
    v_cvt_pk_f16_f32 v32, v64, v65
    v_cvt_pk_f16_f32 v33, v66, v67
    v_mfma_f32_16x16x32_bf16 v[92:95], a[248:251], v[100:103], v[92:95]
    ds_write_b128 v9, v[44:47] offset:25600
    ds_read_b128 v[104:107], v14 offset:640
    v_mfma_f32_32x32x16_bf16 v[240:255], a[248:251], a[224:227], v[240:255]
    s_waitcnt lgkmcnt(3)
    ds_read_b128 a[236:239], v10 offset:9216
    v_pk_fma_f16 v34, v32, v32, s59
    v_pk_fma_f16 v35, v33, v33, s59
    v_pk_mul_f16 v34, v34, v32
    v_pk_mul_f16 v35, v35, v33
    v_exp_f16 v32, v34
    v_mfma_f32_32x32x16_bf16 v[112:127], a[252:255], a[228:231], v[112:127]
    s_waitcnt lgkmcnt(3)
    ds_read_b64_tr_b16 a[240:241], v3 offset:30848
    v_exp_f16 v33, v35
    v_exp_f16_sdwa v32, v34 dst_sel:WORD_1 dst_unused:UNUSED_PRESERVE src0_sel:WORD_1
    v_exp_f16_sdwa v33, v35 dst_sel:WORD_1 dst_unused:UNUSED_PRESERVE src0_sel:WORD_1
    v_mfma_f32_32x32x16_bf16 v[160:175], a[252:255], a[232:235], v[160:175]
    s_waitcnt lgkmcnt(2)
    ds_read_b64_tr_b16 a[242:243], v3 offset:33920
    v_pk_fma_f16 v32, v32, s73, s73
    v_pk_fma_f16 v33, v33, s73, s73
    v_rcp_f16 v34, v32
    v_rcp_f16 v35, v33
    v_mfma_f32_16x16x32_bf16 v[84:87], a[252:255], v[104:107], v[84:87]
    s_waitcnt lgkmcnt(2)
    s_add_u32 s68, s61, 0xc800
    buffer_load_dwordx4 v15, s[24:27], s68 offen offset:1024 lds
    v_mfma_f32_32x32x16_bf16 v[208:223], a[252:255], a[236:239], v[208:223]
    s_add_u32 s61, s61, 0x80
    ds_read_b64_tr_b16 a[244:245], v3 offset:30976
    v_rcp_f16_sdwa v34, v32 dst_sel:WORD_1 dst_unused:UNUSED_PRESERVE src0_sel:WORD_1
    v_rcp_f16_sdwa v35, v33 dst_sel:WORD_1 dst_unused:UNUSED_PRESERVE src0_sel:WORD_1
    v_fma_mix_f32 v64, v64, v34, 0 op_sel:[0,0,0] op_sel_hi:[0,1,0]
    v_mfma_f32_32x32x16_bf16 v[48:63], a[144:147], a[96:99], 0
    ds_read_b64_tr_b16 a[246:247], v3 offset:34048
    v_fma_mix_f32 v65, v65, v34, 0 op_sel:[0,1,0] op_sel_hi:[0,1,0]
    v_fma_mix_f32 v66, v66, v35, 0 op_sel:[0,0,0] op_sel_hi:[0,1,0]
    v_fma_mix_f32 v67, v67, v35, 0 op_sel:[0,1,0] op_sel_hi:[0,1,0]
    v_cvt_pk_bf16_f32 v40, v64, v65
    v_cvt_pk_bf16_f32 v41, v66, v67
    v_mfma_f32_32x32x16_bf16 v[48:63], a[148:151], a[100:103], v[48:63]
    ds_read_b64_tr_b16 a[248:249], v4 offset:24576
    v_cvt_pk_f16_f32 v36, v68, v69
    v_cvt_pk_f16_f32 v37, v70, v71
    v_pk_fma_f16 v38, v36, v36, s59
    v_pk_fma_f16 v39, v37, v37, s59
    v_pk_mul_f16 v38, v38, v36
    v_mfma_f32_32x32x16_bf16 v[48:63], a[152:155], a[104:107], v[48:63]
    s_add_u32 m0, s66, 0
    ds_read_b64_tr_b16 a[250:251], v4 offset:27648
    v_pk_mul_f16 v39, v39, v37
    v_exp_f16 v36, v38
    v_exp_f16 v37, v39
    v_mfma_f32_32x32x16_bf16 v[48:63], a[156:159], a[108:111], v[48:63]
    buffer_load_dwordx4 v16, s[28:31], s62 offen lds
    v_exp_f16_sdwa v36, v38 dst_sel:WORD_1 dst_unused:UNUSED_PRESERVE src0_sel:WORD_1
    v_exp_f16_sdwa v37, v39 dst_sel:WORD_1 dst_unused:UNUSED_PRESERVE src0_sel:WORD_1
    v_mfma_f32_32x32x16_bf16 v[48:63], a[160:163], a[112:115], v[48:63]
    ds_read_b128 a[216:219], v10 offset:2048
    v_pk_fma_f16 v36, v36, s73, s73
    v_pk_fma_f16 v37, v37, s73, s73
    v_rcp_f16 v38, v36
    v_rcp_f16 v39, v37
    v_mfma_f32_32x32x16_bf16 v[48:63], a[164:167], a[116:119], v[48:63]
    ds_read_b128 a[220:223], v10 offset:6144
    v_rcp_f16_sdwa v38, v36 dst_sel:WORD_1 dst_unused:UNUSED_PRESERVE src0_sel:WORD_1
    v_rcp_f16_sdwa v39, v37 dst_sel:WORD_1 dst_unused:UNUSED_PRESERVE src0_sel:WORD_1
    v_fma_mix_f32 v68, v68, v38, 0 op_sel:[0,0,0] op_sel_hi:[0,1,0]
    v_mfma_f32_32x32x16_bf16 v[48:63], a[168:171], a[120:123], v[48:63]
    ds_read_b128 a[224:227], v10 offset:10240
    v_fma_mix_f32 v69, v69, v38, 0 op_sel:[0,1,0] op_sel_hi:[0,1,0]
    v_fma_mix_f32 v70, v70, v39, 0 op_sel:[0,0,0] op_sel_hi:[0,1,0]
    v_fma_mix_f32 v71, v71, v39, 0 op_sel:[0,1,0] op_sel_hi:[0,1,0]
    v_cvt_pk_bf16_f32 v42, v68, v69
    v_cvt_pk_bf16_f32 v43, v70, v71
    v_mfma_f32_32x32x16_bf16 v[48:63], a[172:175], a[124:127], v[48:63]
    ds_write_b128 v9, v[40:43] offset:28672
    v_cvt_pk_f16_f32 v32, v72, v73
    v_mfma_f32_32x32x16_bf16 v[48:63], a[176:179], a[128:131], v[48:63]
    buffer_load_dwordx4 v17, s[28:31], s62 offen offset:1024 lds
    v_cvt_pk_f16_f32 v33, v74, v75
    v_pk_fma_f16 v34, v32, v32, s59
    v_pk_fma_f16 v35, v33, v33, s59
    v_pk_mul_f16 v34, v34, v32
    v_mfma_f32_32x32x16_bf16 v[48:63], a[180:183], a[132:135], v[48:63]
    ds_read_b64_tr_b16 a[252:253], v4 offset:24704
    v_pk_mul_f16 v35, v35, v33
    v_exp_f16 v32, v34
    v_exp_f16 v33, v35
    v_mfma_f32_32x32x16_bf16 v[48:63], a[184:187], a[136:139], v[48:63]
    ds_read_b64_tr_b16 a[254:255], v4 offset:27776
    v_exp_f16_sdwa v32, v34 dst_sel:WORD_1 dst_unused:UNUSED_PRESERVE src0_sel:WORD_1
    v_exp_f16_sdwa v33, v35 dst_sel:WORD_1 dst_unused:UNUSED_PRESERVE src0_sel:WORD_1
    v_pk_fma_f16 v32, v32, s73, s73
    v_mfma_f32_32x32x16_bf16 v[48:63], a[188:191], a[140:143], v[48:63]
    s_waitcnt lgkmcnt(10)
    ds_read_b64_tr_b16 a[144:145], v1
    v_pk_fma_f16 v33, v33, s73, s73
    v_rcp_f16 v34, v32
    v_rcp_f16 v35, v33
    v_mfma_f32_32x32x16_bf16 v[128:143], a[240:243], a[228:231], v[128:143]
    ds_read_b64_tr_b16 a[146:147], v1 offset:2048
    v_rcp_f16_sdwa v34, v32 dst_sel:WORD_1 dst_unused:UNUSED_PRESERVE src0_sel:WORD_1
    v_rcp_f16_sdwa v35, v33 dst_sel:WORD_1 dst_unused:UNUSED_PRESERVE src0_sel:WORD_1
    v_fma_mix_f32 v72, v72, v34, 0 op_sel:[0,0,0] op_sel_hi:[0,1,0]
    v_fma_mix_f32 v73, v73, v34, 0 op_sel:[0,1,0] op_sel_hi:[0,1,0]
    v_mfma_f32_32x32x16_bf16 v[176:191], a[240:243], a[232:235], v[176:191]
    buffer_load_dwordx4 v18, s[28:31], s62 offen offset:2048 lds
    v_fma_mix_f32 v74, v74, v35, 0 op_sel:[0,0,0] op_sel_hi:[0,1,0]
    v_fma_mix_f32 v75, v75, v35, 0 op_sel:[0,1,0] op_sel_hi:[0,1,0]
    v_cvt_pk_bf16_f32 v44, v72, v73
    v_cvt_pk_bf16_f32 v45, v74, v75
    v_mfma_f32_16x16x32_bf16 v[88:91], a[240:243], v[104:107], v[88:91]
    ds_read_b64_tr_b16 a[148:149], v1 offset:1024
    v_cvt_pk_f16_f32 v36, v76, v77
    v_mfma_f32_32x32x16_bf16 v[224:239], a[240:243], a[236:239], v[224:239]
    s_waitcnt lgkmcnt(11)
    ds_read_b64_tr_b16 a[150:151], v1 offset:3072
    v_cvt_pk_f16_f32 v37, v78, v79
    v_pk_fma_f16 v38, v36, v36, s59
    v_pk_fma_f16 v39, v37, v37, s59
    v_pk_mul_f16 v38, v38, v36
    v_pk_mul_f16 v39, v39, v37
    v_mfma_f32_32x32x16_bf16 v[144:159], a[244:247], a[228:231], v[144:159]
    ds_read_b64_tr_b16 a[152:153], v1 offset:4096
    v_exp_f16 v36, v38
    v_exp_f16 v37, v39
    v_exp_f16_sdwa v36, v38 dst_sel:WORD_1 dst_unused:UNUSED_PRESERVE src0_sel:WORD_1
    v_mfma_f32_32x32x16_bf16 v[192:207], a[244:247], a[232:235], v[192:207]
    ds_read_b64_tr_b16 a[154:155], v1 offset:6144
    v_exp_f16_sdwa v37, v39 dst_sel:WORD_1 dst_unused:UNUSED_PRESERVE src0_sel:WORD_1
    v_pk_fma_f16 v36, v36, s73, s73
    v_pk_fma_f16 v37, v37, s73, s73
    v_rcp_f16 v38, v36
    v_mfma_f32_16x16x32_bf16 v[92:95], a[244:247], v[104:107], v[92:95]
    buffer_load_dwordx4 v16, s[28:31], s62 offen offset:3072 lds
    v_mfma_f32_32x32x16_bf16 v[240:255], a[244:247], a[236:239], v[240:255]
    s_waitcnt lgkmcnt(11)
    ds_read_b64_tr_b16 a[156:157], v1 offset:5120
    v_rcp_f16 v39, v37
    v_rcp_f16_sdwa v38, v36 dst_sel:WORD_1 dst_unused:UNUSED_PRESERVE src0_sel:WORD_1
    v_rcp_f16_sdwa v39, v37 dst_sel:WORD_1 dst_unused:UNUSED_PRESERVE src0_sel:WORD_1
    v_mfma_f32_32x32x16_bf16 v[112:127], a[248:251], a[216:219], v[112:127]
    s_waitcnt lgkmcnt(11)
    ds_read_b64_tr_b16 a[158:159], v1 offset:7168
    v_fma_mix_f32 v76, v76, v38, 0 op_sel:[0,0,0] op_sel_hi:[0,1,0]
    v_fma_mix_f32 v77, v77, v38, 0 op_sel:[0,1,0] op_sel_hi:[0,1,0]
    v_fma_mix_f32 v78, v78, v39, 0 op_sel:[0,0,0] op_sel_hi:[0,1,0]
    v_fma_mix_f32 v79, v79, v39, 0 op_sel:[0,1,0] op_sel_hi:[0,1,0]
    v_cvt_pk_bf16_f32 v46, v76, v77
    v_mfma_f32_32x32x16_bf16 v[160:175], a[248:251], a[220:223], v[160:175]
    s_waitcnt lgkmcnt(11)
    ds_read_b64_tr_b16 a[160:161], v1 offset:8192
    v_cvt_pk_bf16_f32 v47, v78, v79
    v_cvt_pk_f16_f32 v32, v48, v49
    v_cvt_pk_f16_f32 v33, v50, v51
    v_pk_fma_f16 v34, v32, v32, s59
    v_pk_fma_f16 v35, v33, v33, s59
    v_pk_mul_f16 v34, v34, v32
    v_mfma_f32_32x32x16_bf16 v[208:223], a[248:251], a[224:227], v[208:223]
    s_waitcnt lgkmcnt(9)
    s_add_u32 m0, s66, 0x1000
    ds_write_b128 v9, v[44:47] offset:29696
    v_pk_mul_f16 v35, v35, v33
    v_mfma_f32_32x32x16_bf16 v[128:143], a[252:255], a[216:219], v[128:143]
    s_add_u32 s62, s62, 0x1000
    buffer_load_dwordx4 v17, s[28:31], s62 offen lds
    v_exp_f16 v32, v34
    v_exp_f16 v33, v35
    v_mfma_f32_32x32x16_bf16 v[176:191], a[252:255], a[220:223], v[176:191]
    ds_read_b64_tr_b16 a[162:163], v1 offset:10240
    v_exp_f16_sdwa v32, v34 dst_sel:WORD_1 dst_unused:UNUSED_PRESERVE src0_sel:WORD_1
    v_exp_f16_sdwa v33, v35 dst_sel:WORD_1 dst_unused:UNUSED_PRESERVE src0_sel:WORD_1
    v_pk_fma_f16 v32, v32, s73, s73
    v_pk_fma_f16 v33, v33, s73, s73
    v_mfma_f32_32x32x16_bf16 v[224:239], a[252:255], a[224:227], v[224:239]
    s_waitcnt lgkmcnt(9)
    ds_read_b64_tr_b16 a[164:165], v1 offset:9216
    v_rcp_f16 v34, v32
    v_rcp_f16 v35, v33
    v_rcp_f16_sdwa v34, v32 dst_sel:WORD_1 dst_unused:UNUSED_PRESERVE src0_sel:WORD_1
    v_mfma_f32_32x32x16_bf16 v[64:79], a[144:147], a[0:3], 0
    s_waitcnt lgkmcnt(8)
    ds_read_b64_tr_b16 a[166:167], v1 offset:11264
    v_rcp_f16_sdwa v35, v33 dst_sel:WORD_1 dst_unused:UNUSED_PRESERVE src0_sel:WORD_1
    v_fma_mix_f32 v48, v48, v34, 0 op_sel:[0,0,0] op_sel_hi:[0,1,0]
    v_fma_mix_f32 v49, v49, v34, 0 op_sel:[0,1,0] op_sel_hi:[0,1,0]
    v_fma_mix_f32 v50, v50, v35, 0 op_sel:[0,0,0] op_sel_hi:[0,1,0]
    v_mfma_f32_32x32x16_bf16 v[64:79], a[148:151], a[4:7], v[64:79]
    ds_read_b64_tr_b16 a[168:169], v2 offset:12288
    v_fma_mix_f32 v51, v51, v35, 0 op_sel:[0,1,0] op_sel_hi:[0,1,0]
    v_cvt_pk_bf16_f32 v40, v48, v49
    v_cvt_pk_bf16_f32 v41, v50, v51
    v_cvt_pk_f16_f32 v36, v52, v53
    v_cvt_pk_f16_f32 v37, v54, v55
    v_pk_fma_f16 v38, v36, v36, s59
    v_mfma_f32_16x16x32_bf16 v[80:83], a[144:147], a[192:195], 0
    s_waitcnt lgkmcnt(8)
    buffer_load_dwordx4 v18, s[28:31], s62 offen offset:1024 lds
    v_mfma_f32_32x32x16_bf16 v[64:79], a[152:155], a[8:11], v[64:79]
    s_waitcnt lgkmcnt(6)
    s_add_u32 s62, s62, 0x5000
    ds_read_b64_tr_b16 a[170:171], v2 offset:14336
    v_pk_fma_f16 v39, v37, v37, s59
    v_pk_mul_f16 v38, v38, v36
    v_pk_mul_f16 v39, v39, v37
    v_exp_f16 v36, v38
    v_mfma_f32_32x32x16_bf16 v[64:79], a[156:159], a[12:15], v[64:79]
    ds_read_b64_tr_b16 a[172:173], v2 offset:13312
    v_exp_f16 v37, v39
    v_exp_f16_sdwa v36, v38 dst_sel:WORD_1 dst_unused:UNUSED_PRESERVE src0_sel:WORD_1
    v_exp_f16_sdwa v37, v39 dst_sel:WORD_1 dst_unused:UNUSED_PRESERVE src0_sel:WORD_1
    v_mfma_f32_16x16x32_bf16 v[80:83], a[148:151], a[196:199], v[80:83]
    s_waitcnt lgkmcnt(5)
    ds_read_b64_tr_b16 a[174:175], v2 offset:15360
    v_pk_fma_f16 v36, v36, s73, s73
    v_mfma_f32_32x32x16_bf16 v[64:79], a[160:163], a[16:19], v[64:79]
    s_waitcnt lgkmcnt(4)
    ds_read_b64_tr_b16 a[176:177], v2 offset:16384
    ds_read_b64_tr_b16 a[178:179], v2 offset:18432
    v_pk_fma_f16 v37, v37, s73, s73
    v_rcp_f16 v38, v36
    v_rcp_f16 v39, v37
    v_mfma_f32_32x32x16_bf16 v[64:79], a[164:167], a[20:23], v[64:79]
    ds_read_b64_tr_b16 a[180:181], v2 offset:17408
    v_rcp_f16_sdwa v38, v36 dst_sel:WORD_1 dst_unused:UNUSED_PRESERVE src0_sel:WORD_1
    v_rcp_f16_sdwa v39, v37 dst_sel:WORD_1 dst_unused:UNUSED_PRESERVE src0_sel:WORD_1
    v_fma_mix_f32 v52, v52, v38, 0 op_sel:[0,0,0] op_sel_hi:[0,1,0]
    v_mfma_f32_16x16x32_bf16 v[80:83], a[152:155], a[200:203], v[80:83]
    s_waitcnt lgkmcnt(5)
    ds_read_b64_tr_b16 a[182:183], v2 offset:19456
    v_fma_mix_f32 v53, v53, v38, 0 op_sel:[0,1,0] op_sel_hi:[0,1,0]
    v_mfma_f32_32x32x16_bf16 v[64:79], a[168:171], a[24:27], v[64:79]
    s_waitcnt lgkmcnt(4)
    ds_read_b64_tr_b16 a[184:185], v2 offset:20480
    v_fma_mix_f32 v54, v54, v39, 0 op_sel:[0,0,0] op_sel_hi:[0,1,0]
    v_fma_mix_f32 v55, v55, v39, 0 op_sel:[0,1,0] op_sel_hi:[0,1,0]
    v_cvt_pk_bf16_f32 v42, v52, v53
    v_cvt_pk_bf16_f32 v43, v54, v55
    v_cvt_pk_f16_f32 v32, v56, v57
    v_cvt_pk_f16_f32 v33, v58, v59
    v_mfma_f32_32x32x16_bf16 v[64:79], a[172:175], a[28:31], v[64:79]
    ds_write_b128 v9, v[40:43] offset:32768
    ds_read_b64_tr_b16 a[186:187], v2 offset:22528
    v_mfma_f32_16x16x32_bf16 v[80:83], a[156:159], a[204:207], v[80:83]
    s_waitcnt lgkmcnt(5)
    ds_read_b64_tr_b16 a[188:189], v2 offset:21504
    v_pk_fma_f16 v34, v32, v32, s59
    v_mfma_f32_32x32x16_bf16 v[64:79], a[176:179], a[32:35], v[64:79]
    s_waitcnt lgkmcnt(4)
    ds_read_b64_tr_b16 a[190:191], v2 offset:23552
    v_pk_fma_f16 v35, v33, v33, s59
    v_pk_mul_f16 v34, v34, v32
    v_pk_mul_f16 v35, v35, v33
    v_exp_f16 v32, v34
    v_mfma_f32_32x32x16_bf16 v[64:79], a[180:183], a[36:39], v[64:79]
    ds_read_b64_tr_b16 a[240:241], v4 offset:24832
    v_exp_f16 v33, v35
    v_exp_f16_sdwa v32, v34 dst_sel:WORD_1 dst_unused:UNUSED_PRESERVE src0_sel:WORD_1
    v_exp_f16_sdwa v33, v35 dst_sel:WORD_1 dst_unused:UNUSED_PRESERVE src0_sel:WORD_1
    v_mfma_f32_16x16x32_bf16 v[80:83], a[160:163], a[208:211], v[80:83]
    s_waitcnt lgkmcnt(3)
    ds_read_b64_tr_b16 a[242:243], v4 offset:27904
    ds_read_b64_tr_b16 a[244:245], v4 offset:30720
    v_mfma_f32_32x32x16_bf16 v[64:79], a[184:187], a[40:43], v[64:79]
    s_waitcnt lgkmcnt(3)
    ds_read_b64_tr_b16 a[246:247], v4 offset:33792
    v_pk_fma_f16 v32, v32, s73, s73
    v_pk_fma_f16 v33, v33, s73, s73
    v_rcp_f16 v34, v32
    v_rcp_f16 v35, v33
    v_mfma_f32_32x32x16_bf16 v[64:79], a[188:191], a[44:47], v[64:79]
    ds_read_b128 a[228:231], v10 offset:3072
    v_rcp_f16_sdwa v34, v32 dst_sel:WORD_1 dst_unused:UNUSED_PRESERVE src0_sel:WORD_1
    v_rcp_f16_sdwa v35, v33 dst_sel:WORD_1 dst_unused:UNUSED_PRESERVE src0_sel:WORD_1
    v_fma_mix_f32 v56, v56, v34, 0 op_sel:[0,0,0] op_sel_hi:[0,1,0]
    v_fma_mix_f32 v57, v57, v34, 0 op_sel:[0,1,0] op_sel_hi:[0,1,0]
    v_mfma_f32_16x16x32_bf16 v[80:83], a[164:167], a[212:215], v[80:83]
    s_waitcnt lgkmcnt(3)
    ds_read_b128 a[232:235], v10 offset:7168
    v_fma_mix_f32 v58, v58, v35, 0 op_sel:[0,0,0] op_sel_hi:[0,1,0]
    v_mfma_f32_32x32x16_bf16 v[144:159], a[240:243], a[216:219], v[144:159]
    ds_read_b128 a[236:239], v10 offset:11264
    v_fma_mix_f32 v59, v59, v35, 0 op_sel:[0,1,0] op_sel_hi:[0,1,0]
    v_cvt_pk_bf16_f32 v44, v56, v57
    v_cvt_pk_bf16_f32 v45, v58, v59
    v_cvt_pk_f16_f32 v36, v60, v61
    v_cvt_pk_f16_f32 v37, v62, v63
    v_pk_fma_f16 v38, v36, v36, s59
    v_mfma_f32_32x32x16_bf16 v[192:207], a[240:243], a[220:223], v[192:207]
    ds_read_b64_tr_b16 a[248:249], v4 offset:30848
    v_pk_fma_f16 v39, v37, v37, s59
    v_pk_mul_f16 v38, v38, v36
    v_pk_mul_f16 v39, v39, v37
    v_exp_f16 v36, v38
    v_mfma_f32_32x32x16_bf16 v[240:255], a[240:243], a[224:227], v[240:255]
    s_waitcnt lgkmcnt(3)
    ds_write_b128 v11, v[80:83] offset:53248
    ds_read_b64_tr_b16 a[250:251], v4 offset:33920
    v_mfma_f32_32x32x16_bf16 v[112:127], a[244:247], a[228:231], v[112:127]
    s_waitcnt lgkmcnt(4)
    v_exp_f16 v37, v39
    v_exp_f16_sdwa v36, v38 dst_sel:WORD_1 dst_unused:UNUSED_PRESERVE src0_sel:WORD_1
    v_exp_f16_sdwa v37, v39 dst_sel:WORD_1 dst_unused:UNUSED_PRESERVE src0_sel:WORD_1
    v_pk_fma_f16 v36, v36, s73, s73
    v_mfma_f32_32x32x16_bf16 v[160:175], a[244:247], a[232:235], v[160:175]
    s_waitcnt lgkmcnt(3)
    ds_read_b64_tr_b16 a[252:253], v4 offset:30976
    v_pk_fma_f16 v37, v37, s73, s73
    v_rcp_f16 v38, v36
    v_rcp_f16 v39, v37
    v_mfma_f32_32x32x16_bf16 v[208:223], a[244:247], a[236:239], v[208:223]
    s_waitcnt lgkmcnt(1)
    ds_read_b64_tr_b16 a[254:255], v4 offset:34048
    v_rcp_f16_sdwa v38, v36 dst_sel:WORD_1 dst_unused:UNUSED_PRESERVE src0_sel:WORD_1
    v_rcp_f16_sdwa v39, v37 dst_sel:WORD_1 dst_unused:UNUSED_PRESERVE src0_sel:WORD_1
    v_fma_mix_f32 v60, v60, v38, 0 op_sel:[0,0,0] op_sel_hi:[0,1,0]
    v_fma_mix_f32 v61, v61, v38, 0 op_sel:[0,1,0] op_sel_hi:[0,1,0]
    v_mfma_f32_32x32x16_bf16 v[128:143], a[248:251], a[228:231], v[128:143]
    v_fma_mix_f32 v62, v62, v39, 0 op_sel:[0,0,0] op_sel_hi:[0,1,0]
    v_fma_mix_f32 v63, v63, v39, 0 op_sel:[0,1,0] op_sel_hi:[0,1,0]
    v_cvt_pk_bf16_f32 v46, v60, v61
    v_cvt_pk_bf16_f32 v47, v62, v63
    v_cvt_pk_f16_f32 v32, v64, v65
    v_cvt_pk_f16_f32 v33, v66, v67
    v_pk_fma_f16 v34, v32, v32, s59
    v_mfma_f32_32x32x16_bf16 v[176:191], a[248:251], a[232:235], v[176:191]
    ds_write_b128 v9, v[44:47] offset:33792
    v_pk_fma_f16 v35, v33, v33, s59
    v_mfma_f32_32x32x16_bf16 v[224:239], a[248:251], a[236:239], v[224:239]
    s_waitcnt lgkmcnt(1)
    v_pk_mul_f16 v34, v34, v32
    v_pk_mul_f16 v35, v35, v33
    v_exp_f16 v32, v34
    v_exp_f16 v33, v35
    v_mfma_f32_32x32x16_bf16 v[144:159], a[252:255], a[228:231], v[144:159]
    v_exp_f16_sdwa v32, v34 dst_sel:WORD_1 dst_unused:UNUSED_PRESERVE src0_sel:WORD_1
    v_exp_f16_sdwa v33, v35 dst_sel:WORD_1 dst_unused:UNUSED_PRESERVE src0_sel:WORD_1
    v_pk_fma_f16 v32, v32, s73, s73
    v_pk_fma_f16 v33, v33, s73, s73
    v_mfma_f32_32x32x16_bf16 v[192:207], a[252:255], a[232:235], v[192:207]
    v_rcp_f16 v34, v32
    v_rcp_f16 v35, v33
    v_rcp_f16_sdwa v34, v32 dst_sel:WORD_1 dst_unused:UNUSED_PRESERVE src0_sel:WORD_1
    v_rcp_f16_sdwa v35, v33 dst_sel:WORD_1 dst_unused:UNUSED_PRESERVE src0_sel:WORD_1
    v_mfma_f32_32x32x16_bf16 v[240:255], a[252:255], a[236:239], v[240:255]
    v_fma_mix_f32 v64, v64, v34, 0 op_sel:[0,0,0] op_sel_hi:[0,1,0]
    v_fma_mix_f32 v65, v65, v34, 0 op_sel:[0,1,0] op_sel_hi:[0,1,0]
    v_fma_mix_f32 v66, v66, v35, 0 op_sel:[0,0,0] op_sel_hi:[0,1,0]
    v_fma_mix_f32 v67, v67, v35, 0 op_sel:[0,1,0] op_sel_hi:[0,1,0]
    v_cvt_pk_bf16_f32 v40, v64, v65
    v_cvt_pk_bf16_f32 v41, v66, v67
    s_sub_u32 s60, s60, 1
    s_cmp_lg_u32 s60, 0
    s_waitcnt vmcnt(0) lgkmcnt(0)
    s_barrier
    s_cbranch_scc1 L_LOOP
    v_mfma_f32_32x32x16_bf16 v[48:63], a[144:147], a[48:51], 0
    s_add_u32 m0, s66, 0x6000
    ds_read2st64_b32 v[96:97], v12 offset0:16 offset1:20
    v_cvt_pk_f16_f32 v36, v68, v69
    v_cvt_pk_f16_f32 v37, v70, v71
    v_pk_fma_f16 v38, v36, v36, s59
    v_pk_fma_f16 v39, v37, v37, s59
    v_pk_mul_f16 v38, v38, v36
    v_mfma_f32_32x32x16_bf16 v[48:63], a[148:151], a[52:55], v[48:63]
    buffer_load_dwordx4 v16, s[28:31], s62 offen lds
    v_pk_mul_f16 v39, v39, v37
    v_exp_f16 v36, v38
    v_mfma_f32_32x32x16_bf16 v[48:63], a[152:155], a[56:59], v[48:63]
    ds_read_b64_tr_b16 a[240:241], v3
    v_exp_f16 v37, v39
    v_exp_f16_sdwa v36, v38 dst_sel:WORD_1 dst_unused:UNUSED_PRESERVE src0_sel:WORD_1
    v_mfma_f32_32x32x16_bf16 v[48:63], a[156:159], a[60:63], v[48:63]
    ds_read_b64_tr_b16 a[242:243], v3 offset:3072
    v_exp_f16_sdwa v37, v39 dst_sel:WORD_1 dst_unused:UNUSED_PRESERVE src0_sel:WORD_1
    v_pk_fma_f16 v36, v36, s73, s73
    v_pk_fma_f16 v37, v37, s73, s73
    v_mfma_f32_32x32x16_bf16 v[48:63], a[160:163], a[64:67], v[48:63]
    buffer_load_dwordx4 v17, s[28:31], s62 offen offset:1024 lds
    v_rcp_f16 v38, v36
    v_rcp_f16 v39, v37
    v_mfma_f32_32x32x16_bf16 v[48:63], a[164:167], a[68:71], v[48:63]
    ds_read_b128 a[216:219], v10 offset:24576
    v_rcp_f16_sdwa v38, v36 dst_sel:WORD_1 dst_unused:UNUSED_PRESERVE src0_sel:WORD_1
    v_rcp_f16_sdwa v39, v37 dst_sel:WORD_1 dst_unused:UNUSED_PRESERVE src0_sel:WORD_1
    v_fma_mix_f32 v68, v68, v38, 0 op_sel:[0,0,0] op_sel_hi:[0,1,0]
    v_mfma_f32_32x32x16_bf16 v[48:63], a[168:171], a[72:75], v[48:63]
    ds_read_b128 a[220:223], v10 offset:28672
    v_fma_mix_f32 v69, v69, v38, 0 op_sel:[0,1,0] op_sel_hi:[0,1,0]
    v_fma_mix_f32 v70, v70, v39, 0 op_sel:[0,0,0] op_sel_hi:[0,1,0]
    v_fma_mix_f32 v71, v71, v39, 0 op_sel:[0,1,0] op_sel_hi:[0,1,0]
    v_cvt_pk_bf16_f32 v42, v68, v69
    v_cvt_pk_bf16_f32 v43, v70, v71
    v_mfma_f32_32x32x16_bf16 v[48:63], a[172:175], a[76:79], v[48:63]
    ds_write_b128 v9, v[40:43]
    buffer_load_dwordx4 v18, s[28:31], s62 offen offset:2048 lds
    v_mfma_f32_32x32x16_bf16 v[48:63], a[176:179], a[80:83], v[48:63]
    s_waitcnt lgkmcnt(5)
    ds_read_b128 v[100:103], v14
    v_add_f32 v96, v96, v97
    v_cvt_pk_f16_f32 v32, v72, v73
    v_cvt_pk_f16_f32 v33, v74, v75
    v_fmaak_f32 v97, v96, v96, 0x409d2a01
    v_pk_fma_f16 v34, v32, v32, s59
    v_mfma_f32_32x32x16_bf16 v[48:63], a[180:183], a[84:87], v[48:63]
    ds_read_b128 a[224:227], v10 offset:32768
    v_pk_fma_f16 v35, v33, v33, s59
    v_mul_f32 v97, v97, v96
    v_pk_mul_f16 v34, v34, v32
    v_pk_mul_f16 v35, v35, v33
    v_mfma_f32_32x32x16_bf16 v[48:63], a[184:187], a[88:91], v[48:63]
    buffer_load_dwordx4 v16, s[28:31], s62 offen offset:3072 lds
    v_exp_f16 v32, v34
    v_exp_f16 v33, v35
    v_mfma_f32_32x32x16_bf16 v[48:63], a[188:191], a[92:95], v[48:63]
    s_waitcnt lgkmcnt(4)
    ds_read_b64_tr_b16 a[244:245], v3 offset:128
    v_exp_f16_sdwa v32, v34 dst_sel:WORD_1 dst_unused:UNUSED_PRESERVE src0_sel:WORD_1
    v_exp_f16_sdwa v33, v35 dst_sel:WORD_1 dst_unused:UNUSED_PRESERVE src0_sel:WORD_1
    v_mfma_f32_32x32x16_bf16 v[112:127], a[240:243], a[216:219], v[112:127]
    s_waitcnt lgkmcnt(4)
    s_add_u32 m0, s66, 0x7000
    ds_read_b64_tr_b16 a[246:247], v3 offset:3200
    v_exp_f32 v97, v97
    v_pk_fma_f16 v32, v32, s73, s73
    v_pk_fma_f16 v33, v33, s73, s73
    v_fma_f32 v97, v97, s67, s67
    v_mfma_f32_32x32x16_bf16 v[160:175], a[240:243], a[220:223], v[160:175]
    s_waitcnt lgkmcnt(3)
    s_add_u32 s62, s62, 0x1000
    buffer_load_dwordx4 v17, s[28:31], s62 offen lds
    v_rcp_f16 v34, v32
    v_rcp_f16 v35, v33
    v_mfma_f32_16x16x32_bf16 v[84:87], a[240:243], v[100:103], v[84:87]
    s_waitcnt lgkmcnt(2)
    ds_read_b64_tr_b16 a[248:249], v3 offset:256
    v_mfma_f32_32x32x16_bf16 v[208:223], a[240:243], a[224:227], v[208:223]
    s_waitcnt lgkmcnt(1)
    ds_read_b64_tr_b16 a[250:251], v3 offset:3328
    v_rcp_f16_sdwa v34, v32 dst_sel:WORD_1 dst_unused:UNUSED_PRESERVE src0_sel:WORD_1
    v_rcp_f16_sdwa v35, v33 dst_sel:WORD_1 dst_unused:UNUSED_PRESERVE src0_sel:WORD_1
    v_mfma_f32_32x32x16_bf16 v[128:143], a[244:247], a[216:219], v[128:143]
    buffer_load_dwordx4 v18, s[28:31], s62 offen offset:1024 lds
    v_rcp_f32 v97, v97
    v_fma_mix_f32 v72, v72, v34, 0 op_sel:[0,0,0] op_sel_hi:[0,1,0]
    v_fma_mix_f32 v73, v73, v34, 0 op_sel:[0,1,0] op_sel_hi:[0,1,0]
    v_mfma_f32_32x32x16_bf16 v[176:191], a[244:247], a[220:223], v[176:191]
    s_add_u32 s62, s62, 0x5000
    ds_read_b64_tr_b16 a[252:253], v3 offset:6144
    v_fma_mix_f32 v74, v74, v35, 0 op_sel:[0,0,0] op_sel_hi:[0,1,0]
    v_fma_mix_f32 v75, v75, v35, 0 op_sel:[0,1,0] op_sel_hi:[0,1,0]
    v_mul_f32 v97, v97, v96
    v_cvt_pk_bf16_f32 v44, v72, v73
    v_cvt_pk_bf16_f32 v45, v74, v75
    v_mfma_f32_16x16x32_bf16 v[88:91], a[244:247], v[100:103], v[88:91]
    ds_read_b64_tr_b16 a[254:255], v3 offset:9216
    v_cvt_pk_bf16_f32 v97, v97, v97
    v_mfma_f32_32x32x16_bf16 v[224:239], a[244:247], a[224:227], v[224:239]
    s_waitcnt lgkmcnt(2)
    ds_write_b16 v13, v97 offset:512
    ds_read_b128 a[228:231], v10 offset:25600
    v_cvt_pk_f16_f32 v36, v76, v77
    v_cvt_pk_f16_f32 v37, v78, v79
    v_pk_fma_f16 v38, v36, v36, s59
    v_mfma_f32_32x32x16_bf16 v[144:159], a[248:251], a[216:219], v[144:159]
    ds_read_b128 a[232:235], v10 offset:29696
    v_pk_fma_f16 v39, v37, v37, s59
    v_pk_mul_f16 v38, v38, v36
    v_pk_mul_f16 v39, v39, v37
    v_exp_f16 v36, v38
    v_mfma_f32_32x32x16_bf16 v[192:207], a[248:251], a[220:223], v[192:207]
    ds_read_b128 v[104:107], v14 offset:128
    v_exp_f16 v37, v39
    v_exp_f16_sdwa v36, v38 dst_sel:WORD_1 dst_unused:UNUSED_PRESERVE src0_sel:WORD_1
    v_mfma_f32_16x16x32_bf16 v[92:95], a[248:251], v[100:103], v[92:95]
    ds_read_b128 a[236:239], v10 offset:33792
    v_exp_f16_sdwa v37, v39 dst_sel:WORD_1 dst_unused:UNUSED_PRESERVE src0_sel:WORD_1
    v_mfma_f32_32x32x16_bf16 v[240:255], a[248:251], a[224:227], v[240:255]
    s_waitcnt lgkmcnt(3)
    ds_read_b64_tr_b16 a[240:241], v3 offset:6272
    v_pk_fma_f16 v36, v36, s73, s73
    v_pk_fma_f16 v37, v37, s73, s73
    v_rcp_f16 v38, v36
    v_mfma_f32_32x32x16_bf16 v[112:127], a[252:255], a[228:231], v[112:127]
    s_waitcnt lgkmcnt(3)
    ds_read_b64_tr_b16 a[242:243], v3 offset:9344
    v_rcp_f16 v39, v37
    v_rcp_f16_sdwa v38, v36 dst_sel:WORD_1 dst_unused:UNUSED_PRESERVE src0_sel:WORD_1
    v_rcp_f16_sdwa v39, v37 dst_sel:WORD_1 dst_unused:UNUSED_PRESERVE src0_sel:WORD_1
    v_mfma_f32_32x32x16_bf16 v[160:175], a[252:255], a[232:235], v[160:175]
    s_waitcnt lgkmcnt(3)
    ds_read_b64_tr_b16 a[244:245], v3 offset:6400
    v_fma_mix_f32 v76, v76, v38, 0 op_sel:[0,0,0] op_sel_hi:[0,1,0]
    v_fma_mix_f32 v77, v77, v38, 0 op_sel:[0,1,0] op_sel_hi:[0,1,0]
    v_fma_mix_f32 v78, v78, v39, 0 op_sel:[0,0,0] op_sel_hi:[0,1,0]
    v_fma_mix_f32 v79, v79, v39, 0 op_sel:[0,1,0] op_sel_hi:[0,1,0]
    v_cvt_pk_bf16_f32 v46, v76, v77
    v_mfma_f32_16x16x32_bf16 v[84:87], a[252:255], v[104:107], v[84:87]
    s_waitcnt lgkmcnt(3)
    ds_read_b64_tr_b16 a[246:247], v3 offset:9472
    v_cvt_pk_bf16_f32 v47, v78, v79
    v_mfma_f32_32x32x16_bf16 v[208:223], a[252:255], a[236:239], v[208:223]
    s_waitcnt lgkmcnt(2)
    ds_write_b128 v9, v[44:47] offset:1024
    v_cvt_pk_f16_f32 v32, v48, v49
    v_mfma_f32_32x32x16_bf16 v[128:143], a[240:243], a[228:231], v[128:143]
    v_cvt_pk_f16_f32 v33, v50, v51
    v_pk_fma_f16 v34, v32, v32, s59
    v_pk_fma_f16 v35, v33, v33, s59
    v_pk_mul_f16 v34, v34, v32
    v_pk_mul_f16 v35, v35, v33
    v_mfma_f32_32x32x16_bf16 v[176:191], a[240:243], a[232:235], v[176:191]
    ds_read_b64_tr_b16 a[248:249], v4
    v_exp_f16 v32, v34
    v_exp_f16 v33, v35
    v_exp_f16_sdwa v32, v34 dst_sel:WORD_1 dst_unused:UNUSED_PRESERVE src0_sel:WORD_1
    v_mfma_f32_16x16x32_bf16 v[88:91], a[240:243], v[104:107], v[88:91]
    ds_read_b64_tr_b16 a[250:251], v4 offset:3072
    v_mfma_f32_32x32x16_bf16 v[224:239], a[240:243], a[236:239], v[224:239]
    s_waitcnt lgkmcnt(3)
    ds_read_b128 a[216:219], v10 offset:26624
    v_exp_f16_sdwa v33, v35 dst_sel:WORD_1 dst_unused:UNUSED_PRESERVE src0_sel:WORD_1
    v_pk_fma_f16 v32, v32, s73, s73
    v_pk_fma_f16 v33, v33, s73, s73
    v_rcp_f16 v34, v32
    v_mfma_f32_32x32x16_bf16 v[144:159], a[244:247], a[228:231], v[144:159]
    ds_read_b128 a[220:223], v10 offset:30720
    v_rcp_f16 v35, v33
    v_rcp_f16_sdwa v34, v32 dst_sel:WORD_1 dst_unused:UNUSED_PRESERVE src0_sel:WORD_1
    v_mfma_f32_32x32x16_bf16 v[192:207], a[244:247], a[232:235], v[192:207]
    ds_read_b128 a[224:227], v10 offset:34816
    v_rcp_f16_sdwa v35, v33 dst_sel:WORD_1 dst_unused:UNUSED_PRESERVE src0_sel:WORD_1
    v_fma_mix_f32 v48, v48, v34, 0 op_sel:[0,0,0] op_sel_hi:[0,1,0]
    v_fma_mix_f32 v49, v49, v34, 0 op_sel:[0,1,0] op_sel_hi:[0,1,0]
    v_fma_mix_f32 v50, v50, v35, 0 op_sel:[0,0,0] op_sel_hi:[0,1,0]
    v_mfma_f32_16x16x32_bf16 v[92:95], a[244:247], v[104:107], v[92:95]
    ds_read_b64_tr_b16 a[252:253], v4 offset:128
    v_fma_mix_f32 v51, v51, v35, 0 op_sel:[0,1,0] op_sel_hi:[0,1,0]
    v_mfma_f32_32x32x16_bf16 v[240:255], a[244:247], a[236:239], v[240:255]
    s_waitcnt lgkmcnt(3)
    ds_read_b64_tr_b16 a[254:255], v4 offset:3200
    v_cvt_pk_bf16_f32 v40, v48, v49
    v_cvt_pk_bf16_f32 v41, v50, v51
    v_cvt_pk_f16_f32 v36, v52, v53
    v_cvt_pk_f16_f32 v37, v54, v55
    v_pk_fma_f16 v38, v36, v36, s59
    v_mfma_f32_32x32x16_bf16 v[112:127], a[248:251], a[216:219], v[112:127]
    s_waitcnt lgkmcnt(3)
    ds_read_b64_tr_b16 a[240:241], v4 offset:256
    v_pk_fma_f16 v39, v37, v37, s59
    v_pk_mul_f16 v38, v38, v36
    v_pk_mul_f16 v39, v39, v37
    v_exp_f16 v36, v38
    v_mfma_f32_32x32x16_bf16 v[160:175], a[248:251], a[220:223], v[160:175]
    s_waitcnt lgkmcnt(3)
    ds_read_b64_tr_b16 a[242:243], v4 offset:3328
    v_exp_f16 v37, v39
    v_exp_f16_sdwa v36, v38 dst_sel:WORD_1 dst_unused:UNUSED_PRESERVE src0_sel:WORD_1
    v_exp_f16_sdwa v37, v39 dst_sel:WORD_1 dst_unused:UNUSED_PRESERVE src0_sel:WORD_1
    v_mfma_f32_32x32x16_bf16 v[208:223], a[248:251], a[224:227], v[208:223]
    s_waitcnt lgkmcnt(2)
    ds_read_b64_tr_b16 a[244:245], v4 offset:6144
    v_pk_fma_f16 v36, v36, s73, s73
    v_pk_fma_f16 v37, v37, s73, s73
    v_rcp_f16 v38, v36
    v_mfma_f32_32x32x16_bf16 v[128:143], a[252:255], a[216:219], v[128:143]
    ds_read_b64_tr_b16 a[246:247], v4 offset:9216
    v_rcp_f16 v39, v37
    v_rcp_f16_sdwa v38, v36 dst_sel:WORD_1 dst_unused:UNUSED_PRESERVE src0_sel:WORD_1
    v_rcp_f16_sdwa v39, v37 dst_sel:WORD_1 dst_unused:UNUSED_PRESERVE src0_sel:WORD_1
    v_mfma_f32_32x32x16_bf16 v[176:191], a[252:255], a[220:223], v[176:191]
    ds_read_b128 a[228:231], v10 offset:27648
    v_fma_mix_f32 v52, v52, v38, 0 op_sel:[0,0,0] op_sel_hi:[0,1,0]
    v_fma_mix_f32 v53, v53, v38, 0 op_sel:[0,1,0] op_sel_hi:[0,1,0]
    v_fma_mix_f32 v54, v54, v39, 0 op_sel:[0,0,0] op_sel_hi:[0,1,0]
    v_fma_mix_f32 v55, v55, v39, 0 op_sel:[0,1,0] op_sel_hi:[0,1,0]
    v_cvt_pk_bf16_f32 v42, v52, v53
    v_mfma_f32_32x32x16_bf16 v[224:239], a[252:255], a[224:227], v[224:239]
    s_waitcnt lgkmcnt(3)
    ds_read_b128 a[232:235], v10 offset:31744
    v_cvt_pk_bf16_f32 v43, v54, v55
    v_cvt_pk_f16_f32 v32, v56, v57
    v_cvt_pk_f16_f32 v33, v58, v59
    v_pk_fma_f16 v34, v32, v32, s59
    v_pk_fma_f16 v35, v33, v33, s59
    v_mfma_f32_32x32x16_bf16 v[144:159], a[240:243], a[216:219], v[144:159]
    ds_write_b128 v9, v[40:43] offset:4096
    ds_read_b128 a[236:239], v10 offset:35840
    v_mfma_f32_32x32x16_bf16 v[192:207], a[240:243], a[220:223], v[192:207]
    ds_read_b64_tr_b16 a[248:249], v4 offset:6272
    v_pk_mul_f16 v34, v34, v32
    v_pk_mul_f16 v35, v35, v33
    v_exp_f16 v32, v34
    v_mfma_f32_32x32x16_bf16 v[240:255], a[240:243], a[224:227], v[240:255]
    s_waitcnt lgkmcnt(4)
    ds_read_b64_tr_b16 a[250:251], v4 offset:9344
    v_exp_f16 v33, v35
    v_exp_f16_sdwa v32, v34 dst_sel:WORD_1 dst_unused:UNUSED_PRESERVE src0_sel:WORD_1
    v_exp_f16_sdwa v33, v35 dst_sel:WORD_1 dst_unused:UNUSED_PRESERVE src0_sel:WORD_1
    v_mfma_f32_32x32x16_bf16 v[112:127], a[244:247], a[228:231], v[112:127]
    s_waitcnt lgkmcnt(4)
    ds_read_b64_tr_b16 a[252:253], v4 offset:6400
    v_pk_fma_f16 v32, v32, s73, s73
    v_pk_fma_f16 v33, v33, s73, s73
    v_rcp_f16 v34, v32
    v_mfma_f32_32x32x16_bf16 v[160:175], a[244:247], a[232:235], v[160:175]
    s_waitcnt lgkmcnt(3)
    ds_read_b64_tr_b16 a[254:255], v4 offset:9472
    v_rcp_f16 v35, v33
    v_rcp_f16_sdwa v34, v32 dst_sel:WORD_1 dst_unused:UNUSED_PRESERVE src0_sel:WORD_1
    v_rcp_f16_sdwa v35, v33 dst_sel:WORD_1 dst_unused:UNUSED_PRESERVE src0_sel:WORD_1
    v_mfma_f32_32x32x16_bf16 v[208:223], a[244:247], a[236:239], v[208:223]
    s_waitcnt lgkmcnt(2)
    v_fma_mix_f32 v56, v56, v34, 0 op_sel:[0,0,0] op_sel_hi:[0,1,0]
    v_fma_mix_f32 v57, v57, v34, 0 op_sel:[0,1,0] op_sel_hi:[0,1,0]
    v_fma_mix_f32 v58, v58, v35, 0 op_sel:[0,0,0] op_sel_hi:[0,1,0]
    v_fma_mix_f32 v59, v59, v35, 0 op_sel:[0,1,0] op_sel_hi:[0,1,0]
    v_cvt_pk_bf16_f32 v44, v56, v57
    v_cvt_pk_bf16_f32 v45, v58, v59
    v_mfma_f32_32x32x16_bf16 v[128:143], a[248:251], a[228:231], v[128:143]
    v_cvt_pk_f16_f32 v36, v60, v61
    v_cvt_pk_f16_f32 v37, v62, v63
    v_pk_fma_f16 v38, v36, v36, s59
    v_pk_fma_f16 v39, v37, v37, s59
    v_pk_mul_f16 v38, v38, v36
    v_pk_mul_f16 v39, v39, v37
    v_mfma_f32_32x32x16_bf16 v[176:191], a[248:251], a[232:235], v[176:191]
    v_exp_f16 v36, v38
    v_exp_f16 v37, v39
    v_exp_f16_sdwa v36, v38 dst_sel:WORD_1 dst_unused:UNUSED_PRESERVE src0_sel:WORD_1
    v_mfma_f32_32x32x16_bf16 v[224:239], a[248:251], a[236:239], v[224:239]
    s_waitcnt lgkmcnt(0)
    v_exp_f16_sdwa v37, v39 dst_sel:WORD_1 dst_unused:UNUSED_PRESERVE src0_sel:WORD_1
    v_pk_fma_f16 v36, v36, s73, s73
    v_pk_fma_f16 v37, v37, s73, s73
    v_rcp_f16 v38, v36
    v_rcp_f16 v39, v37
    v_rcp_f16_sdwa v38, v36 dst_sel:WORD_1 dst_unused:UNUSED_PRESERVE src0_sel:WORD_1
    v_rcp_f16_sdwa v39, v37 dst_sel:WORD_1 dst_unused:UNUSED_PRESERVE src0_sel:WORD_1
    v_fma_mix_f32 v60, v60, v38, 0 op_sel:[0,0,0] op_sel_hi:[0,1,0]
    v_fma_mix_f32 v61, v61, v38, 0 op_sel:[0,1,0] op_sel_hi:[0,1,0]
    v_fma_mix_f32 v62, v62, v39, 0 op_sel:[0,0,0] op_sel_hi:[0,1,0]
    v_fma_mix_f32 v63, v63, v39, 0 op_sel:[0,1,0] op_sel_hi:[0,1,0]
    v_cvt_pk_bf16_f32 v46, v60, v61
    v_cvt_pk_bf16_f32 v47, v62, v63
    v_mfma_f32_32x32x16_bf16 v[144:159], a[252:255], a[228:231], v[144:159]
    ds_write_b128 v9, v[44:47] offset:5120
    v_mfma_f32_32x32x16_bf16 v[192:207], a[252:255], a[232:235], v[192:207]
    v_mfma_f32_32x32x16_bf16 v[240:255], a[252:255], a[236:239], v[240:255]
    s_waitcnt vmcnt(0) lgkmcnt(0)
    s_barrier
    v_mfma_f32_32x32x16_bf16 v[64:79], a[144:147], a[96:99], 0
    s_lshl_b32 s63, s38, 1
    ds_read_b64_tr_b16 a[48:49], v3 offset:24576
    ds_read_b64_tr_b16 a[50:51], v3 offset:27648
    ds_read_b128 a[0:3], v10
    v_lshlrev_b32 v110, 4, v0
    v_mfma_f32_32x32x16_bf16 v[64:79], a[148:151], a[100:103], v[64:79]
    s_add_u32 s63, s63, s37
    ds_read_b64_tr_b16 a[60:61], v3 offset:30720
    ds_read_b64_tr_b16 a[62:63], v3 offset:33792
    ds_read_b128 a[4:7], v10 offset:1024
    v_mfma_f32_32x32x16_bf16 v[64:79], a[152:155], a[104:107], v[64:79]
    s_lshl_b32 s63, s63, 10
    ds_read_b64_tr_b16 a[72:73], v4 offset:24576
    ds_read_b64_tr_b16 a[74:75], v4 offset:27648
    ds_read_b128 a[8:11], v10 offset:2048
    v_mfma_f32_32x32x16_bf16 v[64:79], a[156:159], a[108:111], v[64:79]
    ds_read_b64_tr_b16 a[84:85], v4 offset:30720
    ds_read_b64_tr_b16 a[86:87], v4 offset:33792
    ds_read_b128 a[12:15], v10 offset:3072
    v_add_u32 v110, s63, v110
    v_mfma_f32_32x32x16_bf16 v[64:79], a[160:163], a[112:115], v[64:79]
    s_waitcnt lgkmcnt(9)
    ds_read_b128 v[100:103], v14 offset:512
    ds_read_b128 v[104:107], v14 offset:640
    ds_read_b64_tr_b16 a[52:53], v3 offset:24704
    v_mfma_f32_32x32x16_bf16 v[112:127], a[48:51], a[0:3], v[112:127]
    s_waitcnt lgkmcnt(9)
    ds_read_b64_tr_b16 a[54:55], v3 offset:27776
    ds_read_b64_tr_b16 a[64:65], v3 offset:30848
    ds_read_b64_tr_b16 a[66:67], v3 offset:33920
    v_mfma_f32_32x32x16_bf16 v[112:127], a[60:63], a[4:7], v[112:127]
    s_waitcnt lgkmcnt(9)
    s_add_u32 s63, s36, 0
    ds_read_b64_tr_b16 a[76:77], v4 offset:24704
    ds_read_b64_tr_b16 a[78:79], v4 offset:27776
    ds_read_b64_tr_b16 a[88:89], v4 offset:30848
    v_mfma_f32_32x32x16_bf16 v[112:127], a[72:75], a[8:11], v[112:127]
    s_waitcnt lgkmcnt(9)
    s_mul_i32 s70, s63, 0x15000
    ds_read_b64_tr_b16 a[90:91], v4 offset:33920
    ds_read_b64_tr_b16 a[56:57], v3 offset:24832
    ds_read_b64_tr_b16 a[58:59], v3 offset:27904
    v_mfma_f32_32x32x16_bf16 v[112:127], a[84:87], a[12:15], v[112:127]
    s_waitcnt lgkmcnt(11)
    s_add_u32 s70, s70, s42
    ds_read_b64_tr_b16 a[68:69], v3 offset:30976
    ds_read_b64_tr_b16 a[70:71], v3 offset:34048
    ds_read_b64_tr_b16 a[80:81], v4 offset:24832
    v_mfma_f32_16x16x32_bf16 v[84:87], a[48:51], v[100:103], v[84:87]
    s_waitcnt lgkmcnt(13)
    s_add_u32 s71, s70, 0xa80
    ds_read_b64_tr_b16 a[82:83], v4 offset:27904
    ds_read_b64_tr_b16 a[92:93], v4 offset:30976
    ds_read_b64_tr_b16 a[94:95], v4 offset:34048
    v_mfma_f32_16x16x32_bf16 v[84:87], a[60:63], v[104:107], v[84:87]
    s_waitcnt lgkmcnt(14)
    s_mul_i32 s63, s63, 0x15e0
    ds_read_b128 a[16:19], v10 offset:4096
    ds_read_b128 a[20:23], v10 offset:5120
    ds_read_b128 a[24:27], v10 offset:6144
    v_mfma_f32_32x32x16_bf16 v[128:143], a[52:55], a[0:3], v[128:143]
    s_waitcnt lgkmcnt(15)
    ds_read_b128 a[28:31], v10 offset:7168
    buffer_load_dwordx2 v[108:109], v30, s[16:19], s42 offen
    v_mfma_f32_32x32x16_bf16 v[128:143], a[64:67], a[4:7], v[128:143]
    s_waitcnt lgkmcnt(14)
    v_cvt_pk_bf16_f32 v112, v112, v113
    v_cvt_pk_bf16_f32 v113, v114, v115
    v_cvt_pk_bf16_f32 v114, v116, v117
    v_cvt_pk_bf16_f32 v115, v118, v119
    v_cvt_pk_bf16_f32 v120, v120, v121
    v_mfma_f32_32x32x16_bf16 v[128:143], a[76:79], a[8:11], v[128:143]
    s_waitcnt lgkmcnt(12)
    ds_write_b128 v19, v[112:115]
    v_mfma_f32_32x32x16_bf16 v[128:143], a[88:91], a[12:15], v[128:143]
    ds_write_b128 v110, v[84:87]
    v_mfma_f32_16x16x32_bf16 v[88:91], a[52:55], v[100:103], v[88:91]
    v_cvt_pk_bf16_f32 v121, v122, v123
    v_cvt_pk_bf16_f32 v122, v124, v125
    v_mfma_f32_16x16x32_bf16 v[88:91], a[64:67], v[104:107], v[88:91]
    s_waitcnt lgkmcnt(12)
    v_cvt_pk_bf16_f32 v123, v126, v127
    v_mfma_f32_32x32x16_bf16 v[144:159], a[56:59], a[0:3], v[144:159]
    s_waitcnt lgkmcnt(10)
    ds_write_b128 v19, v[120:123] offset:32
    v_mfma_f32_32x32x16_bf16 v[144:159], a[68:71], a[4:7], v[144:159]
    s_waitcnt lgkmcnt(9)
    v_cvt_pk_bf16_f32 v128, v128, v129
    v_cvt_pk_bf16_f32 v129, v130, v131
    v_cvt_pk_bf16_f32 v130, v132, v133
    v_cvt_pk_bf16_f32 v131, v134, v135
    v_cvt_pk_bf16_f32 v136, v136, v137
    v_mfma_f32_32x32x16_bf16 v[144:159], a[80:83], a[8:11], v[144:159]
    s_waitcnt lgkmcnt(7)
    ds_write_b128 v19, v[128:131] offset:128
    v_mfma_f32_32x32x16_bf16 v[144:159], a[92:95], a[12:15], v[144:159]
    ds_write_b128 v110, v[88:91] offset:4096
    v_mfma_f32_16x16x32_bf16 v[92:95], a[56:59], v[100:103], v[92:95]
    v_cvt_pk_bf16_f32 v137, v138, v139
    v_cvt_pk_bf16_f32 v138, v140, v141
    v_mfma_f32_16x16x32_bf16 v[92:95], a[68:71], v[104:107], v[92:95]
    v_cvt_pk_bf16_f32 v139, v142, v143
    v_mfma_f32_32x32x16_bf16 v[64:79], a[164:167], a[116:119], v[64:79]
    ds_write_b128 v19, v[136:139] offset:160
    v_mfma_f32_32x32x16_bf16 v[64:79], a[168:171], a[120:123], v[64:79]
    s_nop 2
    v_cvt_pk_bf16_f32 v144, v144, v145
    v_cvt_pk_bf16_f32 v145, v146, v147
    v_cvt_pk_bf16_f32 v146, v148, v149
    v_cvt_pk_bf16_f32 v147, v150, v151
    v_cvt_pk_bf16_f32 v152, v152, v153
    v_mfma_f32_32x32x16_bf16 v[64:79], a[172:175], a[124:127], v[64:79]
    ds_write_b128 v19, v[144:147] offset:256
    v_mfma_f32_32x32x16_bf16 v[64:79], a[176:179], a[128:131], v[64:79]
    ds_write_b128 v110, v[92:95] offset:8192
    v_mfma_f32_32x32x16_bf16 v[64:79], a[180:183], a[132:135], v[64:79]
    v_cvt_pk_bf16_f32 v153, v154, v155
    v_cvt_pk_bf16_f32 v154, v156, v157
    v_cvt_pk_bf16_f32 v155, v158, v159
    v_add_u32 v5, s63, v25
    v_add_u32 v6, s63, v26
    v_add_u32 v7, s63, v27
    v_mfma_f32_32x32x16_bf16 v[64:79], a[184:187], a[136:139], v[64:79]
    ds_write_b128 v19, v[152:155] offset:288
    s_waitcnt lgkmcnt(0)
    s_barrier
    v_mfma_f32_32x32x16_bf16 v[64:79], a[188:191], a[140:143], v[64:79]
    ds_read_b128 v[112:115], v5
    ds_read_b128 v[116:119], v6
    ds_read_b128 v[120:123], v7
    v_mfma_f32_32x32x16_bf16 v[160:175], a[48:51], a[16:19], v[160:175]
    ds_read_b128 v[124:127], v5 offset:2800
    ds_read_b128 v[128:131], v6 offset:2800
    ds_read_b128 v[132:135], v7 offset:2800
    v_mfma_f32_32x32x16_bf16 v[160:175], a[60:63], a[20:23], v[160:175]
    ds_read_b128 v[84:87], v29
    ds_read_b128 v[88:91], v29 offset:1024
    v_mfma_f32_32x32x16_bf16 v[160:175], a[72:75], a[24:27], v[160:175]
    s_waitcnt lgkmcnt(7)
    buffer_store_dwordx4 v[112:115], v28, s[32:35], s70 offen sc1
    v_cvt_pk_f16_f32 v32, v64, v65
    v_cvt_pk_f16_f32 v33, v66, v67
    v_pk_fma_f16 v34, v32, v32, s59
    v_pk_fma_f16 v35, v33, v33, s59
    v_pk_mul_f16 v34, v34, v32
    v_pk_mul_f16 v35, v35, v33
    v_exp_f16 v32, v34
    v_exp_f16 v33, v35
    v_exp_f16_sdwa v32, v34 dst_sel:WORD_1 dst_unused:UNUSED_PRESERVE src0_sel:WORD_1
    v_exp_f16_sdwa v33, v35 dst_sel:WORD_1 dst_unused:UNUSED_PRESERVE src0_sel:WORD_1
    v_pk_fma_f16 v32, v32, s73, s73
    v_pk_fma_f16 v33, v33, s73, s73
    v_mfma_f32_32x32x16_bf16 v[160:175], a[84:87], a[28:31], v[160:175]
    s_waitcnt lgkmcnt(6)
    buffer_store_dwordx4 v[116:119], v28, s[32:35], s70 offen offset:896 sc1
    v_rcp_f16 v34, v32
    v_rcp_f16 v35, v33
    v_rcp_f16_sdwa v34, v32 dst_sel:WORD_1 dst_unused:UNUSED_PRESERVE src0_sel:WORD_1
    v_rcp_f16_sdwa v35, v33 dst_sel:WORD_1 dst_unused:UNUSED_PRESERVE src0_sel:WORD_1
    v_fma_mix_f32 v64, v64, v34, 0 op_sel:[0,0,0] op_sel_hi:[0,1,0]
    v_fma_mix_f32 v65, v65, v34, 0 op_sel:[0,1,0] op_sel_hi:[0,1,0]
    v_fma_mix_f32 v66, v66, v35, 0 op_sel:[0,0,0] op_sel_hi:[0,1,0]
    v_fma_mix_f32 v67, v67, v35, 0 op_sel:[0,1,0] op_sel_hi:[0,1,0]
    v_cvt_pk_bf16_f32 v40, v64, v65
    v_cvt_pk_bf16_f32 v41, v66, v67
    v_cvt_pk_f16_f32 v36, v68, v69
    v_cvt_pk_f16_f32 v37, v70, v71
    v_mfma_f32_32x32x16_bf16 v[176:191], a[52:55], a[16:19], v[176:191]
    s_waitcnt lgkmcnt(5)
    buffer_store_dwordx4 v[120:123], v28, s[32:35], s70 offen offset:1792 sc1
    v_pk_fma_f16 v38, v36, v36, s59
    v_pk_fma_f16 v39, v37, v37, s59
    v_pk_mul_f16 v38, v38, v36
    v_pk_mul_f16 v39, v39, v37
    v_exp_f16 v36, v38
    v_exp_f16 v37, v39
    v_exp_f16_sdwa v36, v38 dst_sel:WORD_1 dst_unused:UNUSED_PRESERVE src0_sel:WORD_1
    v_exp_f16_sdwa v37, v39 dst_sel:WORD_1 dst_unused:UNUSED_PRESERVE src0_sel:WORD_1
    v_pk_fma_f16 v36, v36, s73, s73
    v_pk_fma_f16 v37, v37, s73, s73
    v_rcp_f16 v38, v36
    v_mfma_f32_32x32x16_bf16 v[176:191], a[64:67], a[20:23], v[176:191]
    s_waitcnt lgkmcnt(4)
    buffer_store_dwordx4 v[124:127], v28, s[32:35], s71 offen sc1
    v_rcp_f16 v39, v37
    v_rcp_f16_sdwa v38, v36 dst_sel:WORD_1 dst_unused:UNUSED_PRESERVE src0_sel:WORD_1
    v_rcp_f16_sdwa v39, v37 dst_sel:WORD_1 dst_unused:UNUSED_PRESERVE src0_sel:WORD_1
    v_fma_mix_f32 v68, v68, v38, 0 op_sel:[0,0,0] op_sel_hi:[0,1,0]
    v_fma_mix_f32 v69, v69, v38, 0 op_sel:[0,1,0] op_sel_hi:[0,1,0]
    v_fma_mix_f32 v70, v70, v39, 0 op_sel:[0,0,0] op_sel_hi:[0,1,0]
    v_fma_mix_f32 v71, v71, v39, 0 op_sel:[0,1,0] op_sel_hi:[0,1,0]
    v_cvt_pk_bf16_f32 v42, v68, v69
    v_cvt_pk_bf16_f32 v43, v70, v71
    v_mfma_f32_32x32x16_bf16 v[176:191], a[76:79], a[24:27], v[176:191]
    s_waitcnt lgkmcnt(3)
    ds_write_b128 v9, v[40:43] offset:8192
    buffer_store_dwordx4 v[128:131], v28, s[32:35], s71 offen offset:896 sc1
    v_mfma_f32_32x32x16_bf16 v[176:191], a[88:91], a[28:31], v[176:191]
    s_waitcnt lgkmcnt(3)
    buffer_store_dwordx4 v[132:135], v28, s[32:35], s71 offen offset:1792 sc1
    v_cvt_pk_bf16_f32 v160, v160, v161
    v_cvt_pk_bf16_f32 v161, v162, v163
    v_cvt_pk_bf16_f32 v162, v164, v165
    v_cvt_pk_bf16_f32 v163, v166, v167
    v_cvt_pk_bf16_f32 v168, v168, v169
    v_cvt_pk_bf16_f32 v169, v170, v171
    v_cvt_pk_bf16_f32 v170, v172, v173
    v_cvt_pk_bf16_f32 v171, v174, v175
    v_cvt_pk_f16_f32 v32, v72, v73
    v_cvt_pk_f16_f32 v33, v74, v75
    v_pk_fma_f16 v34, v32, v32, s59
    v_pk_fma_f16 v35, v33, v33, s59
    v_pk_mul_f16 v34, v34, v32
    v_pk_mul_f16 v35, v35, v33
    v_exp_f16 v32, v34
    v_exp_f16 v33, v35
    v_exp_f16_sdwa v32, v34 dst_sel:WORD_1 dst_unused:UNUSED_PRESERVE src0_sel:WORD_1
    v_mfma_f32_32x32x16_bf16 v[192:207], a[56:59], a[16:19], v[192:207]
    ds_write_b128 v20, v[160:163]
    v_exp_f16_sdwa v33, v35 dst_sel:WORD_1 dst_unused:UNUSED_PRESERVE src0_sel:WORD_1
    v_pk_fma_f16 v32, v32, s73, s73
    v_pk_fma_f16 v33, v33, s73, s73
    v_rcp_f16 v34, v32
    v_rcp_f16 v35, v33
    v_rcp_f16_sdwa v34, v32 dst_sel:WORD_1 dst_unused:UNUSED_PRESERVE src0_sel:WORD_1
    v_rcp_f16_sdwa v35, v33 dst_sel:WORD_1 dst_unused:UNUSED_PRESERVE src0_sel:WORD_1
    v_fma_mix_f32 v72, v72, v34, 0 op_sel:[0,0,0] op_sel_hi:[0,1,0]
    v_fma_mix_f32 v73, v73, v34, 0 op_sel:[0,1,0] op_sel_hi:[0,1,0]
    v_fma_mix_f32 v74, v74, v35, 0 op_sel:[0,0,0] op_sel_hi:[0,1,0]
    v_fma_mix_f32 v75, v75, v35, 0 op_sel:[0,1,0] op_sel_hi:[0,1,0]
    v_cvt_pk_bf16_f32 v44, v72, v73
    v_cvt_pk_bf16_f32 v45, v74, v75
    v_mfma_f32_32x32x16_bf16 v[192:207], a[68:71], a[20:23], v[192:207]
    ds_write_b128 v20, v[168:171] offset:32
    v_mfma_f32_32x32x16_bf16 v[192:207], a[80:83], a[24:27], v[192:207]
    v_mfma_f32_32x32x16_bf16 v[192:207], a[92:95], a[28:31], v[192:207]
    v_cvt_pk_bf16_f32 v176, v176, v177
    v_cvt_pk_bf16_f32 v177, v178, v179
    v_cvt_pk_bf16_f32 v178, v180, v181
    v_cvt_pk_bf16_f32 v179, v182, v183
    v_cvt_pk_bf16_f32 v184, v184, v185
    v_cvt_pk_bf16_f32 v185, v186, v187
    v_cvt_pk_bf16_f32 v186, v188, v189
    v_cvt_pk_bf16_f32 v187, v190, v191
    v_cvt_pk_f16_f32 v36, v76, v77
    v_cvt_pk_f16_f32 v37, v78, v79
    v_pk_fma_f16 v38, v36, v36, s59
    v_pk_fma_f16 v39, v37, v37, s59
    v_pk_mul_f16 v38, v38, v36
    v_pk_mul_f16 v39, v39, v37
    v_exp_f16 v36, v38
    v_exp_f16 v37, v39
    v_exp_f16_sdwa v36, v38 dst_sel:WORD_1 dst_unused:UNUSED_PRESERVE src0_sel:WORD_1
    v_exp_f16_sdwa v37, v39 dst_sel:WORD_1 dst_unused:UNUSED_PRESERVE src0_sel:WORD_1
    v_pk_fma_f16 v36, v36, s73, s73
    v_pk_fma_f16 v37, v37, s73, s73
    v_rcp_f16 v38, v36
    v_rcp_f16 v39, v37
    v_rcp_f16_sdwa v38, v36 dst_sel:WORD_1 dst_unused:UNUSED_PRESERVE src0_sel:WORD_1
    v_rcp_f16_sdwa v39, v37 dst_sel:WORD_1 dst_unused:UNUSED_PRESERVE src0_sel:WORD_1
    v_fma_mix_f32 v76, v76, v38, 0 op_sel:[0,0,0] op_sel_hi:[0,1,0]
    v_fma_mix_f32 v77, v77, v38, 0 op_sel:[0,1,0] op_sel_hi:[0,1,0]
    v_fma_mix_f32 v78, v78, v39, 0 op_sel:[0,0,0] op_sel_hi:[0,1,0]
    v_fma_mix_f32 v79, v79, v39, 0 op_sel:[0,1,0] op_sel_hi:[0,1,0]
    v_cvt_pk_bf16_f32 v46, v76, v77
    v_cvt_pk_bf16_f32 v47, v78, v79
    v_cvt_pk_bf16_f32 v192, v192, v193
    v_cvt_pk_bf16_f32 v193, v194, v195
    v_cvt_pk_bf16_f32 v194, v196, v197
    v_cvt_pk_bf16_f32 v195, v198, v199
    v_cvt_pk_bf16_f32 v200, v200, v201
    v_cvt_pk_bf16_f32 v201, v202, v203
    v_cvt_pk_bf16_f32 v202, v204, v205
    v_cvt_pk_bf16_f32 v203, v206, v207
    ds_write_b128 v20, v[176:179] offset:128
    ds_write_b128 v20, v[184:187] offset:160
    ds_write_b128 v9, v[44:47] offset:9216
    ds_write_b128 v20, v[192:195] offset:256
    ds_write_b128 v20, v[200:203] offset:288
    s_add_u32 s63, s36, 4
    s_mul_i32 s70, s63, 0x15000
    s_add_u32 s70, s70, s42
    s_add_u32 s71, s70, 0xa80
    s_mul_i32 s63, s63, 0x15e0
    v_add_u32 v5, s63, v25
    v_add_u32 v6, s63, v26
    v_add_u32 v7, s63, v27
    s_waitcnt lgkmcnt(0)
    s_barrier
    ds_read_b128 a[32:35], v10 offset:8192
    ds_read_b128 a[36:39], v10 offset:9216
    ds_read_b128 a[40:43], v10 offset:10240
    ds_read_b128 a[44:47], v10 offset:11264
    ds_read_b128 v[136:139], v5
    ds_read_b128 v[140:143], v6
    ds_read_b128 v[144:147], v7
    ds_read_b128 v[148:151], v5 offset:2800
    ds_read_b128 v[152:155], v6 offset:2800
    ds_read_b128 v[156:159], v7 offset:2800
    v_add_f32 v84, v84, v88
    v_add_f32 v85, v85, v89
    v_add_f32 v86, v86, v90
    v_add_f32 v87, v87, v91
    s_waitcnt vmcnt(6)
    v_lshlrev_b32 v88, 16, v108
    v_and_b32 v89, 0xffff0000, v108
    v_lshlrev_b32 v90, 16, v109
    v_and_b32 v91, 0xffff0000, v109
    v_add_f32 v84, v84, v88
    v_add_f32 v85, v85, v89
    v_add_f32 v86, v86, v90
    v_add_f32 v87, v87, v91
    v_cvt_pk_bf16_f32 v84, v84, v85
    v_cvt_pk_bf16_f32 v85, v86, v87
    s_mov_b32 s56, s70
    s_mov_b32 s57, s71
    s_waitcnt lgkmcnt(9)
    v_mfma_f32_32x32x16_bf16 v[208:223], a[48:51], a[32:35], v[208:223]
    s_waitcnt lgkmcnt(5)
    buffer_store_dwordx4 v[136:139], v28, s[32:35], s70 offen sc1
    ds_write_b64 v31, v[84:85]
    v_mfma_f32_32x32x16_bf16 v[208:223], a[60:63], a[36:39], v[208:223]
    s_waitcnt lgkmcnt(5)
    buffer_store_dwordx4 v[140:143], v28, s[32:35], s70 offen offset:896 sc1
    v_mfma_f32_32x32x16_bf16 v[208:223], a[72:75], a[40:43], v[208:223]
    s_waitcnt lgkmcnt(4)
    buffer_store_dwordx4 v[144:147], v28, s[32:35], s70 offen offset:1792 sc1
    v_mfma_f32_32x32x16_bf16 v[208:223], a[84:87], a[44:47], v[208:223]
    s_waitcnt lgkmcnt(3)
    buffer_store_dwordx4 v[148:151], v28, s[32:35], s71 offen sc1
    v_mfma_f32_32x32x16_bf16 v[224:239], a[52:55], a[32:35], v[224:239]
    s_waitcnt lgkmcnt(2)
    buffer_store_dwordx4 v[152:155], v28, s[32:35], s71 offen offset:896 sc1
    v_mfma_f32_32x32x16_bf16 v[224:239], a[64:67], a[36:39], v[224:239]
    s_waitcnt lgkmcnt(1)
    buffer_store_dwordx4 v[156:159], v28, s[32:35], s71 offen offset:1792 sc1
    v_mfma_f32_32x32x16_bf16 v[224:239], a[76:79], a[40:43], v[224:239]
    v_mfma_f32_32x32x16_bf16 v[224:239], a[88:91], a[44:47], v[224:239]
    s_nop 1
    v_cvt_pk_bf16_f32 v208, v208, v209
    v_cvt_pk_bf16_f32 v209, v210, v211
    v_cvt_pk_bf16_f32 v210, v212, v213
    v_cvt_pk_bf16_f32 v211, v214, v215
    v_cvt_pk_bf16_f32 v216, v216, v217
    v_cvt_pk_bf16_f32 v217, v218, v219
    v_cvt_pk_bf16_f32 v218, v220, v221
    v_mfma_f32_32x32x16_bf16 v[240:255], a[56:59], a[32:35], v[240:255]
    ds_write_b128 v21, v[208:211]
    v_cvt_pk_bf16_f32 v219, v222, v223
    v_mfma_f32_32x32x16_bf16 v[240:255], a[68:71], a[36:39], v[240:255]
    ds_write_b128 v21, v[216:219] offset:32
    v_mfma_f32_32x32x16_bf16 v[240:255], a[80:83], a[40:43], v[240:255]
    v_mfma_f32_32x32x16_bf16 v[240:255], a[92:95], a[44:47], v[240:255]
    v_cvt_pk_bf16_f32 v224, v224, v225
    v_cvt_pk_bf16_f32 v225, v226, v227
    v_cvt_pk_bf16_f32 v226, v228, v229
    v_cvt_pk_bf16_f32 v227, v230, v231
    v_cvt_pk_bf16_f32 v232, v232, v233
    v_cvt_pk_bf16_f32 v233, v234, v235
    v_cvt_pk_bf16_f32 v234, v236, v237
    v_cvt_pk_bf16_f32 v235, v238, v239
    ds_write_b128 v21, v[224:227] offset:128
    ds_write_b128 v21, v[232:235] offset:160
    s_add_u32 s63, s36, 8
    s_mul_i32 s70, s63, 0x15000
    s_add_u32 s70, s70, s42
    s_add_u32 s71, s70, 0xa80
    s_mul_i32 s63, s63, 0x15e0
    v_add_u32 v5, s63, v25
    v_add_u32 v6, s63, v26
    v_add_u32 v7, s63, v27
    s_mul_i32 s63, s37, 0x15000
    s_mul_i32 s64, s38, 0xa80
    s_add_u32 s72, s63, s64
    s_add_u32 s72, s72, s42
    s_add_u32 s72, s72, 0xfc000
    s_mul_i32 s63, s36, 0xaf0
    s_add_u32 s63, s63, 0x10680
    v_add_u32 v36, s63, v25
    v_add_u32 v37, s63, v26
    v_add_u32 v38, s63, v27
    v_cvt_pk_bf16_f32 v240, v240, v241
    v_cvt_pk_bf16_f32 v241, v242, v243
    v_cvt_pk_bf16_f32 v242, v244, v245
    v_cvt_pk_bf16_f32 v243, v246, v247
    ds_write_b128 v21, v[240:243] offset:256
    v_cvt_pk_bf16_f32 v248, v248, v249
    v_cvt_pk_bf16_f32 v249, v250, v251
    v_cvt_pk_bf16_f32 v250, v252, v253
    v_cvt_pk_bf16_f32 v251, v254, v255
    ds_write_b128 v21, v[248:251] offset:288
    s_waitcnt lgkmcnt(0)
    s_barrier
    ds_read_b128 v[112:115], v5
    ds_read_b128 v[116:119], v6
    ds_read_b128 v[120:123], v7
    ds_read_b128 v[124:127], v5 offset:2800
    ds_read_b128 v[128:131], v6 offset:2800
    ds_read_b128 v[132:135], v7 offset:2800
    ds_read_b128 v[48:51], v36
    ds_read_b128 v[52:55], v37
    ds_read_b128 v[56:59], v38
    s_waitcnt lgkmcnt(8)
    buffer_store_dwordx4 v[112:115], v28, s[32:35], s70 offen sc1
    s_waitcnt lgkmcnt(7)
    buffer_store_dwordx4 v[116:119], v28, s[32:35], s70 offen offset:896 sc1
    s_waitcnt lgkmcnt(6)
    buffer_store_dwordx4 v[120:123], v28, s[32:35], s70 offen offset:1792 sc1
    s_waitcnt lgkmcnt(5)
    buffer_store_dwordx4 v[124:127], v28, s[32:35], s71 offen sc1
    s_waitcnt lgkmcnt(4)
    buffer_store_dwordx4 v[128:131], v28, s[32:35], s71 offen offset:896 sc1
    s_waitcnt lgkmcnt(3)
    buffer_store_dwordx4 v[132:135], v28, s[32:35], s71 offen offset:1792 sc1
    s_waitcnt lgkmcnt(2)
    buffer_store_dwordx4 v[48:51], v28, s[32:35], s72 offen sc1
    s_waitcnt lgkmcnt(1)
    buffer_store_dwordx4 v[52:55], v28, s[32:35], s72 offen offset:896 sc1
    s_waitcnt lgkmcnt(0)
    buffer_store_dwordx4 v[56:59], v28, s[32:35], s72 offen offset:1792 sc1
L_END:
s_endpgm
.p2align 8
L_TAB:
.long 0x3000, 0x1d7b0, 0x20190, 0x22bf0
.long 0x3010, 0x1d880, 0x202e0, 0x22cc0
.long 0x3008, 0x1d990, 0x203f0, 0x22dd0
.long 0x3018, 0x1dae0, 0x204c0, 0x23bb0
.long 0x3180, 0x1d800, 0x20260, 0x22c40
.long 0x3190, 0x1d910, 0x20370, 0x22d50
.long 0x3188, 0x1da60, 0x20440, 0x22e20
.long 0x3198, 0x1db70, 0x20550, 0x23c00
.long 0x3340, 0x1e1b0, 0x20b90, 0x235f0
.long 0x3350, 0x1e280, 0x20ce0, 0x236c0
.long 0x3348, 0x1e390, 0x20df0, 0x237d0
.long 0x3358, 0x1e4e0, 0x20ec0, 0x245b0
.long 0x34c0, 0x1e200, 0x20c60, 0x23640
.long 0x34d0, 0x1e310, 0x20d70, 0x23750
.long 0x34c8, 0x1e460, 0x20e40, 0x23820
.long 0x34d8, 0x1e570, 0x20f50, 0x24600
.long 0x3020, 0x1dbf0, 0x205d0, 0x23c80
.long 0x3030, 0x1dcc0, 0x213b0, 0x23d90
.long 0x3028, 0x1ddd0, 0x21480, 0x23ee0
.long 0x3038, 0x1ebb0, 0x21590, 0x23ff0
.long 0x31a0, 0x1dc40, 0x20620, 0x23d10
.long 0x31b0, 0x1dd50, 0x21400, 0x23e60
.long 0x31a8, 0x1de20, 0x21510, 0x23f70
.long 0x31b8, 0x1ec00, 0x21660, 0x24040
.long 0x3360, 0x1e5f0, 0x20fd0, 0x24680
.long 0x3370, 0x1e6c0, 0x21db0, 0x24790
.long 0x3368, 0x1e7d0, 0x21e80, 0x248e0
.long 0x3378, 0x1f5b0, 0x21f90, 0x249f0
.long 0x34e0, 0x1e640, 0x21020, 0x24710
.long 0x34f0, 0x1e750, 0x21e00, 0x24860
.long 0x34e8, 0x1e820, 0x21f10, 0x24970
.long 0x34f8, 0x1f600, 0x22060, 0x24a40
.long 0x3600, 0x1d7a0, 0x20180, 0x22be0
.long 0x3610, 0x1d890, 0x202f0, 0x22cd0
.long 0x3608, 0x1d980, 0x203e0, 0x22dc0
.long 0x3618, 0x1daf0, 0x204d0, 0x23ba0
.long 0x3780, 0x1d810, 0x20270, 0x22c50
.long 0x3790, 0x1d900, 0x20360, 0x22d40
.long 0x3788, 0x1da70, 0x20450, 0x22e30
.long 0x3798, 0x1db60, 0x20540, 0x23c10
.long 0x3940, 0x1e1a0, 0x20b80, 0x235e0
.long 0x3950, 0x1e290, 0x20cf0, 0x236d0
.long 0x3948, 0x1e380, 0x20de0, 0x237c0
.long 0x3958, 0x1e4f0, 0x20ed0, 0x245a0
.long 0x3ac0, 0x1e210, 0x20c70, 0x23650
.long 0x3ad0, 0x1e300, 0x20d60, 0x23740
.long 0x3ac8, 0x1e470, 0x20e50, 0x23830
.long 0x3ad8, 0x1e560, 0x20f40, 0x24610
.long 0x3620, 0x1dbe0, 0x205c0, 0x23c90
.long 0x3630, 0x1dcd0, 0x213a0, 0x23d80
.long 0x3628, 0x1ddc0, 0x21490, 0x23ef0
.long 0x3638, 0x1eba0, 0x21580, 0x23fe0
.long 0x37a0, 0x1dc50, 0x20630, 0x23d00
.long 0x37b0, 0x1dd40, 0x21410, 0x23e70
.long 0x37a8, 0x1de30, 0x21500, 0x23f60
.long 0x37b8, 0x1ec10, 0x21670, 0x24050
.long 0x3960, 0x1e5e0, 0x20fc0, 0x24690
.long 0x3970, 0x1e6d0, 0x21da0, 0x24780
.long 0x3968, 0x1e7c0, 0x21e90, 0x248f0
.long 0x3978, 0x1f5a0, 0x21f80, 0x249e0
.long 0x3ae0, 0x1e650, 0x21030, 0x24700
.long 0x3af0, 0x1e740, 0x21e10, 0x24870
.long 0x3ae8, 0x1e830, 0x21f00, 0x24960
.long 0x3af8, 0x1f610, 0x22070, 0x24a50
.long 0x3040, 0x1d7f0, 0x201d0, 0x22bb0
.long 0x3050, 0x1d8c0, 0x202a0, 0x22c80
.long 0x3048, 0x1d9d0, 0x203b0, 0x22d90
.long 0x3058, 0x1daa0, 0x20480, 0x23bf0
.long 0x31c0, 0x1d840, 0x20220, 0x22c00
.long 0x31d0, 0x1d950, 0x20330, 0x22d10
.long 0x31c8, 0x1da20, 0x20400, 0x22e60
.long 0x31d8, 0x1db30, 0x20510, 0x23c40
.long 0x3300, 0x1e1f0, 0x20bd0, 0x235b0
.long 0x3310, 0x1e2c0, 0x20ca0, 0x23680
.long 0x3308, 0x1e3d0, 0x20db0, 0x23790
.long 0x3318, 0x1e4a0, 0x20e80, 0x245f0
.long 0x3480, 0x1e240, 0x20c20, 0x23600
.long 0x3490, 0x1e350, 0x20d30, 0x23710
.long 0x3488, 0x1e420, 0x20e00, 0x23860
.long 0x3498, 0x1e530, 0x20f10, 0x24640
.long 0x3060, 0x1dbb0, 0x20590, 0x23cc0
.long 0x3070, 0x1dc80, 0x213f0, 0x23dd0
.long 0x3068, 0x1dd90, 0x214c0, 0x23ea0
.long 0x3078, 0x1ebf0, 0x215d0, 0x23fb0
.long 0x31e0, 0x1dc00, 0x20660, 0x23d50
.long 0x31f0, 0x1dd10, 0x21440, 0x23e20
.long 0x31e8, 0x1de60, 0x21550, 0x23f30
.long 0x31f8, 0x1ec40, 0x21620, 0x24000
.long 0x3320, 0x1e5b0, 0x20f90, 0x246c0
.long 0x3330, 0x1e680, 0x21df0, 0x247d0
.long 0x3328, 0x1e790, 0x21ec0, 0x248a0
.long 0x3338, 0x1f5f0, 0x21fd0, 0x249b0
.long 0x34a0, 0x1e600, 0x21060, 0x24750
.long 0x34b0, 0x1e710, 0x21e40, 0x24820
.long 0x34a8, 0x1e860, 0x21f50, 0x24930
.long 0x34b8, 0x1f640, 0x22020, 0x24a00
.long 0x3640, 0x1d7e0, 0x201c0, 0x22ba0
.long 0x3650, 0x1d8d0, 0x202b0, 0x22c90
.long 0x3648, 0x1d9c0, 0x203a0, 0x22d80
.long 0x3658, 0x1dab0, 0x20490, 0x23be0
.long 0x37c0, 0x1d850, 0x20230, 0x22c10
.long 0x37d0, 0x1d940, 0x20320, 0x22d00
.long 0x37c8, 0x1da30, 0x20410, 0x22e70
.long 0x37d8, 0x1db20, 0x20500, 0x23c50
.long 0x3900, 0x1e1e0, 0x20bc0, 0x235a0
.long 0x3910, 0x1e2d0, 0x20cb0, 0x23690
.long 0x3908, 0x1e3c0, 0x20da0, 0x23780
.long 0x3918, 0x1e4b0, 0x20e90, 0x245e0
.long 0x3a80, 0x1e250, 0x20c30, 0x23610
.long 0x3a90, 0x1e340, 0x20d20, 0x23700
.long 0x3a88, 0x1e430, 0x20e10, 0x23870
.long 0x3a98, 0x1e520, 0x20f00, 0x24650
.long 0x3660, 0x1dba0, 0x20580, 0x23cd0
.long 0x3670, 0x1dc90, 0x213e0, 0x23dc0
.long 0x3668, 0x1dd80, 0x214d0, 0x23eb0
.long 0x3678, 0x1ebe0, 0x215c0, 0x23fa0
.long 0x37e0, 0x1dc10, 0x20670, 0x23d40
.long 0x37f0, 0x1dd00, 0x21450, 0x23e30
.long 0x37e8, 0x1de70, 0x21540, 0x23f20
.long 0x37f8, 0x1ec50, 0x21630, 0x24010
.long 0x3920, 0x1e5a0, 0x20f80, 0x246d0
.long 0x3930, 0x1e690, 0x21de0, 0x247c0
.long 0x3928, 0x1e780, 0x21ed0, 0x248b0
.long 0x3938, 0x1f5e0, 0x21fc0, 0x249a0
.long 0x3aa0, 0x1e610, 0x21070, 0x24740
.long 0x3ab0, 0x1e700, 0x21e50, 0x24830
.long 0x3aa8, 0x1e870, 0x21f40, 0x24920
.long 0x3ab8, 0x1f650, 0x22030, 0x24a10
.long 0x0, 0x1ec80, 0x216e0, 0x240c0
.long 0x10, 0x1ed90, 0x217f0, 0x241d0
.long 0x8, 0x1eee0, 0x218c0, 0x24fb0
.long 0x18, 0x1eff0, 0x219d0, 0x25080
.long 0x180, 0x1ed10, 0x21770, 0x24150
.long 0x190, 0x1ee60, 0x21840, 0x24220
.long 0x188, 0x1ef70, 0x21950, 0x25000
.long 0x198, 0x1f040, 0x21a20, 0x25110
.long 0x340, 0x1f680, 0x220e0, 0x24ac0
.long 0x350, 0x1f790, 0x221f0, 0x24bd0
.long 0x348, 0x1f8e0, 0x222c0, 0x259b0
.long 0x358, 0x1f9f0, 0x223d0, 0x25a80
.long 0x4c0, 0x1f710, 0x22170, 0x24b50
.long 0x4d0, 0x1f860, 0x22240, 0x24c20
.long 0x4c8, 0x1f970, 0x22350, 0x25a00
.long 0x4d8, 0x1fa40, 0x22420, 0x25b10
.long 0x20, 0x1f0c0, 0x227b0, 0x25190
.long 0x30, 0x1f1d0, 0x22880, 0x252e0
.long 0x28, 0x1ffb0, 0x22990, 0x253f0
.long 0x38, 0x20080, 0x22ae0, 0x254c0
.long 0x1a0, 0x1f150, 0x22800, 0x25260
.long 0x1b0, 0x1f220, 0x22910, 0x25370
.long 0x1a8, 0x20000, 0x22a60, 0x25440
.long 0x1b8, 0x20110, 0x22b70, 0x25550
.long 0x360, 0x1fac0, 0x231b0, 0x25b90
.long 0x370, 0x1fbd0, 0x23280, 0x25ce0
.long 0x368, 0x209b0, 0x23390, 0x25df0
.long 0x378, 0x20a80, 0x234e0, 0x25ec0
.long 0x4e0, 0x1fb50, 0x23200, 0x25c60
.long 0x4f0, 0x1fc20, 0x23310, 0x25d70
.long 0x4e8, 0x20a00, 0x23460, 0x25e40
.long 0x4f8, 0x20b10, 0x23570, 0x25f50
.long 0x600, 0x1ec90, 0x216f0, 0x240d0
.long 0x610, 0x1ed80, 0x217e0, 0x241c0
.long 0x608, 0x1eef0, 0x218d0, 0x24fa0
.long 0x618, 0x1efe0, 0x219c0, 0x25090
.long 0x780, 0x1ed00, 0x21760, 0x24140
.long 0x790, 0x1ee70, 0x21850, 0x24230
.long 0x788, 0x1ef60, 0x21940, 0x25010
.long 0x798, 0x1f050, 0x21a30, 0x25100
.long 0x940, 0x1f690, 0x220f0, 0x24ad0
.long 0x950, 0x1f780, 0x221e0, 0x24bc0
.long 0x948, 0x1f8f0, 0x222d0, 0x259a0
.long 0x958, 0x1f9e0, 0x223c0, 0x25a90
.long 0xac0, 0x1f700, 0x22160, 0x24b40
.long 0xad0, 0x1f870, 0x22250, 0x24c30
.long 0xac8, 0x1f960, 0x22340, 0x25a10
.long 0xad8, 0x1fa50, 0x22430, 0x25b00
.long 0x620, 0x1f0d0, 0x227a0, 0x25180
.long 0x630, 0x1f1c0, 0x22890, 0x252f0
.long 0x628, 0x1ffa0, 0x22980, 0x253e0
.long 0x638, 0x20090, 0x22af0, 0x254d0
.long 0x7a0, 0x1f140, 0x22810, 0x25270
.long 0x7b0, 0x1f230, 0x22900, 0x25360
.long 0x7a8, 0x20010, 0x22a70, 0x25450
.long 0x7b8, 0x20100, 0x22b60, 0x25540
.long 0x960, 0x1fad0, 0x231a0, 0x25b80
.long 0x970, 0x1fbc0, 0x23290, 0x25cf0
.long 0x968, 0x209a0, 0x23380, 0x25de0
.long 0x978, 0x20a90, 0x234f0, 0x25ed0
.long 0xae0, 0x1fb40, 0x23210, 0x25c70
.long 0xaf0, 0x1fc30, 0x23300, 0x25d60
.long 0xae8, 0x20a10, 0x23470, 0x25e50
.long 0xaf8, 0x20b00, 0x23560, 0x25f40
.long 0x40, 0x1ecc0, 0x216a0, 0x24080
.long 0x50, 0x1edd0, 0x217b0, 0x24190
.long 0x48, 0x1eea0, 0x21880, 0x24ff0
.long 0x58, 0x1efb0, 0x21990, 0x250c0
.long 0x1c0, 0x1ed50, 0x21730, 0x24110
.long 0x1d0, 0x1ee20, 0x21800, 0x24260
.long 0x1c8, 0x1ef30, 0x21910, 0x25040
.long 0x1d8, 0x1f000, 0x21a60, 0x25150
.long 0x300, 0x1f6c0, 0x220a0, 0x24a80
.long 0x310, 0x1f7d0, 0x221b0, 0x24b90
.long 0x308, 0x1f8a0, 0x22280, 0x259f0
.long 0x318, 0x1f9b0, 0x22390, 0x25ac0
.long 0x480, 0x1f750, 0x22130, 0x24b10
.long 0x490, 0x1f820, 0x22200, 0x24c60
.long 0x488, 0x1f930, 0x22310, 0x25a40
.long 0x498, 0x1fa00, 0x22460, 0x25b50
.long 0x60, 0x1f080, 0x227f0, 0x251d0
.long 0x70, 0x1f190, 0x228c0, 0x252a0
.long 0x68, 0x1fff0, 0x229d0, 0x253b0
.long 0x78, 0x200c0, 0x22aa0, 0x25480
.long 0x1e0, 0x1f110, 0x22840, 0x25220
.long 0x1f0, 0x1f260, 0x22950, 0x25330
.long 0x1e8, 0x20040, 0x22a20, 0x25400
.long 0x1f8, 0x20150, 0x22b30, 0x25510
.long 0x320, 0x1fa80, 0x231f0, 0x25bd0
.long 0x330, 0x1fb90, 0x232c0, 0x25ca0
.long 0x328, 0x209f0, 0x233d0, 0x25db0
.long 0x338, 0x20ac0, 0x234a0, 0x25e80
.long 0x4a0, 0x1fb10, 0x23240, 0x25c20
.long 0x4b0, 0x1fc60, 0x23350, 0x25d30
.long 0x4a8, 0x20a40, 0x23420, 0x25e00
.long 0x4b8, 0x20b50, 0x23530, 0x25f10
.long 0x640, 0x1ecd0, 0x216b0, 0x24090
.long 0x650, 0x1edc0, 0x217a0, 0x24180
.long 0x648, 0x1eeb0, 0x21890, 0x24fe0
.long 0x658, 0x1efa0, 0x21980, 0x250d0
.long 0x7c0, 0x1ed40, 0x21720, 0x24100
.long 0x7d0, 0x1ee30, 0x21810, 0x24270
.long 0x7c8, 0x1ef20, 0x21900, 0x25050
.long 0x7d8, 0x1f010, 0x21a70, 0x25140
.long 0x900, 0x1f6d0, 0x220b0, 0x24a90
.long 0x910, 0x1f7c0, 0x221a0, 0x24b80
.long 0x908, 0x1f8b0, 0x22290, 0x259e0
.long 0x918, 0x1f9a0, 0x22380, 0x25ad0
.long 0xa80, 0x1f740, 0x22120, 0x24b00
.long 0xa90, 0x1f830, 0x22210, 0x24c70
.long 0xa88, 0x1f920, 0x22300, 0x25a50
.long 0xa98, 0x1fa10, 0x22470, 0x25b40
.long 0x660, 0x1f090, 0x227e0, 0x251c0
.long 0x670, 0x1f180, 0x228d0, 0x252b0
.long 0x668, 0x1ffe0, 0x229c0, 0x253a0
.long 0x678, 0x200d0, 0x22ab0, 0x25490
.long 0x7e0, 0x1f100, 0x22850, 0x25230
.long 0x7f0, 0x1f270, 0x22940, 0x25320
.long 0x7e8, 0x20050, 0x22a30, 0x25410
.long 0x7f8, 0x20140, 0x22b20, 0x25500
.long 0x920, 0x1fa90, 0x231e0, 0x25bc0
.long 0x930, 0x1fb80, 0x232d0, 0x25cb0
.long 0x928, 0x209e0, 0x233c0, 0x25da0
.long 0x938, 0x20ad0, 0x234b0, 0x25e90
.long 0xaa0, 0x1fb00, 0x23250, 0x25c30
.long 0xab0, 0x1fc70, 0x23340, 0x25d20
.long 0xaa8, 0x20a50, 0x23430, 0x25e10
.long 0xab8, 0x20b40, 0x23520, 0x25f00
.long 0x1a5c0, 0x20380, 0x1d790, 0x201b0
.long 0x1a8e0, 0x206a0, 0x1d8a0, 0x202c0
.long 0x1ac00, 0x209c0, 0x1d9b0, 0x203d0
.long 0x1af20, 0x222c0, 0x1dac0, 0x204e0
.long 0x1a750, 0x20510, 0x1d820, 0x20240
.long 0x1aa70, 0x20830, 0x1d930, 0x20350
.long 0x1ad90, 0x20b50, 0x1da40, 0x20460
.long 0x1b0b0, 0x22450, 0x1db50, 0x20570
.long 0x1bba0, 0x21960, 0x1e190, 0x20bb0
.long 0x1bec0, 0x21c80, 0x1e2a0, 0x20cc0
.long 0x1c1e0, 0x21fa0, 0x1e3b0, 0x20dd0
.long 0x1c500, 0x238a0, 0x1e4c0, 0x20ee0
.long 0x1bd30, 0x21af0, 0x1e220, 0x20c40
.long 0x1c050, 0x21e10, 0x1e330, 0x20d50
.long 0x1c370, 0x22130, 0x1e440, 0x20e60
.long 0x1c690, 0x23a30, 0x1e550, 0x20f70
.long 0x1b240, 0x225e0, 0x1dbd0, 0x205f0
.long 0x1cb40, 0x22900, 0x1dce0, 0x21390
.long 0x1ce60, 0x22c20, 0x1ddf0, 0x214a0
.long 0x1d180, 0x22f40, 0x1eb90, 0x215b0
.long 0x1b3d0, 0x22770, 0x1dc60, 0x20600
.long 0x1ccd0, 0x22a90, 0x1dd70, 0x21420
.long 0x1cff0, 0x22db0, 0x1de00, 0x21530
.long 0x1d310, 0x230d0, 0x1ec20, 0x21640
.long 0x1c820, 0x23bc0, 0x1e5d0, 0x20ff0
.long 0x1e120, 0x23ee0, 0x1e6e0, 0x21d90
.long 0x1e440, 0x24200, 0x1e7f0, 0x21ea0
.long 0x1e760, 0x24520, 0x1f590, 0x21fb0
.long 0x1c9b0, 0x23d50, 0x1e660, 0x21000
.long 0x1e2b0, 0x24070, 0x1e770, 0x21e20
.long 0x1e5d0, 0x24390, 0x1e800, 0x21f30
.long 0x1e8f0, 0x246b0, 0x1f620, 0x22040
.long 0x1a5d0, 0x20390, 0x1d780, 0x201a0
.long 0x1a8f0, 0x206b0, 0x1d8b0, 0x202d0
.long 0x1ac10, 0x209d0, 0x1d9a0, 0x203c0
.long 0x1af30, 0x222d0, 0x1dad0, 0x204f0
.long 0x1a760, 0x20520, 0x1d830, 0x20250
.long 0x1aa80, 0x20840, 0x1d920, 0x20340
.long 0x1ada0, 0x20b60, 0x1da50, 0x20470
.long 0x1b0c0, 0x22460, 0x1db40, 0x20560
.long 0x1bbb0, 0x21970, 0x1e180, 0x20ba0
.long 0x1bed0, 0x21c90, 0x1e2b0, 0x20cd0
.long 0x1c1f0, 0x21fb0, 0x1e3a0, 0x20dc0
.long 0x1c510, 0x238b0, 0x1e4d0, 0x20ef0
.long 0x1bd40, 0x21b00, 0x1e230, 0x20c50
.long 0x1c060, 0x21e20, 0x1e320, 0x20d40
.long 0x1c380, 0x22140, 0x1e450, 0x20e70
.long 0x1c6a0, 0x23a40, 0x1e540, 0x20f60
.long 0x1b250, 0x225f0, 0x1dbc0, 0x205e0
.long 0x1cb50, 0x22910, 0x1dcf0, 0x21380
.long 0x1ce70, 0x22c30, 0x1dde0, 0x214b0
.long 0x1d190, 0x22f50, 0x1eb80, 0x215a0
.long 0x1b3e0, 0x22780, 0x1dc70, 0x20610
.long 0x1cce0, 0x22aa0, 0x1dd60, 0x21430
.long 0x1d000, 0x22dc0, 0x1de10, 0x21520
.long 0x1d320, 0x230e0, 0x1ec30, 0x21650
.long 0x1c830, 0x23bd0, 0x1e5c0, 0x20fe0
.long 0x1e130, 0x23ef0, 0x1e6f0, 0x21d80
.long 0x1e450, 0x24210, 0x1e7e0, 0x21eb0
.long 0x1e770, 0x24530, 0x1f580, 0x21fa0
.long 0x1c9c0, 0x23d60, 0x1e670, 0x21010
.long 0x1e2c0, 0x24080, 0x1e760, 0x21e30
.long 0x1e5e0, 0x243a0, 0x1e810, 0x21f20
.long 0x1e900, 0x246c0, 0x1f630, 0x22050
.long 0x1a600, 0x203c0, 0x1d7d0, 0x201f0
.long 0x1a920, 0x206e0, 0x1d8e0, 0x20280
.long 0x1ac40, 0x20a00, 0x1d9f0, 0x20390
.long 0x1af60, 0x22300, 0x1da80, 0x204a0
.long 0x1a790, 0x20550, 0x1d860, 0x20200
.long 0x1aab0, 0x20870, 0x1d970, 0x20310
.long 0x1add0, 0x20b90, 0x1da00, 0x20420
.long 0x1b0f0, 0x22490, 0x1db10, 0x20530
.long 0x1bbe0, 0x219a0, 0x1e1d0, 0x20bf0
.long 0x1bf00, 0x21cc0, 0x1e2e0, 0x20c80
.long 0x1c220, 0x21fe0, 0x1e3f0, 0x20d90
.long 0x1c540, 0x238e0, 0x1e480, 0x20ea0
.long 0x1bd70, 0x21b30, 0x1e260, 0x20c00
.long 0x1c090, 0x21e50, 0x1e370, 0x20d10
.long 0x1c3b0, 0x22170, 0x1e400, 0x20e20
.long 0x1c6d0, 0x23a70, 0x1e510, 0x20f30
.long 0x1b280, 0x22620, 0x1db90, 0x205b0
.long 0x1cb80, 0x22940, 0x1dca0, 0x213d0
.long 0x1cea0, 0x22c60, 0x1ddb0, 0x214e0
.long 0x1d1c0, 0x22f80, 0x1ebd0, 0x215f0
.long 0x1b410, 0x227b0, 0x1dc20, 0x20640
.long 0x1cd10, 0x22ad0, 0x1dd30, 0x21460
.long 0x1d030, 0x22df0, 0x1de40, 0x21570
.long 0x1d350, 0x23110, 0x1ec60, 0x21600
.long 0x1c860, 0x23c00, 0x1e590, 0x20fb0
.long 0x1e160, 0x23f20, 0x1e6a0, 0x21dd0
.long 0x1e480, 0x24240, 0x1e7b0, 0x21ee0
.long 0x1e7a0, 0x24560, 0x1f5d0, 0x21ff0
.long 0x1c9f0, 0x23d90, 0x1e620, 0x21040
.long 0x1e2f0, 0x240b0, 0x1e730, 0x21e60
.long 0x1e610, 0x243d0, 0x1e840, 0x21f70
.long 0x1e930, 0x246f0, 0x1f660, 0x22000
.long 0x1a610, 0x203d0, 0x1d7c0, 0x201e0
.long 0x1a930, 0x206f0, 0x1d8f0, 0x20290
.long 0x1ac50, 0x20a10, 0x1d9e0, 0x20380
.long 0x1af70, 0x22310, 0x1da90, 0x204b0
.long 0x1a7a0, 0x20560, 0x1d870, 0x20210
.long 0x1aac0, 0x20880, 0x1d960, 0x20300
.long 0x1ade0, 0x20ba0, 0x1da10, 0x20430
.long 0x1b100, 0x224a0, 0x1db00, 0x20520
.long 0x1bbf0, 0x219b0, 0x1e1c0, 0x20be0
.long 0x1bf10, 0x21cd0, 0x1e2f0, 0x20c90
.long 0x1c230, 0x21ff0, 0x1e3e0, 0x20d80
.long 0x1c550, 0x238f0, 0x1e490, 0x20eb0
.long 0x1bd80, 0x21b40, 0x1e270, 0x20c10
.long 0x1c0a0, 0x21e60, 0x1e360, 0x20d00
.long 0x1c3c0, 0x22180, 0x1e410, 0x20e30
.long 0x1c6e0, 0x23a80, 0x1e500, 0x20f20
.long 0x1b290, 0x22630, 0x1db80, 0x205a0
.long 0x1cb90, 0x22950, 0x1dcb0, 0x213c0
.long 0x1ceb0, 0x22c70, 0x1dda0, 0x214f0
.long 0x1d1d0, 0x22f90, 0x1ebc0, 0x215e0
.long 0x1b420, 0x227c0, 0x1dc30, 0x20650
.long 0x1cd20, 0x22ae0, 0x1dd20, 0x21470
.long 0x1d040, 0x22e00, 0x1de50, 0x21560
.long 0x1d360, 0x23120, 0x1ec70, 0x21610
.long 0x1c870, 0x23c10, 0x1e580, 0x20fa0
.long 0x1e170, 0x23f30, 0x1e6b0, 0x21dc0
.long 0x1e490, 0x24250, 0x1e7a0, 0x21ef0
.long 0x1e7b0, 0x24570, 0x1f5c0, 0x21fe0
.long 0x1ca00, 0x23da0, 0x1e630, 0x21050
.long 0x1e300, 0x240c0, 0x1e720, 0x21e70
.long 0x1e620, 0x243e0, 0x1e850, 0x21f60
.long 0x1e940, 0x24700, 0x1f670, 0x22010
.long 0x1d4a0, 0x23260, 0x1eca0, 0x216c0
.long 0x1d7c0, 0x23580, 0x1edb0, 0x217d0
.long 0x1dae0, 0x24e80, 0x1eec0, 0x218e0
.long 0x1de00, 0x251a0, 0x1efd0, 0x219f0
.long 0x1d630, 0x233f0, 0x1ed30, 0x21750
.long 0x1d950, 0x23710, 0x1ee40, 0x21860
.long 0x1dc70, 0x25010, 0x1ef50, 0x21970
.long 0x1df90, 0x25330, 0x1f060, 0x21a00
.long 0x1ea80, 0x24840, 0x1f6a0, 0x220c0
.long 0x1eda0, 0x24b60, 0x1f7b0, 0x221d0
.long 0x1f0c0, 0x26460, 0x1f8c0, 0x222e0
.long 0x1f3e0, 0x26780, 0x1f9d0, 0x223f0
.long 0x1ec10, 0x249d0, 0x1f730, 0x22150
.long 0x1ef30, 0x24cf0, 0x1f840, 0x22260
.long 0x1f250, 0x265f0, 0x1f950, 0x22370
.long 0x1f570, 0x26910, 0x1fa60, 0x22400
.long 0x1f700, 0x254c0, 0x1f0e0, 0x22790
.long 0x1fa20, 0x257e0, 0x1f1f0, 0x228a0
.long 0x1fd40, 0x25b00, 0x1ff90, 0x229b0
.long 0x20060, 0x25e20, 0x200a0, 0x22ac0
.long 0x1f890, 0x25650, 0x1f170, 0x22820
.long 0x1fbb0, 0x25970, 0x1f200, 0x22930
.long 0x1fed0, 0x25c90, 0x20020, 0x22a40
.long 0x201f0, 0x25fb0, 0x20130, 0x22b50
.long 0x20ce0, 0x26aa0, 0x1fae0, 0x23190
.long 0x21000, 0x26dc0, 0x1fbf0, 0x232a0
.long 0x21320, 0x270e0, 0x20990, 0x233b0
.long 0x21640, 0x27400, 0x20aa0, 0x234c0
.long 0x20e70, 0x26c30, 0x1fb70, 0x23220
.long 0x21190, 0x26f50, 0x1fc00, 0x23330
.long 0x214b0, 0x27270, 0x20a20, 0x23440
.long 0x217d0, 0x27590, 0x20b30, 0x23550
.long 0x1d4b0, 0x23270, 0x1ecb0, 0x216d0
.long 0x1d7d0, 0x23590, 0x1eda0, 0x217c0
.long 0x1daf0, 0x24e90, 0x1eed0, 0x218f0
.long 0x1de10, 0x251b0, 0x1efc0, 0x219e0
.long 0x1d640, 0x23400, 0x1ed20, 0x21740
.long 0x1d960, 0x23720, 0x1ee50, 0x21870
.long 0x1dc80, 0x25020, 0x1ef40, 0x21960
.long 0x1dfa0, 0x25340, 0x1f070, 0x21a10
.long 0x1ea90, 0x24850, 0x1f6b0, 0x220d0
.long 0x1edb0, 0x24b70, 0x1f7a0, 0x221c0
.long 0x1f0d0, 0x26470, 0x1f8d0, 0x222f0
.long 0x1f3f0, 0x26790, 0x1f9c0, 0x223e0
.long 0x1ec20, 0x249e0, 0x1f720, 0x22140
.long 0x1ef40, 0x24d00, 0x1f850, 0x22270
.long 0x1f260, 0x26600, 0x1f940, 0x22360
.long 0x1f580, 0x26920, 0x1fa70, 0x22410
.long 0x1f710, 0x254d0, 0x1f0f0, 0x22780
.long 0x1fa30, 0x257f0, 0x1f1e0, 0x228b0
.long 0x1fd50, 0x25b10, 0x1ff80, 0x229a0
.long 0x20070, 0x25e30, 0x200b0, 0x22ad0
.long 0x1f8a0, 0x25660, 0x1f160, 0x22830
.long 0x1fbc0, 0x25980, 0x1f210, 0x22920
.long 0x1fee0, 0x25ca0, 0x20030, 0x22a50
.long 0x20200, 0x25fc0, 0x20120, 0x22b40
.long 0x20cf0, 0x26ab0, 0x1faf0, 0x23180
.long 0x21010, 0x26dd0, 0x1fbe0, 0x232b0
.long 0x21330, 0x270f0, 0x20980, 0x233a0
.long 0x21650, 0x27410, 0x20ab0, 0x234d0
.long 0x20e80, 0x26c40, 0x1fb60, 0x23230
.long 0x211a0, 0x26f60, 0x1fc10, 0x23320
.long 0x214c0, 0x27280, 0x20a30, 0x23450
.long 0x217e0, 0x275a0, 0x20b20, 0x23540
.long 0x1d4e0, 0x232a0, 0x1ece0, 0x21680
.long 0x1d800, 0x235c0, 0x1edf0, 0x21790
.long 0x1db20, 0x24ec0, 0x1ee80, 0x218a0
.long 0x1de40, 0x251e0, 0x1ef90, 0x219b0
.long 0x1d670, 0x23430, 0x1ed70, 0x21710
.long 0x1d990, 0x23750, 0x1ee00, 0x21820
.long 0x1dcb0, 0x25050, 0x1ef10, 0x21930
.long 0x1dfd0, 0x25370, 0x1f020, 0x21a40
.long 0x1eac0, 0x24880, 0x1f6e0, 0x22080
.long 0x1ede0, 0x24ba0, 0x1f7f0, 0x22190
.long 0x1f100, 0x264a0, 0x1f880, 0x222a0
.long 0x1f420, 0x267c0, 0x1f990, 0x223b0
.long 0x1ec50, 0x24a10, 0x1f770, 0x22110
.long 0x1ef70, 0x24d30, 0x1f800, 0x22220
.long 0x1f290, 0x26630, 0x1f910, 0x22330
.long 0x1f5b0, 0x26950, 0x1fa20, 0x22440
.long 0x1f740, 0x25500, 0x1f0a0, 0x227d0
.long 0x1fa60, 0x25820, 0x1f1b0, 0x228e0
.long 0x1fd80, 0x25b40, 0x1ffd0, 0x229f0
.long 0x200a0, 0x25e60, 0x200e0, 0x22a80
.long 0x1f8d0, 0x25690, 0x1f130, 0x22860
.long 0x1fbf0, 0x259b0, 0x1f240, 0x22970
.long 0x1ff10, 0x25cd0, 0x20060, 0x22a00
.long 0x20230, 0x25ff0, 0x20170, 0x22b10
.long 0x20d20, 0x26ae0, 0x1faa0, 0x231d0
.long 0x21040, 0x26e00, 0x1fbb0, 0x232e0
.long 0x21360, 0x27120, 0x209d0, 0x233f0
.long 0x21680, 0x27440, 0x20ae0, 0x23480
.long 0x20eb0, 0x26c70, 0x1fb30, 0x23260
.long 0x211d0, 0x26f90, 0x1fc40, 0x23370
.long 0x214f0, 0x272b0, 0x20a60, 0x23400
.long 0x21810, 0x275d0, 0x20b70, 0x23510
.long 0x1d4f0, 0x232b0, 0x1ecf0, 0x21690
.long 0x1d810, 0x235d0, 0x1ede0, 0x21780
.long 0x1db30, 0x24ed0, 0x1ee90, 0x218b0
.long 0x1de50, 0x251f0, 0x1ef80, 0x219a0
.long 0x1d680, 0x23440, 0x1ed60, 0x21700
.long 0x1d9a0, 0x23760, 0x1ee10, 0x21830
.long 0x1dcc0, 0x25060, 0x1ef00, 0x21920
.long 0x1dfe0, 0x25380, 0x1f030, 0x21a50
.long 0x1ead0, 0x24890, 0x1f6f0, 0x22090
.long 0x1edf0, 0x24bb0, 0x1f7e0, 0x22180
.long 0x1f110, 0x264b0, 0x1f890, 0x222b0
.long 0x1f430, 0x267d0, 0x1f980, 0x223a0
.long 0x1ec60, 0x24a20, 0x1f760, 0x22100
.long 0x1ef80, 0x24d40, 0x1f810, 0x22230
.long 0x1f2a0, 0x26640, 0x1f900, 0x22320
.long 0x1f5c0, 0x26960, 0x1fa30, 0x22450
.long 0x1f750, 0x25510, 0x1f0b0, 0x227c0
.long 0x1fa70, 0x25830, 0x1f1a0, 0x228f0
.long 0x1fd90, 0x25b50, 0x1ffc0, 0x229e0
.long 0x200b0, 0x25e70, 0x200f0, 0x22a90
.long 0x1f8e0, 0x256a0, 0x1f120, 0x22870
.long 0x1fc00, 0x259c0, 0x1f250, 0x22960
.long 0x1ff20, 0x25ce0, 0x20070, 0x22a10
.long 0x20240, 0x26000, 0x20160, 0x22b00
.long 0x20d30, 0x26af0, 0x1fab0, 0x231c0
.long 0x21050, 0x26e10, 0x1fba0, 0x232f0
.long 0x21370, 0x27130, 0x209c0, 0x233e0
.long 0x21690, 0x27450, 0x20af0, 0x23490
.long 0x20ec0, 0x26c80, 0x1fb20, 0x23270
.long 0x211e0, 0x26fa0, 0x1fc50, 0x23360
.long 0x21500, 0x272c0, 0x20a70, 0x23410
.long 0x21820, 0x275e0, 0x20b60, 0x23500
.long 0x22bd0, 0x14800, 0x14ba0, 0x14f40
.long 0x22ce0, 0x14810, 0x14bb0, 0x14f50
.long 0x22df0, 0x14820, 0x14bc0, 0x14f60
.long 0x23b90, 0x14830, 0x14bd0, 0x14f70
.long 0x22c60, 0x14840, 0x14be0, 0x14f80
.long 0x22d70, 0x14850, 0x14bf0, 0x14f90
.long 0x22e00, 0x14860, 0x14c00, 0x14fa0
.long 0x23c20, 0x14870, 0x14c10, 0x14fb0
.long 0x235d0, 0x14880, 0x14c20, 0x14fd0
.long 0x236e0, 0x14890, 0x14c30, 0x14fe0
.long 0x237f0, 0x148a0, 0x14c40, 0x14ff0
.long 0x24590, 0x148b0, 0x14c50, 0x15000
.long 0x23660, 0x148c0, 0x14c60, 0x15010
.long 0x23770, 0x148d0, 0x14c70, 0x15020
.long 0x23800, 0x148e0, 0x14c80, 0x15030
.long 0x24620, 0x148f0, 0x14c90, 0x15040
.long 0x23ca0, 0x14900, 0x14cb0, 0x15050
.long 0x23db0, 0x14910, 0x14cc0, 0x15060
.long 0x23ec0, 0x14920, 0x14cd0, 0x15070
.long 0x23fd0, 0x14930, 0x14ce0, 0x15080
.long 0x23d30, 0x14940, 0x14cf0, 0x15090
.long 0x23e40, 0x14950, 0x14d00, 0x150a0
.long 0x23f50, 0x14960, 0x14d10, 0x150b0
.long 0x24060, 0x14970, 0x14d20, 0x150c0
.long 0x246a0, 0x14990, 0x14d30, 0x150d0
.long 0x247b0, 0x149a0, 0x14d40, 0x150e0
.long 0x248c0, 0x149b0, 0x14d50, 0x150f0
.long 0x249d0, 0x149c0, 0x14d60, 0x15100
.long 0x24730, 0x149d0, 0x14d70, 0x15110
.long 0x24840, 0x149e0, 0x14d80, 0x15120
.long 0x24950, 0x149f0, 0x14d90, 0x15130
.long 0x24a60, 0x14a00, 0x14da0, 0x15140
.long 0x22bc0, 0x14a10, 0x14db0, 0x15160
.long 0x22cf0, 0x14a20, 0x14dc0, 0x15170
.long 0x22de0, 0x14a30, 0x14dd0, 0x15180
.long 0x23b80, 0x14a40, 0x14de0, 0x15190
.long 0x22c70, 0x14a50, 0x14df0, 0x151a0
.long 0x22d60, 0x14a60, 0x14e00, 0x151b0
.long 0x22e10, 0x14a70, 0x14e10, 0x151c0
.long 0x23c30, 0x14a80, 0x14e20, 0x151d0
.long 0x235c0, 0x14a90, 0x14e40, 0x151e0
.long 0x236f0, 0x14aa0, 0x14e50, 0x151f0
.long 0x237e0, 0x14ab0, 0x14e60, 0x15200
.long 0x24580, 0x14ac0, 0x14e70, 0x15210
.long 0x23670, 0x14ad0, 0x14e80, 0x15220
.long 0x23760, 0x14ae0, 0x14e90, 0x15230
.long 0x23810, 0x14af0, 0x14ea0, 0x15240
.long 0x24630, 0x14b00, 0x14eb0, 0x15250
.long 0x23cb0, 0x14b20, 0x14ec0, 0x15260
.long 0x23da0, 0x14b30, 0x14ed0, 0x15270
.long 0x23ed0, 0x14b40, 0x14ee0, 0x15280
.long 0x23fc0, 0x14b50, 0x14ef0, 0x15290
.long 0x23d20, 0x14b60, 0x14f00, 0x152a0
.long 0x23e50, 0x14b70, 0x14f10, 0x152b0
.long 0x23f40, 0x14b80, 0x14f20, 0x152c0
.long 0x24070, 0x14b90, 0x14f30, 0x152d0
.long 0x246b0, 0x14ba0, 0x14f40, 0x152f0
.long 0x247a0, 0x14bb0, 0x14f50, 0x15300
.long 0x248d0, 0x14bc0, 0x14f60, 0x15310
.long 0x249c0, 0x14bd0, 0x14f70, 0x15320
.long 0x24720, 0x14be0, 0x14f80, 0x15330
.long 0x24850, 0x14bf0, 0x14f90, 0x15340
.long 0x24940, 0x14c00, 0x14fa0, 0x15350
.long 0x24a70, 0x14c10, 0x14fb0, 0x15360
.long 0x22b90, 0x14800, 0x14ba0, 0x14f40
.long 0x22ca0, 0x14810, 0x14bb0, 0x14f50
.long 0x22db0, 0x14820, 0x14bc0, 0x14f60
.long 0x23bd0, 0x14830, 0x14bd0, 0x14f70
.long 0x22c20, 0x14840, 0x14be0, 0x14f80
.long 0x22d30, 0x14850, 0x14bf0, 0x14f90
.long 0x22e40, 0x14860, 0x14c00, 0x14fa0
.long 0x23c60, 0x14870, 0x14c10, 0x14fb0
.long 0x23590, 0x14880, 0x14c20, 0x14fd0
.long 0x236a0, 0x14890, 0x14c30, 0x14fe0
.long 0x237b0, 0x148a0, 0x14c40, 0x14ff0
.long 0x245d0, 0x148b0, 0x14c50, 0x15000
.long 0x23620, 0x148c0, 0x14c60, 0x15010
.long 0x23730, 0x148d0, 0x14c70, 0x15020
.long 0x23840, 0x148e0, 0x14c80, 0x15030
.long 0x24660, 0x148f0, 0x14c90, 0x15040
.long 0x23ce0, 0x14900, 0x14cb0, 0x15050
.long 0x23df0, 0x14910, 0x14cc0, 0x15060
.long 0x23e80, 0x14920, 0x14cd0, 0x15070
.long 0x23f90, 0x14930, 0x14ce0, 0x15080
.long 0x23d70, 0x14940, 0x14cf0, 0x15090
.long 0x23e00, 0x14950, 0x14d00, 0x150a0
.long 0x23f10, 0x14960, 0x14d10, 0x150b0
.long 0x24020, 0x14970, 0x14d20, 0x150c0
.long 0x246e0, 0x14990, 0x14d30, 0x150d0
.long 0x247f0, 0x149a0, 0x14d40, 0x150e0
.long 0x24880, 0x149b0, 0x14d50, 0x150f0
.long 0x24990, 0x149c0, 0x14d60, 0x15100
.long 0x24770, 0x149d0, 0x14d70, 0x15110
.long 0x24800, 0x149e0, 0x14d80, 0x15120
.long 0x24910, 0x149f0, 0x14d90, 0x15130
.long 0x24a20, 0x14a00, 0x14da0, 0x15140
.long 0x22b80, 0x14a10, 0x14db0, 0x15160
.long 0x22cb0, 0x14a20, 0x14dc0, 0x15170
.long 0x22da0, 0x14a30, 0x14dd0, 0x15180
.long 0x23bc0, 0x14a40, 0x14de0, 0x15190
.long 0x22c30, 0x14a50, 0x14df0, 0x151a0
.long 0x22d20, 0x14a60, 0x14e00, 0x151b0
.long 0x22e50, 0x14a70, 0x14e10, 0x151c0
.long 0x23c70, 0x14a80, 0x14e20, 0x151d0
.long 0x23580, 0x14a90, 0x14e40, 0x151e0
.long 0x236b0, 0x14aa0, 0x14e50, 0x151f0
.long 0x237a0, 0x14ab0, 0x14e60, 0x15200
.long 0x245c0, 0x14ac0, 0x14e70, 0x15210
.long 0x23630, 0x14ad0, 0x14e80, 0x15220
.long 0x23720, 0x14ae0, 0x14e90, 0x15230
.long 0x23850, 0x14af0, 0x14ea0, 0x15240
.long 0x24670, 0x14b00, 0x14eb0, 0x15250
.long 0x23cf0, 0x14b20, 0x14ec0, 0x15260
.long 0x23de0, 0x14b30, 0x14ed0, 0x15270
.long 0x23e90, 0x14b40, 0x14ee0, 0x15280
.long 0x23f80, 0x14b50, 0x14ef0, 0x15290
.long 0x23d60, 0x14b60, 0x14f00, 0x152a0
.long 0x23e10, 0x14b70, 0x14f10, 0x152b0
.long 0x23f00, 0x14b80, 0x14f20, 0x152c0
.long 0x24030, 0x14b90, 0x14f30, 0x152d0
.long 0x246f0, 0x14ba0, 0x14f40, 0x152f0
.long 0x247e0, 0x14bb0, 0x14f50, 0x15300
.long 0x24890, 0x14bc0, 0x14f60, 0x15310
.long 0x24980, 0x14bd0, 0x14f70, 0x15320
.long 0x24760, 0x14be0, 0x14f80, 0x15330
.long 0x24810, 0x14bf0, 0x14f90, 0x15340
.long 0x24900, 0x14c00, 0x14fa0, 0x15350
.long 0x24a30, 0x14c10, 0x14fb0, 0x15360
.long 0x240e0, 0x14800, 0x14ba0, 0x14f40
.long 0x241f0, 0x14810, 0x14bb0, 0x14f50
.long 0x24f90, 0x14820, 0x14bc0, 0x14f60
.long 0x250a0, 0x14830, 0x14bd0, 0x14f70
.long 0x24170, 0x14840, 0x14be0, 0x14f80
.long 0x24200, 0x14850, 0x14bf0, 0x14f90
.long 0x25020, 0x14860, 0x14c00, 0x14fa0
.long 0x25130, 0x14870, 0x14c10, 0x14fb0
.long 0x24ae0, 0x14880, 0x14c20, 0x14fd0
.long 0x24bf0, 0x14890, 0x14c30, 0x14fe0
.long 0x25990, 0x148a0, 0x14c40, 0x14ff0
.long 0x25aa0, 0x148b0, 0x14c50, 0x15000
.long 0x24b70, 0x148c0, 0x14c60, 0x15010
.long 0x24c00, 0x148d0, 0x14c70, 0x15020
.long 0x25a20, 0x148e0, 0x14c80, 0x15030
.long 0x25b30, 0x148f0, 0x14c90, 0x15040
.long 0x251b0, 0x14900, 0x14cb0, 0x15050
.long 0x252c0, 0x14910, 0x14cc0, 0x15060
.long 0x253d0, 0x14920, 0x14cd0, 0x15070
.long 0x254e0, 0x14930, 0x14ce0, 0x15080
.long 0x25240, 0x14940, 0x14cf0, 0x15090
.long 0x25350, 0x14950, 0x14d00, 0x150a0
.long 0x25460, 0x14960, 0x14d10, 0x150b0
.long 0x25570, 0x14970, 0x14d20, 0x150c0
.long 0x25bb0, 0x14990, 0x14d30, 0x150d0
.long 0x25cc0, 0x149a0, 0x14d40, 0x150e0
.long 0x25dd0, 0x149b0, 0x14d50, 0x150f0
.long 0x25ee0, 0x149c0, 0x14d60, 0x15100
.long 0x25c40, 0x149d0, 0x14d70, 0x15110
.long 0x25d50, 0x149e0, 0x14d80, 0x15120
.long 0x25e60, 0x149f0, 0x14d90, 0x15130
.long 0x25f70, 0x14a00, 0x14da0, 0x15140
.long 0x240f0, 0x14a10, 0x14db0, 0x15160
.long 0x241e0, 0x14a20, 0x14dc0, 0x15170
.long 0x24f80, 0x14a30, 0x14dd0, 0x15180
.long 0x250b0, 0x14a40, 0x14de0, 0x15190
.long 0x24160, 0x14a50, 0x14df0, 0x151a0
.long 0x24210, 0x14a60, 0x14e00, 0x151b0
.long 0x25030, 0x14a70, 0x14e10, 0x151c0
.long 0x25120, 0x14a80, 0x14e20, 0x151d0
.long 0x24af0, 0x14a90, 0x14e40, 0x151e0
.long 0x24be0, 0x14aa0, 0x14e50, 0x151f0
.long 0x25980, 0x14ab0, 0x14e60, 0x15200
.long 0x25ab0, 0x14ac0, 0x14e70, 0x15210
.long 0x24b60, 0x14ad0, 0x14e80, 0x15220
.long 0x24c10, 0x14ae0, 0x14e90, 0x15230
.long 0x25a30, 0x14af0, 0x14ea0, 0x15240
.long 0x25b20, 0x14b00, 0x14eb0, 0x15250
.long 0x251a0, 0x14b20, 0x14ec0, 0x15260
.long 0x252d0, 0x14b30, 0x14ed0, 0x15270
.long 0x253c0, 0x14b40, 0x14ee0, 0x15280
.long 0x254f0, 0x14b50, 0x14ef0, 0x15290
.long 0x25250, 0x14b60, 0x14f00, 0x152a0
.long 0x25340, 0x14b70, 0x14f10, 0x152b0
.long 0x25470, 0x14b80, 0x14f20, 0x152c0
.long 0x25560, 0x14b90, 0x14f30, 0x152d0
.long 0x25ba0, 0x14ba0, 0x14f40, 0x152f0
.long 0x25cd0, 0x14bb0, 0x14f50, 0x15300
.long 0x25dc0, 0x14bc0, 0x14f60, 0x15310
.long 0x25ef0, 0x14bd0, 0x14f70, 0x15320
.long 0x25c50, 0x14be0, 0x14f80, 0x15330
.long 0x25d40, 0x14bf0, 0x14f90, 0x15340
.long 0x25e70, 0x14c00, 0x14fa0, 0x15350
.long 0x25f60, 0x14c10, 0x14fb0, 0x15360
.long 0x240a0, 0x14800, 0x14ba0, 0x14f40
.long 0x241b0, 0x14810, 0x14bb0, 0x14f50
.long 0x24fd0, 0x14820, 0x14bc0, 0x14f60
.long 0x250e0, 0x14830, 0x14bd0, 0x14f70
.long 0x24130, 0x14840, 0x14be0, 0x14f80
.long 0x24240, 0x14850, 0x14bf0, 0x14f90
.long 0x25060, 0x14860, 0x14c00, 0x14fa0
.long 0x25170, 0x14870, 0x14c10, 0x14fb0
.long 0x24aa0, 0x14880, 0x14c20, 0x14fd0
.long 0x24bb0, 0x14890, 0x14c30, 0x14fe0
.long 0x259d0, 0x148a0, 0x14c40, 0x14ff0
.long 0x25ae0, 0x148b0, 0x14c50, 0x15000
.long 0x24b30, 0x148c0, 0x14c60, 0x15010
.long 0x24c40, 0x148d0, 0x14c70, 0x15020
.long 0x25a60, 0x148e0, 0x14c80, 0x15030
.long 0x25b70, 0x148f0, 0x14c90, 0x15040
.long 0x251f0, 0x14900, 0x14cb0, 0x15050
.long 0x25280, 0x14910, 0x14cc0, 0x15060
.long 0x25390, 0x14920, 0x14cd0, 0x15070
.long 0x254a0, 0x14930, 0x14ce0, 0x15080
.long 0x25200, 0x14940, 0x14cf0, 0x15090
.long 0x25310, 0x14950, 0x14d00, 0x150a0
.long 0x25420, 0x14960, 0x14d10, 0x150b0
.long 0x25530, 0x14970, 0x14d20, 0x150c0
.long 0x25bf0, 0x14990, 0x14d30, 0x150d0
.long 0x25c80, 0x149a0, 0x14d40, 0x150e0
.long 0x25d90, 0x149b0, 0x14d50, 0x150f0
.long 0x25ea0, 0x149c0, 0x14d60, 0x15100
.long 0x25c00, 0x149d0, 0x14d70, 0x15110
.long 0x25d10, 0x149e0, 0x14d80, 0x15120
.long 0x25e20, 0x149f0, 0x14d90, 0x15130
.long 0x25f30, 0x14a00, 0x14da0, 0x15140
.long 0x240b0, 0x14a10, 0x14db0, 0x15160
.long 0x241a0, 0x14a20, 0x14dc0, 0x15170
.long 0x24fc0, 0x14a30, 0x14dd0, 0x15180
.long 0x250f0, 0x14a40, 0x14de0, 0x15190
.long 0x24120, 0x14a50, 0x14df0, 0x151a0
.long 0x24250, 0x14a60, 0x14e00, 0x151b0
.long 0x25070, 0x14a70, 0x14e10, 0x151c0
.long 0x25160, 0x14a80, 0x14e20, 0x151d0
.long 0x24ab0, 0x14a90, 0x14e40, 0x151e0
.long 0x24ba0, 0x14aa0, 0x14e50, 0x151f0
.long 0x259c0, 0x14ab0, 0x14e60, 0x15200
.long 0x25af0, 0x14ac0, 0x14e70, 0x15210
.long 0x24b20, 0x14ad0, 0x14e80, 0x15220
.long 0x24c50, 0x14ae0, 0x14e90, 0x15230
.long 0x25a70, 0x14af0, 0x14ea0, 0x15240
.long 0x25b60, 0x14b00, 0x14eb0, 0x15250
.long 0x251e0, 0x14b20, 0x14ec0, 0x15260
.long 0x25290, 0x14b30, 0x14ed0, 0x15270
.long 0x25380, 0x14b40, 0x14ee0, 0x15280
.long 0x254b0, 0x14b50, 0x14ef0, 0x15290
.long 0x25210, 0x14b60, 0x14f00, 0x152a0
.long 0x25300, 0x14b70, 0x14f10, 0x152b0
.long 0x25430, 0x14b80, 0x14f20, 0x152c0
.long 0x25520, 0x14b90, 0x14f30, 0x152d0
.long 0x25be0, 0x14ba0, 0x14f40, 0x152f0
.long 0x25c90, 0x14bb0, 0x14f50, 0x15300
.long 0x25d80, 0x14bc0, 0x14f60, 0x15310
.long 0x25eb0, 0x14bd0, 0x14f70, 0x15320
.long 0x25c10, 0x14be0, 0x14f80, 0x15330
.long 0x25d00, 0x14bf0, 0x14f90, 0x15340
.long 0x25e30, 0x14c00, 0x14fa0, 0x15350
.long 0x25f20, 0x14c10, 0x14fb0, 0x15360
.long 0xc000, 0xe000, 0xe000, 0x0
.long 0xc010, 0xe010, 0xe010, 0x10
.long 0xc020, 0xe020, 0xe020, 0x20
.long 0xc030, 0xe030, 0xe030, 0x30
.long 0xc004, 0xe002, 0xe400, 0x40
.long 0xc014, 0xe012, 0xe400, 0x50
.long 0xc024, 0xe022, 0xe400, 0x60
.long 0xc034, 0xe032, 0xe400, 0x70
.long 0xc008, 0xe004, 0xe400, 0x1800
.long 0xc018, 0xe014, 0xe400, 0x1810
.long 0xc028, 0xe024, 0xe400, 0x1820
.long 0xc038, 0xe034, 0xe400, 0x1830
.long 0xc00c, 0xe006, 0xe400, 0x1840
.long 0xc01c, 0xe016, 0xe400, 0x1850
.long 0xc02c, 0xe026, 0xe400, 0x1860
.long 0xc03c, 0xe036, 0xe400, 0x1870
.long 0xc100, 0xe040, 0xe400, 0x3040
.long 0xc110, 0xe050, 0xe400, 0x3050
.long 0xc120, 0xe060, 0xe400, 0x3060
.long 0xc130, 0xe070, 0xe400, 0x3070
.long 0xc104, 0xe042, 0xe000, 0x3000
.long 0xc114, 0xe052, 0xe010, 0x3010
.long 0xc124, 0xe062, 0xe020, 0x3020
.long 0xc134, 0xe072, 0xe030, 0x3030
.long 0xc108, 0xe044, 0xe400, 0x4840
.long 0xc118, 0xe054, 0xe400, 0x4850
.long 0xc128, 0xe064, 0xe400, 0x4860
.long 0xc138, 0xe074, 0xe400, 0x4870
.long 0xc10c, 0xe046, 0xe400, 0x4800
.long 0xc11c, 0xe056, 0xe400, 0x4810
.long 0xc12c, 0xe066, 0xe400, 0x4820
.long 0xc13c, 0xe076, 0xe400, 0x4830
.long 0xc200, 0xe008, 0xe040, 0x600
.long 0xc210, 0xe018, 0xe050, 0x610
.long 0xc220, 0xe028, 0xe060, 0x620
.long 0xc230, 0xe038, 0xe070, 0x630
.long 0xc204, 0xe00a, 0xe400, 0x640
.long 0xc214, 0xe01a, 0xe400, 0x650
.long 0xc224, 0xe02a, 0xe400, 0x660
.long 0xc234, 0xe03a, 0xe400, 0x670
.long 0xc208, 0xe00c, 0xe400, 0x1e00
.long 0xc218, 0xe01c, 0xe400, 0x1e10
.long 0xc228, 0xe02c, 0xe400, 0x1e20
.long 0xc238, 0xe03c, 0xe400, 0x1e30
.long 0xc20c, 0xe00e, 0xe400, 0x1e40
.long 0xc21c, 0xe01e, 0xe400, 0x1e50
.long 0xc22c, 0xe02e, 0xe400, 0x1e60
.long 0xc23c, 0xe03e, 0xe400, 0x1e70
.long 0xc300, 0xe048, 0xe400, 0x3640
.long 0xc310, 0xe058, 0xe400, 0x3650
.long 0xc320, 0xe068, 0xe400, 0x3660
.long 0xc330, 0xe078, 0xe400, 0x3670
.long 0xc304, 0xe04a, 0xe040, 0x3600
.long 0xc314, 0xe05a, 0xe050, 0x3610
.long 0xc324, 0xe06a, 0xe060, 0x3620
.long 0xc334, 0xe07a, 0xe070, 0x3630
.long 0xc308, 0xe04c, 0xe400, 0x4e40
.long 0xc318, 0xe05c, 0xe400, 0x4e50
.long 0xc328, 0xe06c, 0xe400, 0x4e60
.long 0xc338, 0xe07c, 0xe400, 0x4e70
.long 0xc30c, 0xe04e, 0xe400, 0x4e00
.long 0xc31c, 0xe05e, 0xe400, 0x4e10
.long 0xc32c, 0xe06e, 0xe400, 0x4e20
.long 0xc33c, 0xe07e, 0xe400, 0x4e30
.long 0xc800, 0xe100, 0xe000, 0x0
.long 0xc810, 0xe110, 0xe010, 0x10
.long 0xc820, 0xe120, 0xe020, 0x20
.long 0xc830, 0xe130, 0xe030, 0x30
.long 0xc804, 0xe102, 0xe400, 0x40
.long 0xc814, 0xe112, 0xe400, 0x50
.long 0xc824, 0xe122, 0xe400, 0x60
.long 0xc834, 0xe132, 0xe400, 0x70
.long 0xc808, 0xe104, 0xe400, 0x1800
.long 0xc818, 0xe114, 0xe400, 0x1810
.long 0xc828, 0xe124, 0xe400, 0x1820
.long 0xc838, 0xe134, 0xe400, 0x1830
.long 0xc80c, 0xe106, 0xe400, 0x1840
.long 0xc81c, 0xe116, 0xe400, 0x1850
.long 0xc82c, 0xe126, 0xe400, 0x1860
.long 0xc83c, 0xe136, 0xe400, 0x1870
.long 0xc900, 0xe140, 0xe400, 0x3040
.long 0xc910, 0xe150, 0xe400, 0x3050
.long 0xc920, 0xe160, 0xe400, 0x3060
.long 0xc930, 0xe170, 0xe400, 0x3070
.long 0xc904, 0xe142, 0xe000, 0x3000
.long 0xc914, 0xe152, 0xe010, 0x3010
.long 0xc924, 0xe162, 0xe020, 0x3020
.long 0xc934, 0xe172, 0xe030, 0x3030
.long 0xc908, 0xe144, 0xe400, 0x4840
.long 0xc918, 0xe154, 0xe400, 0x4850
.long 0xc928, 0xe164, 0xe400, 0x4860
.long 0xc938, 0xe174, 0xe400, 0x4870
.long 0xc90c, 0xe146, 0xe400, 0x4800
.long 0xc91c, 0xe156, 0xe400, 0x4810
.long 0xc92c, 0xe166, 0xe400, 0x4820
.long 0xc93c, 0xe176, 0xe400, 0x4830
.long 0xca00, 0xe108, 0xe040, 0x600
.long 0xca10, 0xe118, 0xe050, 0x610
.long 0xca20, 0xe128, 0xe060, 0x620
.long 0xca30, 0xe138, 0xe070, 0x630
.long 0xca04, 0xe10a, 0xe400, 0x640
.long 0xca14, 0xe11a, 0xe400, 0x650
.long 0xca24, 0xe12a, 0xe400, 0x660
.long 0xca34, 0xe13a, 0xe400, 0x670
.long 0xca08, 0xe10c, 0xe400, 0x1e00
.long 0xca18, 0xe11c, 0xe400, 0x1e10
.long 0xca28, 0xe12c, 0xe400, 0x1e20
.long 0xca38, 0xe13c, 0xe400, 0x1e30
.long 0xca0c, 0xe10e, 0xe400, 0x1e40
.long 0xca1c, 0xe11e, 0xe400, 0x1e50
.long 0xca2c, 0xe12e, 0xe400, 0x1e60
.long 0xca3c, 0xe13e, 0xe400, 0x1e70
.long 0xcb00, 0xe148, 0xe400, 0x3640
.long 0xcb10, 0xe158, 0xe400, 0x3650
.long 0xcb20, 0xe168, 0xe400, 0x3660
.long 0xcb30, 0xe178, 0xe400, 0x3670
.long 0xcb04, 0xe14a, 0xe040, 0x3600
.long 0xcb14, 0xe15a, 0xe050, 0x3610
.long 0xcb24, 0xe16a, 0xe060, 0x3620
.long 0xcb34, 0xe17a, 0xe070, 0x3630
.long 0xcb08, 0xe14c, 0xe400, 0x4e40
.long 0xcb18, 0xe15c, 0xe400, 0x4e50
.long 0xcb28, 0xe16c, 0xe400, 0x4e60
.long 0xcb38, 0xe17c, 0xe400, 0x4e70
.long 0xcb0c, 0xe14e, 0xe400, 0x4e00
.long 0xcb1c, 0xe15e, 0xe400, 0x4e10
.long 0xcb2c, 0xe16e, 0xe400, 0x4e20
.long 0xcb3c, 0xe17e, 0xe400, 0x4e30
.long 0xc840, 0xe180, 0xe100, 0x0
.long 0xc850, 0xe190, 0xe110, 0x10
.long 0xc860, 0xe1a0, 0xe120, 0x20
.long 0xc870, 0xe1b0, 0xe130, 0x30
.long 0xc844, 0xe182, 0xe400, 0x40
.long 0xc854, 0xe192, 0xe400, 0x50
.long 0xc864, 0xe1a2, 0xe400, 0x60
.long 0xc874, 0xe1b2, 0xe400, 0x70
.long 0xc848, 0xe184, 0xe400, 0x1800
.long 0xc858, 0xe194, 0xe400, 0x1810
.long 0xc868, 0xe1a4, 0xe400, 0x1820
.long 0xc878, 0xe1b4, 0xe400, 0x1830
.long 0xc84c, 0xe186, 0xe400, 0x1840
.long 0xc85c, 0xe196, 0xe400, 0x1850
.long 0xc86c, 0xe1a6, 0xe400, 0x1860
.long 0xc87c, 0xe1b6, 0xe400, 0x1870
.long 0xc940, 0xe1c0, 0xe400, 0x3040
.long 0xc950, 0xe1d0, 0xe400, 0x3050
.long 0xc960, 0xe1e0, 0xe400, 0x3060
.long 0xc970, 0xe1f0, 0xe400, 0x3070
.long 0xc944, 0xe1c2, 0xe100, 0x3000
.long 0xc954, 0xe1d2, 0xe110, 0x3010
.long 0xc964, 0xe1e2, 0xe120, 0x3020
.long 0xc974, 0xe1f2, 0xe130, 0x3030
.long 0xc948, 0xe1c4, 0xe400, 0x4840
.long 0xc958, 0xe1d4, 0xe400, 0x4850
.long 0xc968, 0xe1e4, 0xe400, 0x4860
.long 0xc978, 0xe1f4, 0xe400, 0x4870
.long 0xc94c, 0xe1c6, 0xe400, 0x4800
.long 0xc95c, 0xe1d6, 0xe400, 0x4810
.long 0xc96c, 0xe1e6, 0xe400, 0x4820
.long 0xc97c, 0xe1f6, 0xe400, 0x4830
.long 0xca40, 0xe188, 0xe140, 0x600
.long 0xca50, 0xe198, 0xe150, 0x610
.long 0xca60, 0xe1a8, 0xe160, 0x620
.long 0xca70, 0xe1b8, 0xe170, 0x630
.long 0xca44, 0xe18a, 0xe400, 0x640
.long 0xca54, 0xe19a, 0xe400, 0x650
.long 0xca64, 0xe1aa, 0xe400, 0x660
.long 0xca74, 0xe1ba, 0xe400, 0x670
.long 0xca48, 0xe18c, 0xe400, 0x1e00
.long 0xca58, 0xe19c, 0xe400, 0x1e10
.long 0xca68, 0xe1ac, 0xe400, 0x1e20
.long 0xca78, 0xe1bc, 0xe400, 0x1e30
.long 0xca4c, 0xe18e, 0xe400, 0x1e40
.long 0xca5c, 0xe19e, 0xe400, 0x1e50
.long 0xca6c, 0xe1ae, 0xe400, 0x1e60
.long 0xca7c, 0xe1be, 0xe400, 0x1e70
.long 0xcb40, 0xe1c8, 0xe400, 0x3640
.long 0xcb50, 0xe1d8, 0xe400, 0x3650
.long 0xcb60, 0xe1e8, 0xe400, 0x3660
.long 0xcb70, 0xe1f8, 0xe400, 0x3670
.long 0xcb44, 0xe1ca, 0xe140, 0x3600
.long 0xcb54, 0xe1da, 0xe150, 0x3610
.long 0xcb64, 0xe1ea, 0xe160, 0x3620
.long 0xcb74, 0xe1fa, 0xe170, 0x3630
.long 0xcb48, 0xe1cc, 0xe400, 0x4e40
.long 0xcb58, 0xe1dc, 0xe400, 0x4e50
.long 0xcb68, 0xe1ec, 0xe400, 0x4e60
.long 0xcb78, 0xe1fc, 0xe400, 0x4e70
.long 0xcb4c, 0xe1ce, 0xe400, 0x4e00
.long 0xcb5c, 0xe1de, 0xe400, 0x4e10
.long 0xcb6c, 0xe1ee, 0xe400, 0x4e20
.long 0xcb7c, 0xe1fe, 0xe400, 0x4e30
.long 0xc040, 0xe080, 0xe100, 0x0
.long 0xc050, 0xe090, 0xe110, 0x10
.long 0xc060, 0xe0a0, 0xe120, 0x20
.long 0xc070, 0xe0b0, 0xe130, 0x30
.long 0xc044, 0xe082, 0xe400, 0x40
.long 0xc054, 0xe092, 0xe400, 0x50
.long 0xc064, 0xe0a2, 0xe400, 0x60
.long 0xc074, 0xe0b2, 0xe400, 0x70
.long 0xc048, 0xe084, 0xe400, 0x1800
.long 0xc058, 0xe094, 0xe400, 0x1810
.long 0xc068, 0xe0a4, 0xe400, 0x1820
.long 0xc078, 0xe0b4, 0xe400, 0x1830
.long 0xc04c, 0xe086, 0xe400, 0x1840
.long 0xc05c, 0xe096, 0xe400, 0x1850
.long 0xc06c, 0xe0a6, 0xe400, 0x1860
.long 0xc07c, 0xe0b6, 0xe400, 0x1870
.long 0xc140, 0xe0c0, 0xe400, 0x3040
.long 0xc150, 0xe0d0, 0xe400, 0x3050
.long 0xc160, 0xe0e0, 0xe400, 0x3060
.long 0xc170, 0xe0f0, 0xe400, 0x3070
.long 0xc144, 0xe0c2, 0xe100, 0x3000
.long 0xc154, 0xe0d2, 0xe110, 0x3010
.long 0xc164, 0xe0e2, 0xe120, 0x3020
.long 0xc174, 0xe0f2, 0xe130, 0x3030
.long 0xc148, 0xe0c4, 0xe400, 0x4840
.long 0xc158, 0xe0d4, 0xe400, 0x4850
.long 0xc168, 0xe0e4, 0xe400, 0x4860
.long 0xc178, 0xe0f4, 0xe400, 0x4870
.long 0xc14c, 0xe0c6, 0xe400, 0x4800
.long 0xc15c, 0xe0d6, 0xe400, 0x4810
.long 0xc16c, 0xe0e6, 0xe400, 0x4820
.long 0xc17c, 0xe0f6, 0xe400, 0x4830
.long 0xc240, 0xe088, 0xe140, 0x600
.long 0xc250, 0xe098, 0xe150, 0x610
.long 0xc260, 0xe0a8, 0xe160, 0x620
.long 0xc270, 0xe0b8, 0xe170, 0x630
.long 0xc244, 0xe08a, 0xe400, 0x640
.long 0xc254, 0xe09a, 0xe400, 0x650
.long 0xc264, 0xe0aa, 0xe400, 0x660
.long 0xc274, 0xe0ba, 0xe400, 0x670
.long 0xc248, 0xe08c, 0xe400, 0x1e00
.long 0xc258, 0xe09c, 0xe400, 0x1e10
.long 0xc268, 0xe0ac, 0xe400, 0x1e20
.long 0xc278, 0xe0bc, 0xe400, 0x1e30
.long 0xc24c, 0xe08e, 0xe400, 0x1e40
.long 0xc25c, 0xe09e, 0xe400, 0x1e50
.long 0xc26c, 0xe0ae, 0xe400, 0x1e60
.long 0xc27c, 0xe0be, 0xe400, 0x1e70
.long 0xc340, 0xe0c8, 0xe400, 0x3640
.long 0xc350, 0xe0d8, 0xe400, 0x3650
.long 0xc360, 0xe0e8, 0xe400, 0x3660
.long 0xc370, 0xe0f8, 0xe400, 0x3670
.long 0xc344, 0xe0ca, 0xe140, 0x3600
.long 0xc354, 0xe0da, 0xe150, 0x3610
.long 0xc364, 0xe0ea, 0xe160, 0x3620
.long 0xc374, 0xe0fa, 0xe170, 0x3630
.long 0xc348, 0xe0cc, 0xe400, 0x4e40
.long 0xc358, 0xe0dc, 0xe400, 0x4e50
.long 0xc368, 0xe0ec, 0xe400, 0x4e60
.long 0xc378, 0xe0fc, 0xe400, 0x4e70
.long 0xc34c, 0xe0ce, 0xe400, 0x4e00
.long 0xc35c, 0xe0de, 0xe400, 0x4e10
.long 0xc36c, 0xe0ee, 0xe400, 0x4e20
.long 0xc37c, 0xe0fe, 0xe400, 0x4e30
.long 0x0, 0x1c000, 0x1c000, 0x0
.long 0x1, 0x1c008, 0x1c008, 0x10
.long 0x2, 0x1c010, 0x1c010, 0x8
.long 0x3, 0x1c018, 0x1c018, 0x18
.long 0x4, 0x1c080, 0x1c080, 0x180
.long 0x5, 0x1c088, 0x1c088, 0x190
.long 0x6, 0x1c090, 0x1c090, 0x188
.long 0x7, 0x1c098, 0x1c098, 0x198
.long 0x8, 0x1c140, 0x1c140, 0x340
.long 0x9, 0x1c148, 0x1c148, 0x350
.long 0xa, 0x1c150, 0x1c150, 0x348
.long 0xb, 0x1c158, 0x1c158, 0x358
.long 0xc, 0x1c1c0, 0x1c1c0, 0x4c0
.long 0xd, 0x1c1c8, 0x1c1c8, 0x4d0
.long 0xe, 0x1c1d0, 0x1c1d0, 0x4c8
.long 0xf, 0x1c1d8, 0x1c1d8, 0x4d8
.long 0x10, 0x1c020, 0x1c020, 0x20
.long 0x11, 0x1c028, 0x1c028, 0x30
.long 0x12, 0x1c030, 0x1c030, 0x28
.long 0x13, 0x1c038, 0x1c038, 0x38
.long 0x14, 0x1c0a0, 0x1c0a0, 0x1a0
.long 0x15, 0x1c0a8, 0x1c0a8, 0x1b0
.long 0x16, 0x1c0b0, 0x1c0b0, 0x1a8
.long 0x17, 0x1c0b8, 0x1c0b8, 0x1b8
.long 0x18, 0x1c160, 0x1c160, 0x360
.long 0x19, 0x1c168, 0x1c168, 0x370
.long 0x1a, 0x1c170, 0x1c170, 0x368
.long 0x1b, 0x1c178, 0x1c178, 0x378
.long 0x1c, 0x1c1e0, 0x1c1e0, 0x4e0
.long 0x1d, 0x1c1e8, 0x1c1e8, 0x4f0
.long 0x1e, 0x1c1f0, 0x1c1f0, 0x4e8
.long 0x1f, 0x1c1f8, 0x1c1f8, 0x4f8
.long 0x20, 0x1c200, 0x1c200, 0x600
.long 0x21, 0x1c208, 0x1c208, 0x610
.long 0x22, 0x1c210, 0x1c210, 0x608
.long 0x23, 0x1c218, 0x1c218, 0x618
.long 0x24, 0x1c280, 0x1c280, 0x780
.long 0x25, 0x1c288, 0x1c288, 0x790
.long 0x26, 0x1c290, 0x1c290, 0x788
.long 0x27, 0x1c298, 0x1c298, 0x798
.long 0x28, 0x1c340, 0x1c340, 0x940
.long 0x29, 0x1c348, 0x1c348, 0x950
.long 0x2a, 0x1c350, 0x1c350, 0x948
.long 0x2b, 0x1c358, 0x1c358, 0x958
.long 0x2c, 0x1c3c0, 0x1c3c0, 0xac0
.long 0x2d, 0x1c3c8, 0x1c3c8, 0xad0
.long 0x2e, 0x1c3d0, 0x1c3d0, 0xac8
.long 0x2f, 0x1c3d8, 0x1c3d8, 0xad8
.long 0x30, 0x1c220, 0x1c220, 0x620
.long 0x31, 0x1c228, 0x1c228, 0x630
.long 0x32, 0x1c230, 0x1c230, 0x628
.long 0x33, 0x1c238, 0x1c238, 0x638
.long 0x34, 0x1c2a0, 0x1c2a0, 0x7a0
.long 0x35, 0x1c2a8, 0x1c2a8, 0x7b0
.long 0x36, 0x1c2b0, 0x1c2b0, 0x7a8
.long 0x37, 0x1c2b8, 0x1c2b8, 0x7b8
.long 0x38, 0x1c360, 0x1c360, 0x960
.long 0x39, 0x1c368, 0x1c368, 0x970
.long 0x3a, 0x1c370, 0x1c370, 0x968
.long 0x3b, 0x1c378, 0x1c378, 0x978
.long 0x3c, 0x1c3e0, 0x1c3e0, 0xae0
.long 0x3d, 0x1c3e8, 0x1c3e8, 0xaf0
.long 0x3e, 0x1c3f0, 0x1c3f0, 0xae8
.long 0x3f, 0x1c3f8, 0x1c3f8, 0xaf8
.long 0x0, 0x1c040, 0x1c040, 0x40
.long 0x1, 0x1c048, 0x1c048, 0x50
.long 0x2, 0x1c050, 0x1c050, 0x48
.long 0x3, 0x1c058, 0x1c058, 0x58
.long 0x4, 0x1c0c0, 0x1c0c0, 0x1c0
.long 0x5, 0x1c0c8, 0x1c0c8, 0x1d0
.long 0x6, 0x1c0d0, 0x1c0d0, 0x1c8
.long 0x7, 0x1c0d8, 0x1c0d8, 0x1d8
.long 0x8, 0x1c100, 0x1c100, 0x300
.long 0x9, 0x1c108, 0x1c108, 0x310
.long 0xa, 0x1c110, 0x1c110, 0x308
.long 0xb, 0x1c118, 0x1c118, 0x318
.long 0xc, 0x1c180, 0x1c180, 0x480
.long 0xd, 0x1c188, 0x1c188, 0x490
.long 0xe, 0x1c190, 0x1c190, 0x488
.long 0xf, 0x1c198, 0x1c198, 0x498
.long 0x10, 0x1c060, 0x1c060, 0x60
.long 0x11, 0x1c068, 0x1c068, 0x70
.long 0x12, 0x1c070, 0x1c070, 0x68
.long 0x13, 0x1c078, 0x1c078, 0x78
.long 0x14, 0x1c0e0, 0x1c0e0, 0x1e0
.long 0x15, 0x1c0e8, 0x1c0e8, 0x1f0
.long 0x16, 0x1c0f0, 0x1c0f0, 0x1e8
.long 0x17, 0x1c0f8, 0x1c0f8, 0x1f8
.long 0x18, 0x1c120, 0x1c120, 0x320
.long 0x19, 0x1c128, 0x1c128, 0x330
.long 0x1a, 0x1c130, 0x1c130, 0x328
.long 0x1b, 0x1c138, 0x1c138, 0x338
.long 0x1c, 0x1c1a0, 0x1c1a0, 0x4a0
.long 0x1d, 0x1c1a8, 0x1c1a8, 0x4b0
.long 0x1e, 0x1c1b0, 0x1c1b0, 0x4a8
.long 0x1f, 0x1c1b8, 0x1c1b8, 0x4b8
.long 0x20, 0x1c240, 0x1c240, 0x640
.long 0x21, 0x1c248, 0x1c248, 0x650
.long 0x22, 0x1c250, 0x1c250, 0x648
.long 0x23, 0x1c258, 0x1c258, 0x658
.long 0x24, 0x1c2c0, 0x1c2c0, 0x7c0
.long 0x25, 0x1c2c8, 0x1c2c8, 0x7d0
.long 0x26, 0x1c2d0, 0x1c2d0, 0x7c8
.long 0x27, 0x1c2d8, 0x1c2d8, 0x7d8
.long 0x28, 0x1c300, 0x1c300, 0x900
.long 0x29, 0x1c308, 0x1c308, 0x910
.long 0x2a, 0x1c310, 0x1c310, 0x908
.long 0x2b, 0x1c318, 0x1c318, 0x918
.long 0x2c, 0x1c380, 0x1c380, 0xa80
.long 0x2d, 0x1c388, 0x1c388, 0xa90
.long 0x2e, 0x1c390, 0x1c390, 0xa88
.long 0x2f, 0x1c398, 0x1c398, 0xa98
.long 0x30, 0x1c260, 0x1c260, 0x660
.long 0x31, 0x1c268, 0x1c268, 0x670
.long 0x32, 0x1c270, 0x1c270, 0x668
.long 0x33, 0x1c278, 0x1c278, 0x678
.long 0x34, 0x1c2e0, 0x1c2e0, 0x7e0
.long 0x35, 0x1c2e8, 0x1c2e8, 0x7f0
.long 0x36, 0x1c2f0, 0x1c2f0, 0x7e8
.long 0x37, 0x1c2f8, 0x1c2f8, 0x7f8
.long 0x38, 0x1c320, 0x1c320, 0x920
.long 0x39, 0x1c328, 0x1c328, 0x930
.long 0x3a, 0x1c330, 0x1c330, 0x928
.long 0x3b, 0x1c338, 0x1c338, 0x938
.long 0x3c, 0x1c3a0, 0x1c3a0, 0xaa0
.long 0x3d, 0x1c3a8, 0x1c3a8, 0xab0
.long 0x3e, 0x1c3b0, 0x1c3b0, 0xaa8
.long 0x3f, 0x1c3b8, 0x1c3b8, 0xab8
.long 0x0, 0x1f040, 0x19040, 0x3000
.long 0x1, 0x1f048, 0x19048, 0x3010
.long 0x2, 0x1f050, 0x19050, 0x3008
.long 0x3, 0x1f058, 0x19058, 0x3018
.long 0x4, 0x1f0c0, 0x190c0, 0x3180
.long 0x5, 0x1f0c8, 0x190c8, 0x3190
.long 0x6, 0x1f0d0, 0x190d0, 0x3188
.long 0x7, 0x1f0d8, 0x190d8, 0x3198
.long 0x8, 0x1f100, 0x19100, 0x3340
.long 0x9, 0x1f108, 0x19108, 0x3350
.long 0xa, 0x1f110, 0x19110, 0x3348
.long 0xb, 0x1f118, 0x19118, 0x3358
.long 0xc, 0x1f180, 0x19180, 0x34c0
.long 0xd, 0x1f188, 0x19188, 0x34d0
.long 0xe, 0x1f190, 0x19190, 0x34c8
.long 0xf, 0x1f198, 0x19198, 0x34d8
.long 0x10, 0x1f060, 0x19060, 0x3020
.long 0x11, 0x1f068, 0x19068, 0x3030
.long 0x12, 0x1f070, 0x19070, 0x3028
.long 0x13, 0x1f078, 0x19078, 0x3038
.long 0x14, 0x1f0e0, 0x190e0, 0x31a0
.long 0x15, 0x1f0e8, 0x190e8, 0x31b0
.long 0x16, 0x1f0f0, 0x190f0, 0x31a8
.long 0x17, 0x1f0f8, 0x190f8, 0x31b8
.long 0x18, 0x1f120, 0x19120, 0x3360
.long 0x19, 0x1f128, 0x19128, 0x3370
.long 0x1a, 0x1f130, 0x19130, 0x3368
.long 0x1b, 0x1f138, 0x19138, 0x3378
.long 0x1c, 0x1f1a0, 0x191a0, 0x34e0
.long 0x1d, 0x1f1a8, 0x191a8, 0x34f0
.long 0x1e, 0x1f1b0, 0x191b0, 0x34e8
.long 0x1f, 0x1f1b8, 0x191b8, 0x34f8
.long 0x20, 0x1f240, 0x19240, 0x3600
.long 0x21, 0x1f248, 0x19248, 0x3610
.long 0x22, 0x1f250, 0x19250, 0x3608
.long 0x23, 0x1f258, 0x19258, 0x3618
.long 0x24, 0x1f2c0, 0x192c0, 0x3780
.long 0x25, 0x1f2c8, 0x192c8, 0x3790
.long 0x26, 0x1f2d0, 0x192d0, 0x3788
.long 0x27, 0x1f2d8, 0x192d8, 0x3798
.long 0x28, 0x1f300, 0x19300, 0x3940
.long 0x29, 0x1f308, 0x19308, 0x3950
.long 0x2a, 0x1f310, 0x19310, 0x3948
.long 0x2b, 0x1f318, 0x19318, 0x3958
.long 0x2c, 0x1f380, 0x19380, 0x3ac0
.long 0x2d, 0x1f388, 0x19388, 0x3ad0
.long 0x2e, 0x1f390, 0x19390, 0x3ac8
.long 0x2f, 0x1f398, 0x19398, 0x3ad8
.long 0x30, 0x1f260, 0x19260, 0x3620
.long 0x31, 0x1f268, 0x19268, 0x3630
.long 0x32, 0x1f270, 0x19270, 0x3628
.long 0x33, 0x1f278, 0x19278, 0x3638
.long 0x34, 0x1f2e0, 0x192e0, 0x37a0
.long 0x35, 0x1f2e8, 0x192e8, 0x37b0
.long 0x36, 0x1f2f0, 0x192f0, 0x37a8
.long 0x37, 0x1f2f8, 0x192f8, 0x37b8
.long 0x38, 0x1f320, 0x19320, 0x3960
.long 0x39, 0x1f328, 0x19328, 0x3970
.long 0x3a, 0x1f330, 0x19330, 0x3968
.long 0x3b, 0x1f338, 0x19338, 0x3978
.long 0x3c, 0x1f3a0, 0x193a0, 0x3ae0
.long 0x3d, 0x1f3a8, 0x193a8, 0x3af0
.long 0x3e, 0x1f3b0, 0x193b0, 0x3ae8
.long 0x3f, 0x1f3b8, 0x193b8, 0x3af8
.long 0x0, 0x1f000, 0x19000, 0x3040
.long 0x1, 0x1f008, 0x19008, 0x3050
.long 0x2, 0x1f010, 0x19010, 0x3048
.long 0x3, 0x1f018, 0x19018, 0x3058
.long 0x4, 0x1f080, 0x19080, 0x31c0
.long 0x5, 0x1f088, 0x19088, 0x31d0
.long 0x6, 0x1f090, 0x19090, 0x31c8
.long 0x7, 0x1f098, 0x19098, 0x31d8
.long 0x8, 0x1f140, 0x19140, 0x3300
.long 0x9, 0x1f148, 0x19148, 0x3310
.long 0xa, 0x1f150, 0x19150, 0x3308
.long 0xb, 0x1f158, 0x19158, 0x3318
.long 0xc, 0x1f1c0, 0x191c0, 0x3480
.long 0xd, 0x1f1c8, 0x191c8, 0x3490
.long 0xe, 0x1f1d0, 0x191d0, 0x3488
.long 0xf, 0x1f1d8, 0x191d8, 0x3498
.long 0x10, 0x1f020, 0x19020, 0x3060
.long 0x11, 0x1f028, 0x19028, 0x3070
.long 0x12, 0x1f030, 0x19030, 0x3068
.long 0x13, 0x1f038, 0x19038, 0x3078
.long 0x14, 0x1f0a0, 0x190a0, 0x31e0
.long 0x15, 0x1f0a8, 0x190a8, 0x31f0
.long 0x16, 0x1f0b0, 0x190b0, 0x31e8
.long 0x17, 0x1f0b8, 0x190b8, 0x31f8
.long 0x18, 0x1f160, 0x19160, 0x3320
.long 0x19, 0x1f168, 0x19168, 0x3330
.long 0x1a, 0x1f170, 0x19170, 0x3328
.long 0x1b, 0x1f178, 0x19178, 0x3338
.long 0x1c, 0x1f1e0, 0x191e0, 0x34a0
.long 0x1d, 0x1f1e8, 0x191e8, 0x34b0
.long 0x1e, 0x1f1f0, 0x191f0, 0x34a8
.long 0x1f, 0x1f1f8, 0x191f8, 0x34b8
.long 0x20, 0x1f200, 0x19200, 0x3640
.long 0x21, 0x1f208, 0x19208, 0x3650
.long 0x22, 0x1f210, 0x19210, 0x3648
.long 0x23, 0x1f218, 0x19218, 0x3658
.long 0x24, 0x1f280, 0x19280, 0x37c0
.long 0x25, 0x1f288, 0x19288, 0x37d0
.long 0x26, 0x1f290, 0x19290, 0x37c8
.long 0x27, 0x1f298, 0x19298, 0x37d8
.long 0x28, 0x1f340, 0x19340, 0x3900
.long 0x29, 0x1f348, 0x19348, 0x3910
.long 0x2a, 0x1f350, 0x19350, 0x3908
.long 0x2b, 0x1f358, 0x19358, 0x3918
.long 0x2c, 0x1f3c0, 0x193c0, 0x3a80
.long 0x2d, 0x1f3c8, 0x193c8, 0x3a90
.long 0x2e, 0x1f3d0, 0x193d0, 0x3a88
.long 0x2f, 0x1f3d8, 0x193d8, 0x3a98
.long 0x30, 0x1f220, 0x19220, 0x3660
.long 0x31, 0x1f228, 0x19228, 0x3670
.long 0x32, 0x1f230, 0x19230, 0x3668
.long 0x33, 0x1f238, 0x19238, 0x3678
.long 0x34, 0x1f2a0, 0x192a0, 0x37e0
.long 0x35, 0x1f2a8, 0x192a8, 0x37f0
.long 0x36, 0x1f2b0, 0x192b0, 0x37e8
.long 0x37, 0x1f2b8, 0x192b8, 0x37f8
.long 0x38, 0x1f360, 0x19360, 0x3920
.long 0x39, 0x1f368, 0x19368, 0x3930
.long 0x3a, 0x1f370, 0x19370, 0x3928
.long 0x3b, 0x1f378, 0x19378, 0x3938
.long 0x3c, 0x1f3e0, 0x193e0, 0x3aa0
.long 0x3d, 0x1f3e8, 0x193e8, 0x3ab0
.long 0x3e, 0x1f3f0, 0x193f0, 0x3aa8
.long 0x3f, 0x1f3f8, 0x193f8, 0x3ab8
.long 0xbef00000, 0xe800, 0xe800, 0x0
.long 0xbef00000, 0xe810, 0xe810, 0x10
.long 0xbef00000, 0xe820, 0xe820, 0x20
.long 0xbef00000, 0xe830, 0xe830, 0x30
.long 0xbef00000, 0xe840, 0xe840, 0x40
.long 0xbef00000, 0xe850, 0xe850, 0x50
.long 0xbef00000, 0xe860, 0xe860, 0x60
.long 0xbef00000, 0xe870, 0xe870, 0x70
.long 0xbef00000, 0xe880, 0xe880, 0x80
.long 0xbef00000, 0xe890, 0xe890, 0x90
.long 0xbef00000, 0xe8a0, 0xe8a0, 0xa0
.long 0xbef00000, 0xe8b0, 0xe8b0, 0xb0
.long 0xbef00000, 0xe8c0, 0xe8c0, 0xc0
.long 0xbef00000, 0xe8d0, 0xe8d0, 0xd0
.long 0xbef00000, 0xe8e0, 0xe8e0, 0xe0
.long 0xbef00000, 0xe8f0, 0xe8f0, 0xf0
.long 0xbef00000, 0xe900, 0xe900, 0x100
.long 0xbef00000, 0xe910, 0xe910, 0x110
.long 0xbef00000, 0xe920, 0xe920, 0x120
.long 0xbef00000, 0xe930, 0xe930, 0x130
.long 0xbef00000, 0xe940, 0xe940, 0x140
.long 0xbef00000, 0xe950, 0xe950, 0x150
.long 0xbef00000, 0xe960, 0xe960, 0x160
.long 0xbef00000, 0xe970, 0xe970, 0x170
.long 0xbef00000, 0xe980, 0xe980, 0x180
.long 0xbef00000, 0xe990, 0xe990, 0x190
.long 0xbef00000, 0xe9a0, 0xe9a0, 0x1a0
.long 0xbef00000, 0xe9b0, 0xe9b0, 0x1b0
.long 0xbef00000, 0xe9c0, 0xe9c0, 0x1c0
.long 0xbef00000, 0xe9d0, 0xe9d0, 0x1d0
.long 0xbef00000, 0xe9e0, 0xe9e0, 0x1e0
.long 0xbef00000, 0xe9f0, 0xe9f0, 0x1f0
.long 0xbef00000, 0xea00, 0xea00, 0x200
.long 0xbef00000, 0xea10, 0xea10, 0x210
.long 0xbef00000, 0xea20, 0xea20, 0x220
.long 0xbef00000, 0xea30, 0xea30, 0x230
.long 0xbef00000, 0xea40, 0xea40, 0x240
.long 0xbef00000, 0xea50, 0xea50, 0x250
.long 0xbef00000, 0xea60, 0xea60, 0x260
.long 0xbef00000, 0xea70, 0xea70, 0x270
.long 0xbef00000, 0xea80, 0xea80, 0x280
.long 0xbef00000, 0xea90, 0xea90, 0x290
.long 0xbef00000, 0xeaa0, 0xeaa0, 0x2a0
.long 0xbef00000, 0xeab0, 0xeab0, 0x2b0
.long 0xbef00000, 0xeac0, 0xeac0, 0x2c0
.long 0xbef00000, 0xead0, 0xead0, 0x2d0
.long 0xbef00000, 0xeae0, 0xeae0, 0x2e0
.long 0xbef00000, 0xeaf0, 0xeaf0, 0x2f0
.long 0xbef00000, 0xeb00, 0xeb00, 0x300
.long 0xbef00000, 0xeb10, 0xeb10, 0x310
.long 0xbef00000, 0xeb20, 0xeb20, 0x320
.long 0xbef00000, 0xeb30, 0xeb30, 0x330
.long 0xbef00000, 0xeb40, 0xeb40, 0x340
.long 0xbef00000, 0xeb50, 0xeb50, 0x350
.long 0xbef00000, 0xeb60, 0xeb60, 0x360
.long 0xbef00000, 0xeb70, 0xeb70, 0x370
.long 0xbef00000, 0xeb80, 0xeb80, 0x380
.long 0xbef00000, 0xeb90, 0xeb90, 0x390
.long 0xbef00000, 0xeba0, 0xeba0, 0x3a0
.long 0xbef00000, 0xebb0, 0xebb0, 0x3b0
.long 0xbef00000, 0xebc0, 0xebc0, 0x3c0
.long 0xbef00000, 0xebd0, 0xebd0, 0x3d0
.long 0xbef00000, 0xebe0, 0xebe0, 0x3e0
.long 0xbef00000, 0xebf0, 0xebf0, 0x3f0
.long 0xbef00000, 0xf000, 0xe800, 0x800
.long 0xbef00000, 0xf010, 0xe810, 0x810
.long 0xbef00000, 0xf020, 0xe820, 0x820
.long 0xbef00000, 0xf030, 0xe830, 0x830
.long 0xbef00000, 0xf040, 0xe840, 0x840
.long 0xbef00000, 0xf050, 0xe850, 0x850
.long 0xbef00000, 0xf060, 0xe860, 0x860
.long 0xbef00000, 0xf070, 0xe870, 0x870
.long 0xbef00000, 0xf080, 0xe880, 0x880
.long 0xbef00000, 0xf090, 0xe890, 0x890
.long 0xbef00000, 0xf0a0, 0xe8a0, 0x8a0
.long 0xbef00000, 0xf0b0, 0xe8b0, 0x8b0
.long 0xbef00000, 0xf0c0, 0xe8c0, 0x8c0
.long 0xbef00000, 0xf0d0, 0xe8d0, 0x8d0
.long 0xbef00000, 0xf0e0, 0xe8e0, 0x8e0
.long 0xbef00000, 0xf0f0, 0xe8f0, 0x8f0
.long 0xbef00000, 0xf100, 0xe900, 0x900
.long 0xbef00000, 0xf110, 0xe910, 0x910
.long 0xbef00000, 0xf120, 0xe920, 0x920
.long 0xbef00000, 0xf130, 0xe930, 0x930
.long 0xbef00000, 0xf140, 0xe940, 0x940
.long 0xbef00000, 0xf150, 0xe950, 0x950
.long 0xbef00000, 0xf160, 0xe960, 0x960
.long 0xbef00000, 0xf170, 0xe970, 0x970
.long 0xbef00000, 0xf180, 0xe980, 0x980
.long 0xbef00000, 0xf190, 0xe990, 0x990
.long 0xbef00000, 0xf1a0, 0xe9a0, 0x9a0
.long 0xbef00000, 0xf1b0, 0xe9b0, 0x9b0
.long 0xbef00000, 0xf1c0, 0xe9c0, 0x9c0
.long 0xbef00000, 0xf1d0, 0xe9d0, 0x9d0
.long 0xbef00000, 0xf1e0, 0xe9e0, 0x9e0
.long 0xbef00000, 0xf1f0, 0xe9f0, 0x9f0
.long 0xbef00000, 0xf200, 0xea00, 0xa00
.long 0xbef00000, 0xf210, 0xea10, 0xa10
.long 0xbef00000, 0xf220, 0xea20, 0xa20
.long 0xbef00000, 0xf230, 0xea30, 0xa30
.long 0xbef00000, 0xf240, 0xea40, 0xa40
.long 0xbef00000, 0xf250, 0xea50, 0xa50
.long 0xbef00000, 0xf260, 0xea60, 0xa60
.long 0xbef00000, 0xf270, 0xea70, 0xa70
.long 0xbef00000, 0xf280, 0xea80, 0xa80
.long 0xbef00000, 0xf290, 0xea90, 0xa90
.long 0xbef00000, 0xf2a0, 0xeaa0, 0xaa0
.long 0xbef00000, 0xf2b0, 0xeab0, 0xab0
.long 0xbef00000, 0xf2c0, 0xeac0, 0xac0
.long 0xbef00000, 0xf2d0, 0xead0, 0xad0
.long 0xbef00000, 0xf2e0, 0xeae0, 0xae0
.long 0xbef00000, 0xf2f0, 0xeaf0, 0xaf0
.long 0xbef00000, 0xf300, 0xeb00, 0xb00
.long 0xbef00000, 0xf310, 0xeb10, 0xb10
.long 0xbef00000, 0xf320, 0xeb20, 0xb20
.long 0xbef00000, 0xf330, 0xeb30, 0xb30
.long 0xbef00000, 0xf340, 0xeb40, 0xb40
.long 0xbef00000, 0xf350, 0xeb50, 0xb50
.long 0xbef00000, 0xf360, 0xeb60, 0xb60
.long 0xbef00000, 0xf370, 0xeb70, 0xb70
.long 0xbef00000, 0xf380, 0xeb80, 0xb80
.long 0xbef00000, 0xf390, 0xeb90, 0xb90
.long 0xbef00000, 0xf3a0, 0xeba0, 0xba0
.long 0xbef00000, 0xf3b0, 0xebb0, 0xbb0
.long 0xbef00000, 0xf3c0, 0xebc0, 0xbc0
.long 0xbef00000, 0xf3d0, 0xebd0, 0xbd0
.long 0xbef00000, 0xf3e0, 0xebe0, 0xbe0
.long 0xbef00000, 0xf3f0, 0xebf0, 0xbf0
.long 0xbef00000, 0x11800, 0x11800, 0xc00
.long 0xbef00000, 0x11810, 0x11810, 0xc10
.long 0xbef00000, 0x11820, 0x11820, 0xc20
.long 0xbef00000, 0x11830, 0x11830, 0xc30
.long 0xbef00000, 0x11840, 0x11840, 0xc40
.long 0xbef00000, 0x11850, 0x11850, 0xc50
.long 0xbef00000, 0x11860, 0x11860, 0xc60
.long 0xbef00000, 0x11870, 0x11870, 0xc70
.long 0xbef00000, 0x11880, 0x11880, 0xc80
.long 0xbef00000, 0x11890, 0x11890, 0xc90
.long 0xbef00000, 0x118a0, 0x118a0, 0xca0
.long 0xbef00000, 0x118b0, 0x118b0, 0xcb0
.long 0x0, 0x118c0, 0x118c0, 0xcc0
.long 0x0, 0x118d0, 0x118d0, 0xcd0
.long 0x0, 0x118e0, 0x118e0, 0xce0
.long 0x0, 0x118f0, 0x118f0, 0xcf0
.long 0xbef00000, 0x11900, 0x11900, 0xd00
.long 0xbef00000, 0x11910, 0x11910, 0xd10
.long 0xbef00000, 0x11920, 0x11920, 0xd20
.long 0xbef00000, 0x11930, 0x11930, 0xd30
.long 0xbef00000, 0x11940, 0x11940, 0xd40
.long 0xbef00000, 0x11950, 0x11950, 0xd50
.long 0xbef00000, 0x11960, 0x11960, 0xd60
.long 0xbef00000, 0x11970, 0x11970, 0xd70
.long 0xbef00000, 0x11980, 0x11980, 0xd80
.long 0xbef00000, 0x11990, 0x11990, 0xd90
.long 0xbef00000, 0x119a0, 0x119a0, 0xda0
.long 0xbef00000, 0x119b0, 0x119b0, 0xdb0
.long 0x0, 0x119c0, 0x119c0, 0xdc0
.long 0x0, 0x119d0, 0x119d0, 0xdd0
.long 0x0, 0x119e0, 0x119e0, 0xde0
.long 0x0, 0x119f0, 0x119f0, 0xdf0
.long 0xbef00000, 0x11a00, 0x11a00, 0xe00
.long 0xbef00000, 0x11a10, 0x11a10, 0xe10
.long 0xbef00000, 0x11a20, 0x11a20, 0xe20
.long 0xbef00000, 0x11a30, 0x11a30, 0xe30
.long 0xbef00000, 0x11a40, 0x11a40, 0xe40
.long 0xbef00000, 0x11a50, 0x11a50, 0xe50
.long 0xbef00000, 0x11a60, 0x11a60, 0xe60
.long 0xbef00000, 0x11a70, 0x11a70, 0xe70
.long 0xbef00000, 0x11a80, 0x11a80, 0xe80
.long 0xbef00000, 0x11a90, 0x11a90, 0xe90
.long 0xbef00000, 0x11aa0, 0x11aa0, 0xea0
.long 0xbef00000, 0x11ab0, 0x11ab0, 0xeb0
.long 0x0, 0x11ac0, 0x11ac0, 0xec0
.long 0x0, 0x11ad0, 0x11ad0, 0xed0
.long 0x0, 0x11ae0, 0x11ae0, 0xee0
.long 0x0, 0x11af0, 0x11af0, 0xef0
.long 0xbef00000, 0x11b00, 0x11b00, 0xf00
.long 0xbef00000, 0x11b10, 0x11b10, 0xf10
.long 0xbef00000, 0x11b20, 0x11b20, 0xf20
.long 0xbef00000, 0x11b30, 0x11b30, 0xf30
.long 0xbef00000, 0x11b40, 0x11b40, 0xf40
.long 0xbef00000, 0x11b50, 0x11b50, 0xf50
.long 0xbef00000, 0x11b60, 0x11b60, 0xf60
.long 0xbef00000, 0x11b70, 0x11b70, 0xf70
.long 0xbef00000, 0x11b80, 0x11b80, 0xf80
.long 0xbef00000, 0x11b90, 0x11b90, 0xf90
.long 0xbef00000, 0x11ba0, 0x11ba0, 0xfa0
.long 0xbef00000, 0x11bb0, 0x11bb0, 0xfb0
.long 0x0, 0x11bc0, 0x11bc0, 0xfc0
.long 0x0, 0x11bd0, 0x11bd0, 0xfd0
.long 0x0, 0x11be0, 0x11be0, 0xfe0
.long 0x0, 0x11bf0, 0x11bf0, 0xff0
.long 0xbef00000, 0x12000, 0x11800, 0x400
.long 0xbef00000, 0x12010, 0x11810, 0x410
.long 0xbef00000, 0x12020, 0x11820, 0x420
.long 0xbef00000, 0x12030, 0x11830, 0x430
.long 0xbef00000, 0x12040, 0x11840, 0x440
.long 0xbef00000, 0x12050, 0x11850, 0x450
.long 0xbef00000, 0x12060, 0x11860, 0x460
.long 0xbef00000, 0x12070, 0x11870, 0x470
.long 0xbef00000, 0x12080, 0x11880, 0x480
.long 0xbef00000, 0x12090, 0x11890, 0x490
.long 0xbef00000, 0x120a0, 0x118a0, 0x4a0
.long 0xbef00000, 0x120b0, 0x118b0, 0x4b0
.long 0x0, 0x120c0, 0x118c0, 0x4c0
.long 0x0, 0x120d0, 0x118d0, 0x4d0
.long 0x0, 0x120e0, 0x118e0, 0x4e0
.long 0x0, 0x120f0, 0x118f0, 0x4f0
.long 0xbef00000, 0x12100, 0x11900, 0x500
.long 0xbef00000, 0x12110, 0x11910, 0x510
.long 0xbef00000, 0x12120, 0x11920, 0x520
.long 0xbef00000, 0x12130, 0x11930, 0x530
.long 0xbef00000, 0x12140, 0x11940, 0x540
.long 0xbef00000, 0x12150, 0x11950, 0x550
.long 0xbef00000, 0x12160, 0x11960, 0x560
.long 0xbef00000, 0x12170, 0x11970, 0x570
.long 0xbef00000, 0x12180, 0x11980, 0x580
.long 0xbef00000, 0x12190, 0x11990, 0x590
.long 0xbef00000, 0x121a0, 0x119a0, 0x5a0
.long 0xbef00000, 0x121b0, 0x119b0, 0x5b0
.long 0x0, 0x121c0, 0x119c0, 0x5c0
.long 0x0, 0x121d0, 0x119d0, 0x5d0
.long 0x0, 0x121e0, 0x119e0, 0x5e0
.long 0x0, 0x121f0, 0x119f0, 0x5f0
.long 0xbef00000, 0x12200, 0x11a00, 0x600
.long 0xbef00000, 0x12210, 0x11a10, 0x610
.long 0xbef00000, 0x12220, 0x11a20, 0x620
.long 0xbef00000, 0x12230, 0x11a30, 0x630
.long 0xbef00000, 0x12240, 0x11a40, 0x640
.long 0xbef00000, 0x12250, 0x11a50, 0x650
.long 0xbef00000, 0x12260, 0x11a60, 0x660
.long 0xbef00000, 0x12270, 0x11a70, 0x670
.long 0xbef00000, 0x12280, 0x11a80, 0x680
.long 0xbef00000, 0x12290, 0x11a90, 0x690
.long 0xbef00000, 0x122a0, 0x11aa0, 0x6a0
.long 0xbef00000, 0x122b0, 0x11ab0, 0x6b0
.long 0x0, 0x122c0, 0x11ac0, 0x6c0
.long 0x0, 0x122d0, 0x11ad0, 0x6d0
.long 0x0, 0x122e0, 0x11ae0, 0x6e0
.long 0x0, 0x122f0, 0x11af0, 0x6f0
.long 0xbef00000, 0x12300, 0x11b00, 0x700
.long 0xbef00000, 0x12310, 0x11b10, 0x710
.long 0xbef00000, 0x12320, 0x11b20, 0x720
.long 0xbef00000, 0x12330, 0x11b30, 0x730
.long 0xbef00000, 0x12340, 0x11b40, 0x740
.long 0xbef00000, 0x12350, 0x11b50, 0x750
.long 0xbef00000, 0x12360, 0x11b60, 0x760
.long 0xbef00000, 0x12370, 0x11b70, 0x770
.long 0xbef00000, 0x12380, 0x11b80, 0x780
.long 0xbef00000, 0x12390, 0x11b90, 0x790
.long 0xbef00000, 0x123a0, 0x11ba0, 0x7a0
.long 0xbef00000, 0x123b0, 0x11bb0, 0x7b0
.long 0x0, 0x123c0, 0x11bc0, 0x7c0
.long 0x0, 0x123d0, 0x11bd0, 0x7d0
.long 0x0, 0x123e0, 0x11be0, 0x7e0
.long 0x0, 0x123f0, 0x11bf0, 0x7f0
.long 0x0, 0x40, 0x0, 0x14800
.long 0x10, 0x50, 0x10, 0x14b20
.long 0x20, 0x60, 0x20, 0x14e40
.long 0x30, 0x70, 0x30, 0x15160
.long 0x40, 0x0, 0x40, 0x14990
.long 0x50, 0x10, 0x50, 0x14cb0
.long 0x60, 0x20, 0x60, 0x14fd0
.long 0x70, 0x30, 0x70, 0x152f0
.long 0x80, 0xc0, 0x80, 0x15de0
.long 0x90, 0xd0, 0x90, 0x16100
.long 0xa0, 0xe0, 0xa0, 0x16420
.long 0xb0, 0xf0, 0xb0, 0x16740
.long 0xc0, 0x80, 0xc0, 0x15f70
.long 0xd0, 0x90, 0xd0, 0x16290
.long 0xe0, 0xa0, 0xe0, 0x165b0
.long 0xf0, 0xb0, 0xf0, 0x168d0
.long 0x100, 0x140, 0x140, 0x15480
.long 0x110, 0x150, 0x150, 0x157a0
.long 0x120, 0x160, 0x160, 0x15ac0
.long 0x130, 0x170, 0x170, 0x173c0
.long 0x140, 0x100, 0x100, 0x15610
.long 0x150, 0x110, 0x110, 0x15930
.long 0x160, 0x120, 0x120, 0x15c50
.long 0x170, 0x130, 0x130, 0x17550
.long 0x180, 0x1c0, 0x1c0, 0x16a60
.long 0x190, 0x1d0, 0x1d0, 0x16d80
.long 0x1a0, 0x1e0, 0x1e0, 0x170a0
.long 0x1b0, 0x1f0, 0x1f0, 0x189a0
.long 0x1c0, 0x180, 0x180, 0x16bf0
.long 0x1d0, 0x190, 0x190, 0x16f10
.long 0x1e0, 0x1a0, 0x1a0, 0x17230
.long 0x1f0, 0x1b0, 0x1b0, 0x18b30
.long 0x200, 0x200, 0x240, 0x14810
.long 0x210, 0x210, 0x250, 0x14b30
.long 0x220, 0x220, 0x260, 0x14e50
.long 0x230, 0x230, 0x270, 0x15170
.long 0x240, 0x240, 0x200, 0x149a0
.long 0x250, 0x250, 0x210, 0x14cc0
.long 0x260, 0x260, 0x220, 0x14fe0
.long 0x270, 0x270, 0x230, 0x15300
.long 0x280, 0x280, 0x2c0, 0x15df0
.long 0x290, 0x290, 0x2d0, 0x16110
.long 0x2a0, 0x2a0, 0x2e0, 0x16430
.long 0x2b0, 0x2b0, 0x2f0, 0x16750
.long 0x2c0, 0x2c0, 0x280, 0x15f80
.long 0x2d0, 0x2d0, 0x290, 0x162a0
.long 0x2e0, 0x2e0, 0x2a0, 0x165c0
.long 0x2f0, 0x2f0, 0x2b0, 0x168e0
.long 0x340, 0x300, 0x340, 0x15490
.long 0x350, 0x310, 0x350, 0x157b0
.long 0x360, 0x320, 0x360, 0x15ad0
.long 0x370, 0x330, 0x370, 0x173d0
.long 0x300, 0x340, 0x300, 0x15620
.long 0x310, 0x350, 0x310, 0x15940
.long 0x320, 0x360, 0x320, 0x15c60
.long 0x330, 0x370, 0x330, 0x17560
.long 0x3c0, 0x380, 0x3c0, 0x16a70
.long 0x3d0, 0x390, 0x3d0, 0x16d90
.long 0x3e0, 0x3a0, 0x3e0, 0x170b0
.long 0x3f0, 0x3b0, 0x3f0, 0x189b0
.long 0x380, 0x3c0, 0x380, 0x16c00
.long 0x390, 0x3d0, 0x390, 0x16f20
.long 0x3a0, 0x3e0, 0x3a0, 0x17240
.long 0x3b0, 0x3f0, 0x3b0, 0x18b40
.long 0x0, 0x40, 0x0, 0x14840
.long 0x10, 0x50, 0x10, 0x14b60
.long 0x20, 0x60, 0x20, 0x14e80
.long 0x30, 0x70, 0x30, 0x151a0
.long 0x40, 0x0, 0x40, 0x149d0
.long 0x50, 0x10, 0x50, 0x14cf0
.long 0x60, 0x20, 0x60, 0x15010
.long 0x70, 0x30, 0x70, 0x15330
.long 0x80, 0xc0, 0x80, 0x15e20
.long 0x90, 0xd0, 0x90, 0x16140
.long 0xa0, 0xe0, 0xa0, 0x16460
.long 0xb0, 0xf0, 0xb0, 0x16780
.long 0xc0, 0x80, 0xc0, 0x15fb0
.long 0xd0, 0x90, 0xd0, 0x162d0
.long 0xe0, 0xa0, 0xe0, 0x165f0
.long 0xf0, 0xb0, 0xf0, 0x16910
.long 0x100, 0x140, 0x140, 0x154c0
.long 0x110, 0x150, 0x150, 0x157e0
.long 0x120, 0x160, 0x160, 0x15b00
.long 0x130, 0x170, 0x170, 0x17400
.long 0x140, 0x100, 0x100, 0x15650
.long 0x150, 0x110, 0x110, 0x15970
.long 0x160, 0x120, 0x120, 0x15c90
.long 0x170, 0x130, 0x130, 0x17590
.long 0x180, 0x1c0, 0x1c0, 0x16aa0
.long 0x190, 0x1d0, 0x1d0, 0x16dc0
.long 0x1a0, 0x1e0, 0x1e0, 0x170e0
.long 0x1b0, 0x1f0, 0x1f0, 0x189e0
.long 0x1c0, 0x180, 0x180, 0x16c30
.long 0x1d0, 0x190, 0x190, 0x16f50
.long 0x1e0, 0x1a0, 0x1a0, 0x17270
.long 0x1f0, 0x1b0, 0x1b0, 0x18b70
.long 0x200, 0x200, 0x240, 0x14850
.long 0x210, 0x210, 0x250, 0x14b70
.long 0x220, 0x220, 0x260, 0x14e90
.long 0x230, 0x230, 0x270, 0x151b0
.long 0x240, 0x240, 0x200, 0x149e0
.long 0x250, 0x250, 0x210, 0x14d00
.long 0x260, 0x260, 0x220, 0x15020
.long 0x270, 0x270, 0x230, 0x15340
.long 0x280, 0x280, 0x2c0, 0x15e30
.long 0x290, 0x290, 0x2d0, 0x16150
.long 0x2a0, 0x2a0, 0x2e0, 0x16470
.long 0x2b0, 0x2b0, 0x2f0, 0x16790
.long 0x2c0, 0x2c0, 0x280, 0x15fc0
.long 0x2d0, 0x2d0, 0x290, 0x162e0
.long 0x2e0, 0x2e0, 0x2a0, 0x16600
.long 0x2f0, 0x2f0, 0x2b0, 0x16920
.long 0x340, 0x300, 0x340, 0x154d0
.long 0x350, 0x310, 0x350, 0x157f0
.long 0x360, 0x320, 0x360, 0x15b10
.long 0x370, 0x330, 0x370, 0x17410
.long 0x300, 0x340, 0x300, 0x15660
.long 0x310, 0x350, 0x310, 0x15980
.long 0x320, 0x360, 0x320, 0x15ca0
.long 0x330, 0x370, 0x330, 0x175a0
.long 0x3c0, 0x380, 0x3c0, 0x16ab0
.long 0x3d0, 0x390, 0x3d0, 0x16dd0
.long 0x3e0, 0x3a0, 0x3e0, 0x170f0
.long 0x3f0, 0x3b0, 0x3f0, 0x189f0
.long 0x380, 0x3c0, 0x380, 0x16c40
.long 0x390, 0x3d0, 0x390, 0x16f60
.long 0x3a0, 0x3e0, 0x3a0, 0x17280
.long 0x3b0, 0x3f0, 0x3b0, 0x18b80
.long 0x0, 0x40, 0x0, 0x176e0
.long 0x10, 0x50, 0x10, 0x17a00
.long 0x20, 0x60, 0x20, 0x17d20
.long 0x30, 0x70, 0x30, 0x18040
.long 0x40, 0x0, 0x40, 0x17870
.long 0x50, 0x10, 0x50, 0x17b90
.long 0x60, 0x20, 0x60, 0x17eb0
.long 0x70, 0x30, 0x70, 0x181d0
.long 0x80, 0xc0, 0x80, 0x18cc0
.long 0x90, 0xd0, 0x90, 0x18fe0
.long 0xa0, 0xe0, 0xa0, 0x19300
.long 0xb0, 0xf0, 0xb0, 0x19620
.long 0xc0, 0x80, 0xc0, 0x18e50
.long 0xd0, 0x90, 0xd0, 0x19170
.long 0xe0, 0xa0, 0xe0, 0x19490
.long 0xf0, 0xb0, 0xf0, 0x197b0
.long 0x100, 0x140, 0x140, 0x18360
.long 0x110, 0x150, 0x150, 0x18680
.long 0x120, 0x160, 0x160, 0x19f80
.long 0x130, 0x170, 0x170, 0x1a2a0
.long 0x140, 0x100, 0x100, 0x184f0
.long 0x150, 0x110, 0x110, 0x18810
.long 0x160, 0x120, 0x120, 0x1a110
.long 0x170, 0x130, 0x130, 0x1a430
.long 0x180, 0x1c0, 0x1c0, 0x19940
.long 0x190, 0x1d0, 0x1d0, 0x19c60
.long 0x1a0, 0x1e0, 0x1e0, 0x1b560
.long 0x1b0, 0x1f0, 0x1f0, 0x1b880
.long 0x1c0, 0x180, 0x180, 0x19ad0
.long 0x1d0, 0x190, 0x190, 0x19df0
.long 0x1e0, 0x1a0, 0x1a0, 0x1b6f0
.long 0x1f0, 0x1b0, 0x1b0, 0x1ba10
.long 0x200, 0x200, 0x240, 0x176f0
.long 0x210, 0x210, 0x250, 0x17a10
.long 0x220, 0x220, 0x260, 0x17d30
.long 0x230, 0x230, 0x270, 0x18050
.long 0x240, 0x240, 0x200, 0x17880
.long 0x250, 0x250, 0x210, 0x17ba0
.long 0x260, 0x260, 0x220, 0x17ec0
.long 0x270, 0x270, 0x230, 0x181e0
.long 0x280, 0x280, 0x2c0, 0x18cd0
.long 0x290, 0x290, 0x2d0, 0x18ff0
.long 0x2a0, 0x2a0, 0x2e0, 0x19310
.long 0x2b0, 0x2b0, 0x2f0, 0x19630
.long 0x2c0, 0x2c0, 0x280, 0x18e60
.long 0x2d0, 0x2d0, 0x290, 0x19180
.long 0x2e0, 0x2e0, 0x2a0, 0x194a0
.long 0x2f0, 0x2f0, 0x2b0, 0x197c0
.long 0x340, 0x300, 0x340, 0x18370
.long 0x350, 0x310, 0x350, 0x18690
.long 0x360, 0x320, 0x360, 0x19f90
.long 0x370, 0x330, 0x370, 0x1a2b0
.long 0x300, 0x340, 0x300, 0x18500
.long 0x310, 0x350, 0x310, 0x18820
.long 0x320, 0x360, 0x320, 0x1a120
.long 0x330, 0x370, 0x330, 0x1a440
.long 0x3c0, 0x380, 0x3c0, 0x19950
.long 0x3d0, 0x390, 0x3d0, 0x19c70
.long 0x3e0, 0x3a0, 0x3e0, 0x1b570
.long 0x3f0, 0x3b0, 0x3f0, 0x1b890
.long 0x380, 0x3c0, 0x380, 0x19ae0
.long 0x390, 0x3d0, 0x390, 0x19e00
.long 0x3a0, 0x3e0, 0x3a0, 0x1b700
.long 0x3b0, 0x3f0, 0x3b0, 0x1ba20
.long 0x0, 0x40, 0x0, 0x17720
.long 0x10, 0x50, 0x10, 0x17a40
.long 0x20, 0x60, 0x20, 0x17d60
.long 0x30, 0x70, 0x30, 0x18080
.long 0x40, 0x0, 0x40, 0x178b0
.long 0x50, 0x10, 0x50, 0x17bd0
.long 0x60, 0x20, 0x60, 0x17ef0
.long 0x70, 0x30, 0x70, 0x18210
.long 0x80, 0xc0, 0x80, 0x18d00
.long 0x90, 0xd0, 0x90, 0x19020
.long 0xa0, 0xe0, 0xa0, 0x19340
.long 0xb0, 0xf0, 0xb0, 0x19660
.long 0xc0, 0x80, 0xc0, 0x18e90
.long 0xd0, 0x90, 0xd0, 0x191b0
.long 0xe0, 0xa0, 0xe0, 0x194d0
.long 0xf0, 0xb0, 0xf0, 0x197f0
.long 0x100, 0x140, 0x140, 0x183a0
.long 0x110, 0x150, 0x150, 0x186c0
.long 0x120, 0x160, 0x160, 0x19fc0
.long 0x130, 0x170, 0x170, 0x1a2e0
.long 0x140, 0x100, 0x100, 0x18530
.long 0x150, 0x110, 0x110, 0x18850
.long 0x160, 0x120, 0x120, 0x1a150
.long 0x170, 0x130, 0x130, 0x1a470
.long 0x180, 0x1c0, 0x1c0, 0x19980
.long 0x190, 0x1d0, 0x1d0, 0x19ca0
.long 0x1a0, 0x1e0, 0x1e0, 0x1b5a0
.long 0x1b0, 0x1f0, 0x1f0, 0x1b8c0
.long 0x1c0, 0x180, 0x180, 0x19b10
.long 0x1d0, 0x190, 0x190, 0x19e30
.long 0x1e0, 0x1a0, 0x1a0, 0x1b730
.long 0x1f0, 0x1b0, 0x1b0, 0x1ba50
.long 0x200, 0x200, 0x240, 0x17730
.long 0x210, 0x210, 0x250, 0x17a50
.long 0x220, 0x220, 0x260, 0x17d70
.long 0x230, 0x230, 0x270, 0x18090
.long 0x240, 0x240, 0x200, 0x178c0
.long 0x250, 0x250, 0x210, 0x17be0
.long 0x260, 0x260, 0x220, 0x17f00
.long 0x270, 0x270, 0x230, 0x18220
.long 0x280, 0x280, 0x2c0, 0x18d10
.long 0x290, 0x290, 0x2d0, 0x19030
.long 0x2a0, 0x2a0, 0x2e0, 0x19350
.long 0x2b0, 0x2b0, 0x2f0, 0x19670
.long 0x2c0, 0x2c0, 0x280, 0x18ea0
.long 0x2d0, 0x2d0, 0x290, 0x191c0
.long 0x2e0, 0x2e0, 0x2a0, 0x194e0
.long 0x2f0, 0x2f0, 0x2b0, 0x19800
.long 0x340, 0x300, 0x340, 0x183b0
.long 0x350, 0x310, 0x350, 0x186d0
.long 0x360, 0x320, 0x360, 0x19fd0
.long 0x370, 0x330, 0x370, 0x1a2f0
.long 0x300, 0x340, 0x300, 0x18540
.long 0x310, 0x350, 0x310, 0x18860
.long 0x320, 0x360, 0x320, 0x1a160
.long 0x330, 0x370, 0x330, 0x1a480
.long 0x3c0, 0x380, 0x3c0, 0x19990
.long 0x3d0, 0x390, 0x3d0, 0x19cb0
.long 0x3e0, 0x3a0, 0x3e0, 0x1b5b0
.long 0x3f0, 0x3b0, 0x3f0, 0x1b8d0
.long 0x380, 0x3c0, 0x380, 0x19b20
.long 0x390, 0x3d0, 0x390, 0x19e40
.long 0x3a0, 0x3e0, 0x3a0, 0x1b740
.long 0x3b0, 0x3f0, 0x3b0, 0x1ba60
.long 0x0, 0x0, 0xfd200, 0x26140
.long 0x10, 0x10, 0xfd380, 0x262d0
.long 0x20, 0x20, 0x112200, 0x27720
.long 0x30, 0x30, 0x112380, 0x278b0
.long 0x40, 0x40, 0xfd220, 0x26160
.long 0x50, 0x50, 0xfd3a0, 0x262f0
.long 0x60, 0x60, 0x112220, 0x27740
.long 0x70, 0x70, 0x1123a0, 0x278d0
.long 0x80, 0x1000, 0xfd280, 0x261c0
.long 0x90, 0x1010, 0xfd400, 0x26350
.long 0xa0, 0x1020, 0x112280, 0x277a0
.long 0xb0, 0x1030, 0x112400, 0x27930
.long 0xc0, 0x1040, 0xfd2a0, 0x261e0
.long 0xd0, 0x1050, 0xfd420, 0x26370
.long 0xe0, 0x1060, 0x1122a0, 0x277c0
.long 0xf0, 0x1070, 0x112420, 0x27950
.long 0x100, 0x100, 0xfd210, 0x26150
.long 0x110, 0x110, 0xfd390, 0x262e0
.long 0x120, 0x120, 0x112210, 0x27730
.long 0x130, 0x130, 0x112390, 0x278c0
.long 0x140, 0x140, 0xfd230, 0x26170
.long 0x150, 0x150, 0xfd3b0, 0x26300
.long 0x160, 0x160, 0x112230, 0x27750
.long 0x170, 0x170, 0x1123b0, 0x278e0
.long 0x180, 0x1100, 0xfd290, 0x261d0
.long 0x190, 0x1110, 0xfd410, 0x26360
.long 0x1a0, 0x1120, 0x112290, 0x277b0
.long 0x1b0, 0x1130, 0x112410, 0x27940
.long 0x1c0, 0x1140, 0xfd2b0, 0x261f0
.long 0x1d0, 0x1150, 0xfd430, 0x26380
.long 0x1e0, 0x1160, 0x1122b0, 0x277d0
.long 0x1f0, 0x1170, 0x112430, 0x27960
.long 0x200, 0x200, 0xfd208, 0x26148
.long 0x210, 0x210, 0xfd388, 0x262d8
.long 0x220, 0x220, 0x112208, 0x27728
.long 0x230, 0x230, 0x112388, 0x278b8
.long 0x240, 0x240, 0xfd228, 0x26168
.long 0x250, 0x250, 0xfd3a8, 0x262f8
.long 0x260, 0x260, 0x112228, 0x27748
.long 0x270, 0x270, 0x1123a8, 0x278d8
.long 0x280, 0x1200, 0xfd288, 0x261c8
.long 0x290, 0x1210, 0xfd408, 0x26358
.long 0x2a0, 0x1220, 0x112288, 0x277a8
.long 0x2b0, 0x1230, 0x112408, 0x27938
.long 0x2c0, 0x1240, 0xfd2a8, 0x261e8
.long 0x2d0, 0x1250, 0xfd428, 0x26378
.long 0x2e0, 0x1260, 0x1122a8, 0x277c8
.long 0x2f0, 0x1270, 0x112428, 0x27958
.long 0x300, 0x300, 0xfd218, 0x26158
.long 0x310, 0x310, 0xfd398, 0x262e8
.long 0x320, 0x320, 0x112218, 0x27738
.long 0x330, 0x330, 0x112398, 0x278c8
.long 0x340, 0x340, 0xfd238, 0x26178
.long 0x350, 0x350, 0xfd3b8, 0x26308
.long 0x360, 0x360, 0x112238, 0x27758
.long 0x370, 0x370, 0x1123b8, 0x278e8
.long 0x80000000, 0x1300, 0xfd298, 0x261d8
.long 0x80000000, 0x1310, 0xfd418, 0x26368
.long 0x80000000, 0x1320, 0x112298, 0x277b8
.long 0x80000000, 0x1330, 0x112418, 0x27948
.long 0x80000000, 0x1340, 0xfd2b8, 0x261f8
.long 0x80000000, 0x1350, 0xfd438, 0x26388
.long 0x80000000, 0x1360, 0x1122b8, 0x277d8
.long 0x80000000, 0x1370, 0x112438, 0x27968
.long 0x0, 0x800, 0xfd240, 0x26180
.long 0x10, 0x810, 0xfd3c0, 0x26310
.long 0x20, 0x820, 0x112240, 0x27760
.long 0x30, 0x830, 0x1123c0, 0x278f0
.long 0x40, 0x840, 0xfd260, 0x261a0
.long 0x50, 0x850, 0xfd3e0, 0x26330
.long 0x60, 0x860, 0x112260, 0x27780
.long 0x70, 0x870, 0x1123e0, 0x27910
.long 0x80, 0x1800, 0xfd2c0, 0x26200
.long 0x90, 0x1810, 0xfd440, 0x26390
.long 0xa0, 0x1820, 0x1122c0, 0x277e0
.long 0xb0, 0x1830, 0x112440, 0x27970
.long 0xc0, 0x1840, 0xfd2e0, 0x26220
.long 0xd0, 0x1850, 0xfd460, 0x263b0
.long 0xe0, 0x1860, 0x1122e0, 0x27800
.long 0xf0, 0x1870, 0x112460, 0x27990
.long 0x100, 0x900, 0xfd250, 0x26190
.long 0x110, 0x910, 0xfd3d0, 0x26320
.long 0x120, 0x920, 0x112250, 0x27770
.long 0x130, 0x930, 0x1123d0, 0x27900
.long 0x140, 0x940, 0xfd270, 0x261b0
.long 0x150, 0x950, 0xfd3f0, 0x26340
.long 0x160, 0x960, 0x112270, 0x27790
.long 0x170, 0x970, 0x1123f0, 0x27920
.long 0x180, 0x1900, 0xfd2d0, 0x26210
.long 0x190, 0x1910, 0xfd450, 0x263a0
.long 0x1a0, 0x1920, 0x1122d0, 0x277f0
.long 0x1b0, 0x1930, 0x112450, 0x27980
.long 0x1c0, 0x1940, 0xfd2f0, 0x26230
.long 0x1d0, 0x1950, 0xfd470, 0x263c0
.long 0x1e0, 0x1960, 0x1122f0, 0x27810
.long 0x1f0, 0x1970, 0x112470, 0x279a0
.long 0x200, 0xa00, 0xfd248, 0x26188
.long 0x210, 0xa10, 0xfd3c8, 0x26318
.long 0x220, 0xa20, 0x112248, 0x27768
.long 0x230, 0xa30, 0x1123c8, 0x278f8
.long 0x240, 0xa40, 0xfd268, 0x261a8
.long 0x250, 0xa50, 0xfd3e8, 0x26338
.long 0x260, 0xa60, 0x112268, 0x27788
.long 0x270, 0xa70, 0x1123e8, 0x27918
.long 0x280, 0x1a00, 0xfd2c8, 0x26208
.long 0x290, 0x1a10, 0xfd448, 0x26398
.long 0x2a0, 0x1a20, 0x1122c8, 0x277e8
.long 0x2b0, 0x1a30, 0x112448, 0x27978
.long 0x2c0, 0x1a40, 0xfd2e8, 0x26228
.long 0x2d0, 0x1a50, 0xfd468, 0x263b8
.long 0x2e0, 0x1a60, 0x1122e8, 0x27808
.long 0x2f0, 0x1a70, 0x112468, 0x27998
.long 0x300, 0xb00, 0xfd258, 0x26198
.long 0x310, 0xb10, 0xfd3d8, 0x26328
.long 0x320, 0xb20, 0x112258, 0x27778
.long 0x330, 0xb30, 0x1123d8, 0x27908
.long 0x340, 0xb40, 0xfd278, 0x261b8
.long 0x350, 0xb50, 0xfd3f8, 0x26348
.long 0x360, 0xb60, 0x112278, 0x27798
.long 0x370, 0xb70, 0x1123f8, 0x27928
.long 0x80000000, 0x1b00, 0xfd2d8, 0x26218
.long 0x80000000, 0x1b10, 0xfd458, 0x263a8
.long 0x80000000, 0x1b20, 0x1122d8, 0x277f8
.long 0x80000000, 0x1b30, 0x112458, 0x27988
.long 0x80000000, 0x1b40, 0xfd2f8, 0x26238
.long 0x80000000, 0x1b50, 0xfd478, 0x263c8
.long 0x80000000, 0x1b60, 0x1122f8, 0x27818
.long 0x80000000, 0x1b70, 0x112478, 0x279a8
.long 0x0, 0x2000, 0xfd300, 0x26240
.long 0x10, 0x2010, 0xfd480, 0x263d0
.long 0x20, 0x2020, 0x112300, 0x27820
.long 0x30, 0x2030, 0x112480, 0x279b0
.long 0x40, 0x2040, 0xfd320, 0x26260
.long 0x50, 0x2050, 0xfd4a0, 0x263f0
.long 0x60, 0x2060, 0x112320, 0x27840
.long 0x70, 0x2070, 0x1124a0, 0x279d0
.long 0x80, 0x1000, 0xfd280, 0x261c0
.long 0x90, 0x1010, 0xfd400, 0x26350
.long 0xa0, 0x1020, 0x112280, 0x277a0
.long 0xb0, 0x1030, 0x112400, 0x27930
.long 0xc0, 0x1040, 0xfd2a0, 0x261e0
.long 0xd0, 0x1050, 0xfd420, 0x26370
.long 0xe0, 0x1060, 0x1122a0, 0x277c0
.long 0xf0, 0x1070, 0x112420, 0x27950
.long 0x100, 0x2100, 0xfd310, 0x26250
.long 0x110, 0x2110, 0xfd490, 0x263e0
.long 0x120, 0x2120, 0x112310, 0x27830
.long 0x130, 0x2130, 0x112490, 0x279c0
.long 0x140, 0x2140, 0xfd330, 0x26270
.long 0x150, 0x2150, 0xfd4b0, 0x26400
.long 0x160, 0x2160, 0x112330, 0x27850
.long 0x170, 0x2170, 0x1124b0, 0x279e0
.long 0x180, 0x1100, 0xfd290, 0x261d0
.long 0x190, 0x1110, 0xfd410, 0x26360
.long 0x1a0, 0x1120, 0x112290, 0x277b0
.long 0x1b0, 0x1130, 0x112410, 0x27940
.long 0x1c0, 0x1140, 0xfd2b0, 0x261f0
.long 0x1d0, 0x1150, 0xfd430, 0x26380
.long 0x1e0, 0x1160, 0x1122b0, 0x277d0
.long 0x1f0, 0x1170, 0x112430, 0x27960
.long 0x200, 0x2200, 0xfd308, 0x26248
.long 0x210, 0x2210, 0xfd488, 0x263d8
.long 0x220, 0x2220, 0x112308, 0x27828
.long 0x230, 0x2230, 0x112488, 0x279b8
.long 0x240, 0x2240, 0xfd328, 0x26268
.long 0x250, 0x2250, 0xfd4a8, 0x263f8
.long 0x260, 0x2260, 0x112328, 0x27848
.long 0x270, 0x2270, 0x1124a8, 0x279d8
.long 0x280, 0x1200, 0xfd288, 0x261c8
.long 0x290, 0x1210, 0xfd408, 0x26358
.long 0x2a0, 0x1220, 0x112288, 0x277a8
.long 0x2b0, 0x1230, 0x112408, 0x27938
.long 0x2c0, 0x1240, 0xfd2a8, 0x261e8
.long 0x2d0, 0x1250, 0xfd428, 0x26378
.long 0x2e0, 0x1260, 0x1122a8, 0x277c8
.long 0x2f0, 0x1270, 0x112428, 0x27958
.long 0x300, 0x2300, 0xfd318, 0x26258
.long 0x310, 0x2310, 0xfd498, 0x263e8
.long 0x320, 0x2320, 0x112318, 0x27838
.long 0x330, 0x2330, 0x112498, 0x279c8
.long 0x340, 0x2340, 0xfd338, 0x26278
.long 0x350, 0x2350, 0xfd4b8, 0x26408
.long 0x360, 0x2360, 0x112338, 0x27858
.long 0x370, 0x2370, 0x1124b8, 0x279e8
.long 0x80000000, 0x1300, 0xfd298, 0x261d8
.long 0x80000000, 0x1310, 0xfd418, 0x26368
.long 0x80000000, 0x1320, 0x112298, 0x277b8
.long 0x80000000, 0x1330, 0x112418, 0x27948
.long 0x80000000, 0x1340, 0xfd2b8, 0x261f8
.long 0x80000000, 0x1350, 0xfd438, 0x26388
.long 0x80000000, 0x1360, 0x1122b8, 0x277d8
.long 0x80000000, 0x1370, 0x112438, 0x27968
.long 0x0, 0x2800, 0xfd340, 0x26280
.long 0x10, 0x2810, 0xfd4c0, 0x26410
.long 0x20, 0x2820, 0x112340, 0x27860
.long 0x30, 0x2830, 0x1124c0, 0x279f0
.long 0x40, 0x2840, 0xfd360, 0x262a0
.long 0x50, 0x2850, 0xfd4e0, 0x26430
.long 0x60, 0x2860, 0x112360, 0x27880
.long 0x70, 0x2870, 0x1124e0, 0x27a10
.long 0x80, 0x1800, 0xfd2c0, 0x26200
.long 0x90, 0x1810, 0xfd440, 0x26390
.long 0xa0, 0x1820, 0x1122c0, 0x277e0
.long 0xb0, 0x1830, 0x112440, 0x27970
.long 0xc0, 0x1840, 0xfd2e0, 0x26220
.long 0xd0, 0x1850, 0xfd460, 0x263b0
.long 0xe0, 0x1860, 0x1122e0, 0x27800
.long 0xf0, 0x1870, 0x112460, 0x27990
.long 0x100, 0x2900, 0xfd350, 0x26290
.long 0x110, 0x2910, 0xfd4d0, 0x26420
.long 0x120, 0x2920, 0x112350, 0x27870
.long 0x130, 0x2930, 0x1124d0, 0x27a00
.long 0x140, 0x2940, 0xfd370, 0x262b0
.long 0x150, 0x2950, 0xfd4f0, 0x26440
.long 0x160, 0x2960, 0x112370, 0x27890
.long 0x170, 0x2970, 0x1124f0, 0x27a20
.long 0x180, 0x1900, 0xfd2d0, 0x26210
.long 0x190, 0x1910, 0xfd450, 0x263a0
.long 0x1a0, 0x1920, 0x1122d0, 0x277f0
.long 0x1b0, 0x1930, 0x112450, 0x27980
.long 0x1c0, 0x1940, 0xfd2f0, 0x26230
.long 0x1d0, 0x1950, 0xfd470, 0x263c0
.long 0x1e0, 0x1960, 0x1122f0, 0x27810
.long 0x1f0, 0x1970, 0x112470, 0x279a0
.long 0x200, 0x2a00, 0xfd348, 0x26288
.long 0x210, 0x2a10, 0xfd4c8, 0x26418
.long 0x220, 0x2a20, 0x112348, 0x27868
.long 0x230, 0x2a30, 0x1124c8, 0x279f8
.long 0x240, 0x2a40, 0xfd368, 0x262a8
.long 0x250, 0x2a50, 0xfd4e8, 0x26438
.long 0x260, 0x2a60, 0x112368, 0x27888
.long 0x270, 0x2a70, 0x1124e8, 0x27a18
.long 0x280, 0x1a00, 0xfd2c8, 0x26208
.long 0x290, 0x1a10, 0xfd448, 0x26398
.long 0x2a0, 0x1a20, 0x1122c8, 0x277e8
.long 0x2b0, 0x1a30, 0x112448, 0x27978
.long 0x2c0, 0x1a40, 0xfd2e8, 0x26228
.long 0x2d0, 0x1a50, 0xfd468, 0x263b8
.long 0x2e0, 0x1a60, 0x1122e8, 0x27808
.long 0x2f0, 0x1a70, 0x112468, 0x27998
.long 0x300, 0x2b00, 0xfd358, 0x26298
.long 0x310, 0x2b10, 0xfd4d8, 0x26428
.long 0x320, 0x2b20, 0x112358, 0x27878
.long 0x330, 0x2b30, 0x1124d8, 0x27a08
.long 0x340, 0x2b40, 0xfd378, 0x262b8
.long 0x350, 0x2b50, 0xfd4f8, 0x26448
.long 0x360, 0x2b60, 0x112378, 0x27898
.long 0x370, 0x2b70, 0x1124f8, 0x27a28
.long 0x80000000, 0x1b00, 0xfd2d8, 0x26218
.long 0x80000000, 0x1b10, 0xfd458, 0x263a8
.long 0x80000000, 0x1b20, 0x1122d8, 0x277f8
.long 0x80000000, 0x1b30, 0x112458, 0x27988
.long 0x80000000, 0x1b40, 0xfd2f8, 0x26238
.long 0x80000000, 0x1b50, 0xfd478, 0x263c8
.long 0x80000000, 0x1b60, 0x1122f8, 0x27818
.long 0x80000000, 0x1b70, 0x112478, 0x279a8
.long 0x19000, 0x19400, 0x0, 0x130
.long 0x19000, 0x19400, 0x220, 0x310
.long 0x19000, 0x19400, 0x440, 0x570
.long 0x19000, 0x19400, 0x660, 0x750
.long 0x19040, 0x19440, 0x10, 0x3000
.long 0x19040, 0x19440, 0x230, 0x3220
.long 0x19040, 0x19440, 0x450, 0x3440
.long 0x19040, 0x19440, 0x670, 0x3660
.long 0x19080, 0x19480, 0x20, 0x3010
.long 0x19080, 0x19480, 0x200, 0x3230
.long 0x19080, 0x19480, 0x460, 0x3450
.long 0x19080, 0x19480, 0x640, 0x3670
.long 0x190c0, 0x194c0, 0x30, 0x3020
.long 0x190c0, 0x194c0, 0x210, 0x3200
.long 0x190c0, 0x194c0, 0x470, 0x3460
.long 0x190c0, 0x194c0, 0x650, 0x3640
.long 0x19100, 0x19500, 0x40, 0x170
.long 0x19100, 0x19500, 0x260, 0x350
.long 0x19100, 0x19500, 0x400, 0x530
.long 0x19100, 0x19500, 0x620, 0x710
.long 0x19140, 0x19540, 0x50, 0x3040
.long 0x19140, 0x19540, 0x270, 0x3260
.long 0x19140, 0x19540, 0x410, 0x3400
.long 0x19140, 0x19540, 0x630, 0x3620
.long 0x19180, 0x19580, 0x60, 0x3050
.long 0x19180, 0x19580, 0x240, 0x3270
.long 0x19180, 0x19580, 0x420, 0x3410
.long 0x19180, 0x19580, 0x600, 0x3630
.long 0x191c0, 0x195c0, 0x70, 0x3060
.long 0x191c0, 0x195c0, 0x250, 0x3240
.long 0x191c0, 0x195c0, 0x430, 0x3420
.long 0x191c0, 0x195c0, 0x610, 0x3600
.long 0x19200, 0x19600, 0x80, 0x1b0
.long 0x19200, 0x19600, 0x2a0, 0x390
.long 0x19200, 0x19600, 0x4c0, 0x5f0
.long 0x19200, 0x19600, 0x6e0, 0x7d0
.long 0x19240, 0x19640, 0x90, 0x3080
.long 0x19240, 0x19640, 0x2b0, 0x32a0
.long 0x19240, 0x19640, 0x4d0, 0x34c0
.long 0x19240, 0x19640, 0x6f0, 0x36e0
.long 0x19280, 0x19680, 0xa0, 0x3090
.long 0x19280, 0x19680, 0x280, 0x32b0
.long 0x19280, 0x19680, 0x4e0, 0x34d0
.long 0x19280, 0x19680, 0x6c0, 0x36f0
.long 0x192c0, 0x196c0, 0xb0, 0x30a0
.long 0x192c0, 0x196c0, 0x290, 0x3280
.long 0x192c0, 0x196c0, 0x4f0, 0x34e0
.long 0x192c0, 0x196c0, 0x6d0, 0x36c0
.long 0x19300, 0x19700, 0xc0, 0x1f0
.long 0x19300, 0x19700, 0x2e0, 0x3d0
.long 0x19300, 0x19700, 0x480, 0x5b0
.long 0x19300, 0x19700, 0x6a0, 0x790
.long 0x19340, 0x19740, 0xd0, 0x30c0
.long 0x19340, 0x19740, 0x2f0, 0x32e0
.long 0x19340, 0x19740, 0x490, 0x3480
.long 0x19340, 0x19740, 0x6b0, 0x36a0
.long 0x19380, 0x19780, 0xe0, 0x30d0
.long 0x19380, 0x19780, 0x2c0, 0x32f0
.long 0x19380, 0x19780, 0x4a0, 0x3490
.long 0x19380, 0x19780, 0x680, 0x36b0
.long 0x193c0, 0x197c0, 0xf0, 0x30e0
.long 0x193c0, 0x197c0, 0x2d0, 0x32c0
.long 0x193c0, 0x197c0, 0x4b0, 0x34a0
.long 0x193c0, 0x197c0, 0x690, 0x3680
.long 0x19400, 0x19000, 0x800, 0x930
.long 0x19400, 0x19000, 0xa20, 0xb10
.long 0x19400, 0x19000, 0xc40, 0xd70
.long 0x19400, 0x19000, 0xe60, 0xf50
.long 0x19440, 0x19040, 0x810, 0x3800
.long 0x19440, 0x19040, 0xa30, 0x3a20
.long 0x19440, 0x19040, 0xc50, 0x3c40
.long 0x19440, 0x19040, 0xe70, 0x3e60
.long 0x19480, 0x19080, 0x820, 0x3810
.long 0x19480, 0x19080, 0xa00, 0x3a30
.long 0x19480, 0x19080, 0xc60, 0x3c50
.long 0x19480, 0x19080, 0xe40, 0x3e70
.long 0x194c0, 0x190c0, 0x830, 0x3820
.long 0x194c0, 0x190c0, 0xa10, 0x3a00
.long 0x194c0, 0x190c0, 0xc70, 0x3c60
.long 0x194c0, 0x190c0, 0xe50, 0x3e40
.long 0x19500, 0x19100, 0x840, 0x970
.long 0x19500, 0x19100, 0xa60, 0xb50
.long 0x19500, 0x19100, 0xc00, 0xd30
.long 0x19500, 0x19100, 0xe20, 0xf10
.long 0x19540, 0x19140, 0x850, 0x3840
.long 0x19540, 0x19140, 0xa70, 0x3a60
.long 0x19540, 0x19140, 0xc10, 0x3c00
.long 0x19540, 0x19140, 0xe30, 0x3e20
.long 0x19580, 0x19180, 0x860, 0x3850
.long 0x19580, 0x19180, 0xa40, 0x3a70
.long 0x19580, 0x19180, 0xc20, 0x3c10
.long 0x19580, 0x19180, 0xe00, 0x3e30
.long 0x195c0, 0x191c0, 0x870, 0x3860
.long 0x195c0, 0x191c0, 0xa50, 0x3a40
.long 0x195c0, 0x191c0, 0xc30, 0x3c20
.long 0x195c0, 0x191c0, 0xe10, 0x3e00
.long 0x19600, 0x19200, 0x880, 0x9b0
.long 0x19600, 0x19200, 0xaa0, 0xb90
.long 0x19600, 0x19200, 0xcc0, 0xdf0
.long 0x19600, 0x19200, 0xee0, 0xfd0
.long 0x19640, 0x19240, 0x890, 0x3880
.long 0x19640, 0x19240, 0xab0, 0x3aa0
.long 0x19640, 0x19240, 0xcd0, 0x3cc0
.long 0x19640, 0x19240, 0xef0, 0x3ee0
.long 0x19680, 0x19280, 0x8a0, 0x3890
.long 0x19680, 0x19280, 0xa80, 0x3ab0
.long 0x19680, 0x19280, 0xce0, 0x3cd0
.long 0x19680, 0x19280, 0xec0, 0x3ef0
.long 0x196c0, 0x192c0, 0x8b0, 0x38a0
.long 0x196c0, 0x192c0, 0xa90, 0x3a80
.long 0x196c0, 0x192c0, 0xcf0, 0x3ce0
.long 0x196c0, 0x192c0, 0xed0, 0x3ec0
.long 0x19700, 0x19300, 0x8c0, 0x9f0
.long 0x19700, 0x19300, 0xae0, 0xbd0
.long 0x19700, 0x19300, 0xc80, 0xdb0
.long 0x19700, 0x19300, 0xea0, 0xf90
.long 0x19740, 0x19340, 0x8d0, 0x38c0
.long 0x19740, 0x19340, 0xaf0, 0x3ae0
.long 0x19740, 0x19340, 0xc90, 0x3c80
.long 0x19740, 0x19340, 0xeb0, 0x3ea0
.long 0x19780, 0x19380, 0x8e0, 0x38d0
.long 0x19780, 0x19380, 0xac0, 0x3af0
.long 0x19780, 0x19380, 0xca0, 0x3c90
.long 0x19780, 0x19380, 0xe80, 0x3eb0
.long 0x197c0, 0x193c0, 0x8f0, 0x38e0
.long 0x197c0, 0x193c0, 0xad0, 0x3ac0
.long 0x197c0, 0x193c0, 0xcb0, 0x3ca0
.long 0x197c0, 0x193c0, 0xe90, 0x3e80
.long 0x19800, 0x19c00, 0x100, 0x3030
.long 0x19800, 0x19c00, 0x320, 0x3210
.long 0x19800, 0x19c00, 0x540, 0x3470
.long 0x19800, 0x19c00, 0x760, 0x3650
.long 0x19840, 0x19c40, 0x110, 0x3100
.long 0x19840, 0x19c40, 0x330, 0x3320
.long 0x19840, 0x19c40, 0x550, 0x3540
.long 0x19840, 0x19c40, 0x770, 0x3760
.long 0x19880, 0x19c80, 0x120, 0x3110
.long 0x19880, 0x19c80, 0x300, 0x3330
.long 0x19880, 0x19c80, 0x560, 0x3550
.long 0x19880, 0x19c80, 0x740, 0x3770
.long 0x198c0, 0x19cc0, 0x14840, 0x14840
.long 0x198c0, 0x19cc0, 0x14a40, 0x14a40
.long 0x198c0, 0x19cc0, 0x14c40, 0x14c40
.long 0x198c0, 0x19cc0, 0x14e40, 0x14e40
.long 0x19900, 0x19d00, 0x140, 0x3070
.long 0x19900, 0x19d00, 0x360, 0x3250
.long 0x19900, 0x19d00, 0x500, 0x3430
.long 0x19900, 0x19d00, 0x720, 0x3610
.long 0x19940, 0x19d40, 0x150, 0x3140
.long 0x19940, 0x19d40, 0x370, 0x3360
.long 0x19940, 0x19d40, 0x510, 0x3500
.long 0x19940, 0x19d40, 0x730, 0x3720
.long 0x19980, 0x19d80, 0x160, 0x3150
.long 0x19980, 0x19d80, 0x340, 0x3370
.long 0x19980, 0x19d80, 0x520, 0x3510
.long 0x19980, 0x19d80, 0x700, 0x3730
.long 0x199c0, 0x19dc0, 0x14850, 0x14850
.long 0x199c0, 0x19dc0, 0x14a50, 0x14a50
.long 0x199c0, 0x19dc0, 0x14c50, 0x14c50
.long 0x199c0, 0x19dc0, 0x14e50, 0x14e50
.long 0x19a00, 0x19e00, 0x180, 0x30b0
.long 0x19a00, 0x19e00, 0x3a0, 0x3290
.long 0x19a00, 0x19e00, 0x5c0, 0x34f0
.long 0x19a00, 0x19e00, 0x7e0, 0x36d0
.long 0x19a40, 0x19e40, 0x190, 0x3180
.long 0x19a40, 0x19e40, 0x3b0, 0x33a0
.long 0x19a40, 0x19e40, 0x5d0, 0x35c0
.long 0x19a40, 0x19e40, 0x7f0, 0x37e0
.long 0x19a80, 0x19e80, 0x1a0, 0x3190
.long 0x19a80, 0x19e80, 0x380, 0x33b0
.long 0x19a80, 0x19e80, 0x5e0, 0x35d0
.long 0x19a80, 0x19e80, 0x7c0, 0x37f0
.long 0x19ac0, 0x19ec0, 0x14860, 0x14860
.long 0x19ac0, 0x19ec0, 0x14a60, 0x14a60
.long 0x19ac0, 0x19ec0, 0x14c60, 0x14c60
.long 0x19ac0, 0x19ec0, 0x14e60, 0x14e60
.long 0x19b00, 0x19f00, 0x1c0, 0x30f0
.long 0x19b00, 0x19f00, 0x3e0, 0x32d0
.long 0x19b00, 0x19f00, 0x580, 0x34b0
.long 0x19b00, 0x19f00, 0x7a0, 0x3690
.long 0x19b40, 0x19f40, 0x1d0, 0x31c0
.long 0x19b40, 0x19f40, 0x3f0, 0x33e0
.long 0x19b40, 0x19f40, 0x590, 0x3580
.long 0x19b40, 0x19f40, 0x7b0, 0x37a0
.long 0x19b80, 0x19f80, 0x1e0, 0x31d0
.long 0x19b80, 0x19f80, 0x3c0, 0x33f0
.long 0x19b80, 0x19f80, 0x5a0, 0x3590
.long 0x19b80, 0x19f80, 0x780, 0x37b0
.long 0x19bc0, 0x19fc0, 0x14870, 0x14870
.long 0x19bc0, 0x19fc0, 0x14a70, 0x14a70
.long 0x19bc0, 0x19fc0, 0x14c70, 0x14c70
.long 0x19bc0, 0x19fc0, 0x14e70, 0x14e70
.long 0x19c00, 0x19800, 0x900, 0x3830
.long 0x19c00, 0x19800, 0xb20, 0x3a10
.long 0x19c00, 0x19800, 0xd40, 0x3c70
.long 0x19c00, 0x19800, 0xf60, 0x3e50
.long 0x19c40, 0x19840, 0x910, 0x3900
.long 0x19c40, 0x19840, 0xb30, 0x3b20
.long 0x19c40, 0x19840, 0xd50, 0x3d40
.long 0x19c40, 0x19840, 0xf70, 0x3f60
.long 0x19c80, 0x19880, 0x920, 0x3910
.long 0x19c80, 0x19880, 0xb00, 0x3b30
.long 0x19c80, 0x19880, 0xd60, 0x3d50
.long 0x19c80, 0x19880, 0xf40, 0x3f70
.long 0x19cc0, 0x198c0, 0x15040, 0x15040
.long 0x19cc0, 0x198c0, 0x15240, 0x15240
.long 0x19cc0, 0x198c0, 0x15440, 0x15440
.long 0x19cc0, 0x198c0, 0x15640, 0x15640
.long 0x19d00, 0x19900, 0x940, 0x3870
.long 0x19d00, 0x19900, 0xb60, 0x3a50
.long 0x19d00, 0x19900, 0xd00, 0x3c30
.long 0x19d00, 0x19900, 0xf20, 0x3e10
.long 0x19d40, 0x19940, 0x950, 0x3940
.long 0x19d40, 0x19940, 0xb70, 0x3b60
.long 0x19d40, 0x19940, 0xd10, 0x3d00
.long 0x19d40, 0x19940, 0xf30, 0x3f20
.long 0x19d80, 0x19980, 0x960, 0x3950
.long 0x19d80, 0x19980, 0xb40, 0x3b70
.long 0x19d80, 0x19980, 0xd20, 0x3d10
.long 0x19d80, 0x19980, 0xf00, 0x3f30
.long 0x19dc0, 0x199c0, 0x15050, 0x15050
.long 0x19dc0, 0x199c0, 0x15250, 0x15250
.long 0x19dc0, 0x199c0, 0x15450, 0x15450
.long 0x19dc0, 0x199c0, 0x15650, 0x15650
.long 0x19e00, 0x19a00, 0x980, 0x38b0
.long 0x19e00, 0x19a00, 0xba0, 0x3a90
.long 0x19e00, 0x19a00, 0xdc0, 0x3cf0
.long 0x19e00, 0x19a00, 0xfe0, 0x3ed0
.long 0x19e40, 0x19a40, 0x990, 0x3980
.long 0x19e40, 0x19a40, 0xbb0, 0x3ba0
.long 0x19e40, 0x19a40, 0xdd0, 0x3dc0
.long 0x19e40, 0x19a40, 0xff0, 0x3fe0
.long 0x19e80, 0x19a80, 0x9a0, 0x3990
.long 0x19e80, 0x19a80, 0xb80, 0x3bb0
.long 0x19e80, 0x19a80, 0xde0, 0x3dd0
.long 0x19e80, 0x19a80, 0xfc0, 0x3ff0
.long 0x19ec0, 0x19ac0, 0x15060, 0x15060
.long 0x19ec0, 0x19ac0, 0x15260, 0x15260
.long 0x19ec0, 0x19ac0, 0x15460, 0x15460
.long 0x19ec0, 0x19ac0, 0x15660, 0x15660
.long 0x19f00, 0x19b00, 0x9c0, 0x38f0
.long 0x19f00, 0x19b00, 0xbe0, 0x3ad0
.long 0x19f00, 0x19b00, 0xd80, 0x3cb0
.long 0x19f00, 0x19b00, 0xfa0, 0x3e90
.long 0x19f40, 0x19b40, 0x9d0, 0x39c0
.long 0x19f40, 0x19b40, 0xbf0, 0x3be0
.long 0x19f40, 0x19b40, 0xd90, 0x3d80
.long 0x19f40, 0x19b40, 0xfb0, 0x3fa0
.long 0x19f80, 0x19b80, 0x9e0, 0x39d0
.long 0x19f80, 0x19b80, 0xbc0, 0x3bf0
.long 0x19f80, 0x19b80, 0xda0, 0x3d90
.long 0x19f80, 0x19b80, 0xf80, 0x3fb0
.long 0x19fc0, 0x19bc0, 0x15070, 0x15070
.long 0x19fc0, 0x19bc0, 0x15270, 0x15270
.long 0x19fc0, 0x19bc0, 0x15470, 0x15470
.long 0x19fc0, 0x19bc0, 0x15670, 0x15670
.long 0x3120, 0x6110, 0x9100, 0xe830
.long 0x3300, 0x6330, 0x9320, 0xea10
.long 0x3560, 0x6550, 0x9540, 0xec70
.long 0x3740, 0x6770, 0x9760, 0xee50
.long 0x3130, 0x6120, 0x9110, 0xe900
.long 0x3310, 0x6300, 0x9330, 0xeb20
.long 0x3570, 0x6560, 0x9550, 0xed40
.long 0x3750, 0x6740, 0x9770, 0xef60
.long 0x6000, 0x6130, 0x9120, 0xe910
.long 0x6220, 0x6310, 0x9300, 0xeb30
.long 0x6440, 0x6570, 0x9560, 0xed50
.long 0x6660, 0x6750, 0x9740, 0xef70
.long 0x6010, 0x9000, 0x9130, 0xe920
.long 0x6230, 0x9220, 0x9310, 0xeb00
.long 0x6450, 0x9440, 0x9570, 0xed60
.long 0x6670, 0x9660, 0x9750, 0xef40
.long 0x3160, 0x6150, 0x9140, 0xe870
.long 0x3340, 0x6370, 0x9360, 0xea50
.long 0x3520, 0x6510, 0x9500, 0xec30
.long 0x3700, 0x6730, 0x9720, 0xee10
.long 0x3170, 0x6160, 0x9150, 0xe940
.long 0x3350, 0x6340, 0x9370, 0xeb60
.long 0x3530, 0x6520, 0x9510, 0xed00
.long 0x3710, 0x6700, 0x9730, 0xef20
.long 0x6040, 0x6170, 0x9160, 0xe950
.long 0x6260, 0x6350, 0x9340, 0xeb70
.long 0x6400, 0x6530, 0x9520, 0xed10
.long 0x6620, 0x6710, 0x9700, 0xef30
.long 0x6050, 0x9040, 0x9170, 0xe960
.long 0x6270, 0x9260, 0x9350, 0xeb40
.long 0x6410, 0x9400, 0x9530, 0xed20
.long 0x6630, 0x9620, 0x9710, 0xef00
.long 0x31a0, 0x6190, 0x9180, 0xe8b0
.long 0x3380, 0x63b0, 0x93a0, 0xea90
.long 0x35e0, 0x65d0, 0x95c0, 0xecf0
.long 0x37c0, 0x67f0, 0x97e0, 0xeed0
.long 0x31b0, 0x61a0, 0x9190, 0xe980
.long 0x3390, 0x6380, 0x93b0, 0xeba0
.long 0x35f0, 0x65e0, 0x95d0, 0xedc0
.long 0x37d0, 0x67c0, 0x97f0, 0xefe0
.long 0x6080, 0x61b0, 0x91a0, 0xe990
.long 0x62a0, 0x6390, 0x9380, 0xebb0
.long 0x64c0, 0x65f0, 0x95e0, 0xedd0
.long 0x66e0, 0x67d0, 0x97c0, 0xeff0
.long 0x6090, 0x9080, 0x91b0, 0xe9a0
.long 0x62b0, 0x92a0, 0x9390, 0xeb80
.long 0x64d0, 0x94c0, 0x95f0, 0xede0
.long 0x66f0, 0x96e0, 0x97d0, 0xefc0
.long 0x31e0, 0x61d0, 0x91c0, 0xe8f0
.long 0x33c0, 0x63f0, 0x93e0, 0xead0
.long 0x35a0, 0x6590, 0x9580, 0xecb0
.long 0x3780, 0x67b0, 0x97a0, 0xee90
.long 0x31f0, 0x61e0, 0x91d0, 0xe9c0
.long 0x33d0, 0x63c0, 0x93f0, 0xebe0
.long 0x35b0, 0x65a0, 0x9590, 0xed80
.long 0x3790, 0x6780, 0x97b0, 0xefa0
.long 0x60c0, 0x61f0, 0x91e0, 0xe9d0
.long 0x62e0, 0x63d0, 0x93c0, 0xebf0
.long 0x6480, 0x65b0, 0x95a0, 0xed90
.long 0x66a0, 0x6790, 0x9780, 0xefb0
.long 0x60d0, 0x90c0, 0x91f0, 0xe9e0
.long 0x62f0, 0x92e0, 0x93d0, 0xebc0
.long 0x6490, 0x9480, 0x95b0, 0xeda0
.long 0x66b0, 0x96a0, 0x9790, 0xef80
.long 0x3920, 0x6910, 0x9900, 0xf030
.long 0x3b00, 0x6b30, 0x9b20, 0xf210
.long 0x3d60, 0x6d50, 0x9d40, 0xf470
.long 0x3f40, 0x6f70, 0x9f60, 0xf650
.long 0x3930, 0x6920, 0x9910, 0xf100
.long 0x3b10, 0x6b00, 0x9b30, 0xf320
.long 0x3d70, 0x6d60, 0x9d50, 0xf540
.long 0x3f50, 0x6f40, 0x9f70, 0xf760
.long 0x6800, 0x6930, 0x9920, 0xf110
.long 0x6a20, 0x6b10, 0x9b00, 0xf330
.long 0x6c40, 0x6d70, 0x9d60, 0xf550
.long 0x6e60, 0x6f50, 0x9f40, 0xf770
.long 0x6810, 0x9800, 0x9930, 0xf120
.long 0x6a30, 0x9a20, 0x9b10, 0xf300
.long 0x6c50, 0x9c40, 0x9d70, 0xf560
.long 0x6e70, 0x9e60, 0x9f50, 0xf740
.long 0x3960, 0x6950, 0x9940, 0xf070
.long 0x3b40, 0x6b70, 0x9b60, 0xf250
.long 0x3d20, 0x6d10, 0x9d00, 0xf430
.long 0x3f00, 0x6f30, 0x9f20, 0xf610
.long 0x3970, 0x6960, 0x9950, 0xf140
.long 0x3b50, 0x6b40, 0x9b70, 0xf360
.long 0x3d30, 0x6d20, 0x9d10, 0xf500
.long 0x3f10, 0x6f00, 0x9f30, 0xf720
.long 0x6840, 0x6970, 0x9960, 0xf150
.long 0x6a60, 0x6b50, 0x9b40, 0xf370
.long 0x6c00, 0x6d30, 0x9d20, 0xf510
.long 0x6e20, 0x6f10, 0x9f00, 0xf730
.long 0x6850, 0x9840, 0x9970, 0xf160
.long 0x6a70, 0x9a60, 0x9b50, 0xf340
.long 0x6c10, 0x9c00, 0x9d30, 0xf520
.long 0x6e30, 0x9e20, 0x9f10, 0xf700
.long 0x39a0, 0x6990, 0x9980, 0xf0b0
.long 0x3b80, 0x6bb0, 0x9ba0, 0xf290
.long 0x3de0, 0x6dd0, 0x9dc0, 0xf4f0
.long 0x3fc0, 0x6ff0, 0x9fe0, 0xf6d0
.long 0x39b0, 0x69a0, 0x9990, 0xf180
.long 0x3b90, 0x6b80, 0x9bb0, 0xf3a0
.long 0x3df0, 0x6de0, 0x9dd0, 0xf5c0
.long 0x3fd0, 0x6fc0, 0x9ff0, 0xf7e0
.long 0x6880, 0x69b0, 0x99a0, 0xf190
.long 0x6aa0, 0x6b90, 0x9b80, 0xf3b0
.long 0x6cc0, 0x6df0, 0x9de0, 0xf5d0
.long 0x6ee0, 0x6fd0, 0x9fc0, 0xf7f0
.long 0x6890, 0x9880, 0x99b0, 0xf1a0
.long 0x6ab0, 0x9aa0, 0x9b90, 0xf380
.long 0x6cd0, 0x9cc0, 0x9df0, 0xf5e0
.long 0x6ef0, 0x9ee0, 0x9fd0, 0xf7c0
.long 0x39e0, 0x69d0, 0x99c0, 0xf0f0
.long 0x3bc0, 0x6bf0, 0x9be0, 0xf2d0
.long 0x3da0, 0x6d90, 0x9d80, 0xf4b0
.long 0x3f80, 0x6fb0, 0x9fa0, 0xf690
.long 0x39f0, 0x69e0, 0x99d0, 0xf1c0
.long 0x3bd0, 0x6bc0, 0x9bf0, 0xf3e0
.long 0x3db0, 0x6da0, 0x9d90, 0xf580
.long 0x3f90, 0x6f80, 0x9fb0, 0xf7a0
.long 0x68c0, 0x69f0, 0x99e0, 0xf1d0
.long 0x6ae0, 0x6bd0, 0x9bc0, 0xf3f0
.long 0x6c80, 0x6db0, 0x9da0, 0xf590
.long 0x6ea0, 0x6f90, 0x9f80, 0xf7b0
.long 0x68d0, 0x98c0, 0x99f0, 0xf1e0
.long 0x6af0, 0x9ae0, 0x9bd0, 0xf3c0
.long 0x6c90, 0x9c80, 0x9db0, 0xf5a0
.long 0x6eb0, 0x9ea0, 0x9f90, 0xf780
.long 0x6020, 0x9010, 0xe800, 0xe930
.long 0x6200, 0x9230, 0xea20, 0xeb10
.long 0x6460, 0x9450, 0xec40, 0xed70
.long 0x6640, 0x9670, 0xee60, 0xef50
.long 0x6030, 0x9020, 0xe810, 0x11800
.long 0x6210, 0x9200, 0xea30, 0x11a20
.long 0x6470, 0x9460, 0xec50, 0x11c40
.long 0x6650, 0x9640, 0xee70, 0x11e60
.long 0x6100, 0x9030, 0xe820, 0x11810
.long 0x6320, 0x9210, 0xea00, 0x11a30
.long 0x6540, 0x9470, 0xec60, 0x11c50
.long 0x6760, 0x9650, 0xee40, 0x11e70
.long 0x14840, 0x14840, 0x14840, 0x14840
.long 0x14a40, 0x14a40, 0x14a40, 0x14a40
.long 0x14c40, 0x14c40, 0x14c40, 0x14c40
.long 0x14e40, 0x14e40, 0x14e40, 0x14e40
.long 0x6060, 0x9050, 0xe840, 0xe970
.long 0x6240, 0x9270, 0xea60, 0xeb50
.long 0x6420, 0x9410, 0xec00, 0xed30
.long 0x6600, 0x9630, 0xee20, 0xef10
.long 0x6070, 0x9060, 0xe850, 0x11840
.long 0x6250, 0x9240, 0xea70, 0x11a60
.long 0x6430, 0x9420, 0xec10, 0x11c00
.long 0x6610, 0x9600, 0xee30, 0x11e20
.long 0x6140, 0x9070, 0xe860, 0x11850
.long 0x6360, 0x9250, 0xea40, 0x11a70
.long 0x6500, 0x9430, 0xec20, 0x11c10
.long 0x6720, 0x9610, 0xee00, 0x11e30
.long 0x14850, 0x14850, 0x14850, 0x14850
.long 0x14a50, 0x14a50, 0x14a50, 0x14a50
.long 0x14c50, 0x14c50, 0x14c50, 0x14c50
.long 0x14e50, 0x14e50, 0x14e50, 0x14e50
.long 0x60a0, 0x9090, 0xe880, 0xe9b0
.long 0x6280, 0x92b0, 0xeaa0, 0xeb90
.long 0x64e0, 0x94d0, 0xecc0, 0xedf0
.long 0x66c0, 0x96f0, 0xeee0, 0xefd0
.long 0x60b0, 0x90a0, 0xe890, 0x11880
.long 0x6290, 0x9280, 0xeab0, 0x11aa0
.long 0x64f0, 0x94e0, 0xecd0, 0x11cc0
.long 0x66d0, 0x96c0, 0xeef0, 0x11ee0
.long 0x6180, 0x90b0, 0xe8a0, 0x11890
.long 0x63a0, 0x9290, 0xea80, 0x11ab0
.long 0x65c0, 0x94f0, 0xece0, 0x11cd0
.long 0x67e0, 0x96d0, 0xeec0, 0x11ef0
.long 0x14860, 0x14860, 0x14860, 0x14860
.long 0x14a60, 0x14a60, 0x14a60, 0x14a60
.long 0x14c60, 0x14c60, 0x14c60, 0x14c60
.long 0x14e60, 0x14e60, 0x14e60, 0x14e60
.long 0x60e0, 0x90d0, 0xe8c0, 0xe9f0
.long 0x62c0, 0x92f0, 0xeae0, 0xebd0
.long 0x64a0, 0x9490, 0xec80, 0xedb0
.long 0x6680, 0x96b0, 0xeea0, 0xef90
.long 0x60f0, 0x90e0, 0xe8d0, 0x118c0
.long 0x62d0, 0x92c0, 0xeaf0, 0x11ae0
.long 0x64b0, 0x94a0, 0xec90, 0x11c80
.long 0x6690, 0x9680, 0xeeb0, 0x11ea0
.long 0x61c0, 0x90f0, 0xe8e0, 0x118d0
.long 0x63e0, 0x92d0, 0xeac0, 0x11af0
.long 0x6580, 0x94b0, 0xeca0, 0x11c90
.long 0x67a0, 0x9690, 0xee80, 0x11eb0
.long 0x14870, 0x14870, 0x14870, 0x14870
.long 0x14a70, 0x14a70, 0x14a70, 0x14a70
.long 0x14c70, 0x14c70, 0x14c70, 0x14c70
.long 0x14e70, 0x14e70, 0x14e70, 0x14e70
.long 0x6820, 0x9810, 0xf000, 0xf130
.long 0x6a00, 0x9a30, 0xf220, 0xf310
.long 0x6c60, 0x9c50, 0xf440, 0xf570
.long 0x6e40, 0x9e70, 0xf660, 0xf750
.long 0x6830, 0x9820, 0xf010, 0x12000
.long 0x6a10, 0x9a00, 0xf230, 0x12220
.long 0x6c70, 0x9c60, 0xf450, 0x12440
.long 0x6e50, 0x9e40, 0xf670, 0x12660
.long 0x6900, 0x9830, 0xf020, 0x12010
.long 0x6b20, 0x9a10, 0xf200, 0x12230
.long 0x6d40, 0x9c70, 0xf460, 0x12450
.long 0x6f60, 0x9e50, 0xf640, 0x12670
.long 0x15040, 0x15040, 0x15040, 0x15040
.long 0x15240, 0x15240, 0x15240, 0x15240
.long 0x15440, 0x15440, 0x15440, 0x15440
.long 0x15640, 0x15640, 0x15640, 0x15640
.long 0x6860, 0x9850, 0xf040, 0xf170
.long 0x6a40, 0x9a70, 0xf260, 0xf350
.long 0x6c20, 0x9c10, 0xf400, 0xf530
.long 0x6e00, 0x9e30, 0xf620, 0xf710
.long 0x6870, 0x9860, 0xf050, 0x12040
.long 0x6a50, 0x9a40, 0xf270, 0x12260
.long 0x6c30, 0x9c20, 0xf410, 0x12400
.long 0x6e10, 0x9e00, 0xf630, 0x12620
.long 0x6940, 0x9870, 0xf060, 0x12050
.long 0x6b60, 0x9a50, 0xf240, 0x12270
.long 0x6d00, 0x9c30, 0xf420, 0x12410
.long 0x6f20, 0x9e10, 0xf600, 0x12630
.long 0x15050, 0x15050, 0x15050, 0x15050
.long 0x15250, 0x15250, 0x15250, 0x15250
.long 0x15450, 0x15450, 0x15450, 0x15450
.long 0x15650, 0x15650, 0x15650, 0x15650
.long 0x68a0, 0x9890, 0xf080, 0xf1b0
.long 0x6a80, 0x9ab0, 0xf2a0, 0xf390
.long 0x6ce0, 0x9cd0, 0xf4c0, 0xf5f0
.long 0x6ec0, 0x9ef0, 0xf6e0, 0xf7d0
.long 0x68b0, 0x98a0, 0xf090, 0x12080
.long 0x6a90, 0x9a80, 0xf2b0, 0x122a0
.long 0x6cf0, 0x9ce0, 0xf4d0, 0x124c0
.long 0x6ed0, 0x9ec0, 0xf6f0, 0x126e0
.long 0x6980, 0x98b0, 0xf0a0, 0x12090
.long 0x6ba0, 0x9a90, 0xf280, 0x122b0
.long 0x6dc0, 0x9cf0, 0xf4e0, 0x124d0
.long 0x6fe0, 0x9ed0, 0xf6c0, 0x126f0
.long 0x15060, 0x15060, 0x15060, 0x15060
.long 0x15260, 0x15260, 0x15260, 0x15260
.long 0x15460, 0x15460, 0x15460, 0x15460
.long 0x15660, 0x15660, 0x15660, 0x15660
.long 0x68e0, 0x98d0, 0xf0c0, 0xf1f0
.long 0x6ac0, 0x9af0, 0xf2e0, 0xf3d0
.long 0x6ca0, 0x9c90, 0xf480, 0xf5b0
.long 0x6e80, 0x9eb0, 0xf6a0, 0xf790
.long 0x68f0, 0x98e0, 0xf0d0, 0x120c0
.long 0x6ad0, 0x9ac0, 0xf2f0, 0x122e0
.long 0x6cb0, 0x9ca0, 0xf490, 0x12480
.long 0x6e90, 0x9e80, 0xf6b0, 0x126a0
.long 0x69c0, 0x98f0, 0xf0e0, 0x120d0
.long 0x6be0, 0x9ad0, 0xf2c0, 0x122f0
.long 0x6d80, 0x9cb0, 0xf4a0, 0x12490
.long 0x6fa0, 0x9e90, 0xf680, 0x126b0
.long 0x15070, 0x15070, 0x15070, 0x15070
.long 0x15270, 0x15270, 0x15270, 0x15270
.long 0x15470, 0x15470, 0x15470, 0x15470
.long 0x15670, 0x15670, 0x15670, 0x15670
.long 0x11820, 0x0, 0x40, 0x1800
.long 0x11a00, 0x10, 0x50, 0x1810
.long 0x11c60, 0x20, 0x60, 0x1820
.long 0x11e40, 0x30, 0x70, 0x1830
.long 0x11830, 0x40, 0x0, 0x1840
.long 0x11a10, 0x50, 0x10, 0x1850
.long 0x11c70, 0x60, 0x20, 0x1860
.long 0x11e50, 0x70, 0x30, 0x1870
.long 0x11900, 0x80, 0xc0, 0x1880
.long 0x11b20, 0x90, 0xd0, 0x1890
.long 0x11d40, 0xa0, 0xe0, 0x18a0
.long 0x11f60, 0xb0, 0xf0, 0x18b0
.long 0x11910, 0xc0, 0x80, 0x18c0
.long 0x11b30, 0xd0, 0x90, 0x18d0
.long 0x11d50, 0xe0, 0xa0, 0x18e0
.long 0x11f70, 0xf0, 0xb0, 0x18f0
.long 0x11860, 0x100, 0x140, 0x1900
.long 0x11a40, 0x110, 0x150, 0x1910
.long 0x11c20, 0x120, 0x160, 0x1920
.long 0x11e00, 0x130, 0x170, 0x1930
.long 0x11870, 0x140, 0x100, 0x1940
.long 0x11a50, 0x150, 0x110, 0x1950
.long 0x11c30, 0x160, 0x120, 0x1960
.long 0x11e10, 0x170, 0x130, 0x1970
.long 0x11940, 0x180, 0x1c0, 0x1980
.long 0x11b60, 0x190, 0x1d0, 0x1990
.long 0x11d00, 0x1a0, 0x1e0, 0x19a0
.long 0x11f20, 0x1b0, 0x1f0, 0x19b0
.long 0x11950, 0x1c0, 0x180, 0x19c0
.long 0x11b70, 0x1d0, 0x190, 0x19d0
.long 0x11d10, 0x1e0, 0x1a0, 0x19e0
.long 0x11f30, 0x1f0, 0x1b0, 0x19f0
.long 0x118a0, 0x220, 0x260, 0x1a20
.long 0x11a80, 0x230, 0x270, 0x1a30
.long 0x11ce0, 0x200, 0x240, 0x1a00
.long 0x11ec0, 0x210, 0x250, 0x1a10
.long 0x118b0, 0x260, 0x220, 0x1a60
.long 0x11a90, 0x270, 0x230, 0x1a70
.long 0x11cf0, 0x240, 0x200, 0x1a40
.long 0x11ed0, 0x250, 0x210, 0x1a50
.long 0x11980, 0x2a0, 0x2e0, 0x1aa0
.long 0x11ba0, 0x2b0, 0x2f0, 0x1ab0
.long 0x11dc0, 0x280, 0x2c0, 0x1a80
.long 0x11fe0, 0x290, 0x2d0, 0x1a90
.long 0x11990, 0x2e0, 0x2a0, 0x1ae0
.long 0x11bb0, 0x2f0, 0x2b0, 0x1af0
.long 0x11dd0, 0x2c0, 0x280, 0x1ac0
.long 0x11ff0, 0x2d0, 0x290, 0x1ad0
.long 0x118e0, 0x320, 0x360, 0x1b20
.long 0x11ac0, 0x330, 0x370, 0x1b30
.long 0x11ca0, 0x300, 0x340, 0x1b00
.long 0x11e80, 0x310, 0x350, 0x1b10
.long 0x118f0, 0x360, 0x320, 0x1b60
.long 0x11ad0, 0x370, 0x330, 0x1b70
.long 0x11cb0, 0x340, 0x300, 0x1b40
.long 0x11e90, 0x350, 0x310, 0x1b50
.long 0x119c0, 0x3a0, 0x3e0, 0x1ba0
.long 0x11be0, 0x3b0, 0x3f0, 0x1bb0
.long 0x11d80, 0x380, 0x3c0, 0x1b80
.long 0x11fa0, 0x390, 0x3d0, 0x1b90
.long 0x119d0, 0x3e0, 0x3a0, 0x1be0
.long 0x11bf0, 0x3f0, 0x3b0, 0x1bf0
.long 0x11d90, 0x3c0, 0x380, 0x1bc0
.long 0x11fb0, 0x3d0, 0x390, 0x1bd0
.long 0x12020, 0x0, 0x40, 0x1800
.long 0x12200, 0x10, 0x50, 0x1810
.long 0x12460, 0x20, 0x60, 0x1820
.long 0x12640, 0x30, 0x70, 0x1830
.long 0x12030, 0x40, 0x0, 0x1840
.long 0x12210, 0x50, 0x10, 0x1850
.long 0x12470, 0x60, 0x20, 0x1860
.long 0x12650, 0x70, 0x30, 0x1870
.long 0x12100, 0x80, 0xc0, 0x1880
.long 0x12320, 0x90, 0xd0, 0x1890
.long 0x12540, 0xa0, 0xe0, 0x18a0
.long 0x12760, 0xb0, 0xf0, 0x18b0
.long 0x12110, 0xc0, 0x80, 0x18c0
.long 0x12330, 0xd0, 0x90, 0x18d0
.long 0x12550, 0xe0, 0xa0, 0x18e0
.long 0x12770, 0xf0, 0xb0, 0x18f0
.long 0x12060, 0x100, 0x140, 0x1900
.long 0x12240, 0x110, 0x150, 0x1910
.long 0x12420, 0x120, 0x160, 0x1920
.long 0x12600, 0x130, 0x170, 0x1930
.long 0x12070, 0x140, 0x100, 0x1940
.long 0x12250, 0x150, 0x110, 0x1950
.long 0x12430, 0x160, 0x120, 0x1960
.long 0x12610, 0x170, 0x130, 0x1970
.long 0x12140, 0x180, 0x1c0, 0x1980
.long 0x12360, 0x190, 0x1d0, 0x1990
.long 0x12500, 0x1a0, 0x1e0, 0x19a0
.long 0x12720, 0x1b0, 0x1f0, 0x19b0
.long 0x12150, 0x1c0, 0x180, 0x19c0
.long 0x12370, 0x1d0, 0x190, 0x19d0
.long 0x12510, 0x1e0, 0x1a0, 0x19e0
.long 0x12730, 0x1f0, 0x1b0, 0x19f0
.long 0x120a0, 0x220, 0x260, 0x1a20
.long 0x12280, 0x230, 0x270, 0x1a30
.long 0x124e0, 0x200, 0x240, 0x1a00
.long 0x126c0, 0x210, 0x250, 0x1a10
.long 0x120b0, 0x260, 0x220, 0x1a60
.long 0x12290, 0x270, 0x230, 0x1a70
.long 0x124f0, 0x240, 0x200, 0x1a40
.long 0x126d0, 0x250, 0x210, 0x1a50
.long 0x12180, 0x2a0, 0x2e0, 0x1aa0
.long 0x123a0, 0x2b0, 0x2f0, 0x1ab0
.long 0x125c0, 0x280, 0x2c0, 0x1a80
.long 0x127e0, 0x290, 0x2d0, 0x1a90
.long 0x12190, 0x2e0, 0x2a0, 0x1ae0
.long 0x123b0, 0x2f0, 0x2b0, 0x1af0
.long 0x125d0, 0x2c0, 0x280, 0x1ac0
.long 0x127f0, 0x2d0, 0x290, 0x1ad0
.long 0x120e0, 0x320, 0x360, 0x1b20
.long 0x122c0, 0x330, 0x370, 0x1b30
.long 0x124a0, 0x300, 0x340, 0x1b00
.long 0x12680, 0x310, 0x350, 0x1b10
.long 0x120f0, 0x360, 0x320, 0x1b60
.long 0x122d0, 0x370, 0x330, 0x1b70
.long 0x124b0, 0x340, 0x300, 0x1b40
.long 0x12690, 0x350, 0x310, 0x1b50
.long 0x121c0, 0x3a0, 0x3e0, 0x1ba0
.long 0x123e0, 0x3b0, 0x3f0, 0x1bb0
.long 0x12580, 0x380, 0x3c0, 0x1b80
.long 0x127a0, 0x390, 0x3d0, 0x1b90
.long 0x121d0, 0x3e0, 0x3a0, 0x1be0
.long 0x123f0, 0x3f0, 0x3b0, 0x1bf0
.long 0x12590, 0x3c0, 0x380, 0x1bc0
.long 0x127b0, 0x3d0, 0x390, 0x1bd0
.long 0x11920, 0x4800, 0x4840, 0x3000
.long 0x11b00, 0x4810, 0x4850, 0x3010
.long 0x11d60, 0x4820, 0x4860, 0x3020
.long 0x11f40, 0x4830, 0x4870, 0x3030
.long 0x11930, 0x4840, 0x4800, 0x3040
.long 0x11b10, 0x4850, 0x4810, 0x3050
.long 0x11d70, 0x4860, 0x4820, 0x3060
.long 0x11f50, 0x4870, 0x4830, 0x3070
.long 0x14800, 0x4880, 0x48c0, 0x3080
.long 0x14a00, 0x4890, 0x48d0, 0x3090
.long 0x14c00, 0x48a0, 0x48e0, 0x30a0
.long 0x14e00, 0x48b0, 0x48f0, 0x30b0
.long 0x14840, 0x48c0, 0x4880, 0x30c0
.long 0x14a40, 0x48d0, 0x4890, 0x30d0
.long 0x14c40, 0x48e0, 0x48a0, 0x30e0
.long 0x14e40, 0x48f0, 0x48b0, 0x30f0
.long 0x11960, 0x4900, 0x4940, 0x3100
.long 0x11b40, 0x4910, 0x4950, 0x3110
.long 0x11d20, 0x4920, 0x4960, 0x3120
.long 0x11f00, 0x4930, 0x4970, 0x3130
.long 0x11970, 0x4940, 0x4900, 0x3140
.long 0x11b50, 0x4950, 0x4910, 0x3150
.long 0x11d30, 0x4960, 0x4920, 0x3160
.long 0x11f10, 0x4970, 0x4930, 0x3170
.long 0x14810, 0x4980, 0x49c0, 0x3180
.long 0x14a10, 0x4990, 0x49d0, 0x3190
.long 0x14c10, 0x49a0, 0x49e0, 0x31a0
.long 0x14e10, 0x49b0, 0x49f0, 0x31b0
.long 0x14850, 0x49c0, 0x4980, 0x31c0
.long 0x14a50, 0x49d0, 0x4990, 0x31d0
.long 0x14c50, 0x49e0, 0x49a0, 0x31e0
.long 0x14e50, 0x49f0, 0x49b0, 0x31f0
.long 0x119a0, 0x4a20, 0x4a60, 0x3220
.long 0x11b80, 0x4a30, 0x4a70, 0x3230
.long 0x11de0, 0x4a00, 0x4a40, 0x3200
.long 0x11fc0, 0x4a10, 0x4a50, 0x3210
.long 0x119b0, 0x4a60, 0x4a20, 0x3260
.long 0x11b90, 0x4a70, 0x4a30, 0x3270
.long 0x11df0, 0x4a40, 0x4a00, 0x3240
.long 0x11fd0, 0x4a50, 0x4a10, 0x3250
.long 0x14820, 0x4aa0, 0x4ae0, 0x32a0
.long 0x14a20, 0x4ab0, 0x4af0, 0x32b0
.long 0x14c20, 0x4a80, 0x4ac0, 0x3280
.long 0x14e20, 0x4a90, 0x4ad0, 0x3290
.long 0x14860, 0x4ae0, 0x4aa0, 0x32e0
.long 0x14a60, 0x4af0, 0x4ab0, 0x32f0
.long 0x14c60, 0x4ac0, 0x4a80, 0x32c0
.long 0x14e60, 0x4ad0, 0x4a90, 0x32d0
.long 0x119e0, 0x4b20, 0x4b60, 0x3320
.long 0x11bc0, 0x4b30, 0x4b70, 0x3330
.long 0x11da0, 0x4b00, 0x4b40, 0x3300
.long 0x11f80, 0x4b10, 0x4b50, 0x3310
.long 0x119f0, 0x4b60, 0x4b20, 0x3360
.long 0x11bd0, 0x4b70, 0x4b30, 0x3370
.long 0x11db0, 0x4b40, 0x4b00, 0x3340
.long 0x11f90, 0x4b50, 0x4b10, 0x3350
.long 0x14830, 0x4ba0, 0x4be0, 0x33a0
.long 0x14a30, 0x4bb0, 0x4bf0, 0x33b0
.long 0x14c30, 0x4b80, 0x4bc0, 0x3380
.long 0x14e30, 0x4b90, 0x4bd0, 0x3390
.long 0x14870, 0x4be0, 0x4ba0, 0x33e0
.long 0x14a70, 0x4bf0, 0x4bb0, 0x33f0
.long 0x14c70, 0x4bc0, 0x4b80, 0x33c0
.long 0x14e70, 0x4bd0, 0x4b90, 0x33d0
.long 0x12120, 0x4800, 0x4840, 0x3000
.long 0x12300, 0x4810, 0x4850, 0x3010
.long 0x12560, 0x4820, 0x4860, 0x3020
.long 0x12740, 0x4830, 0x4870, 0x3030
.long 0x12130, 0x4840, 0x4800, 0x3040
.long 0x12310, 0x4850, 0x4810, 0x3050
.long 0x12570, 0x4860, 0x4820, 0x3060
.long 0x12750, 0x4870, 0x4830, 0x3070
.long 0x15000, 0x4880, 0x48c0, 0x3080
.long 0x15200, 0x4890, 0x48d0, 0x3090
.long 0x15400, 0x48a0, 0x48e0, 0x30a0
.long 0x15600, 0x48b0, 0x48f0, 0x30b0
.long 0x15040, 0x48c0, 0x4880, 0x30c0
.long 0x15240, 0x48d0, 0x4890, 0x30d0
.long 0x15440, 0x48e0, 0x48a0, 0x30e0
.long 0x15640, 0x48f0, 0x48b0, 0x30f0
.long 0x12160, 0x4900, 0x4940, 0x3100
.long 0x12340, 0x4910, 0x4950, 0x3110
.long 0x12520, 0x4920, 0x4960, 0x3120
.long 0x12700, 0x4930, 0x4970, 0x3130
.long 0x12170, 0x4940, 0x4900, 0x3140
.long 0x12350, 0x4950, 0x4910, 0x3150
.long 0x12530, 0x4960, 0x4920, 0x3160
.long 0x12710, 0x4970, 0x4930, 0x3170
.long 0x15010, 0x4980, 0x49c0, 0x3180
.long 0x15210, 0x4990, 0x49d0, 0x3190
.long 0x15410, 0x49a0, 0x49e0, 0x31a0
.long 0x15610, 0x49b0, 0x49f0, 0x31b0
.long 0x15050, 0x49c0, 0x4980, 0x31c0
.long 0x15250, 0x49d0, 0x4990, 0x31d0
.long 0x15450, 0x49e0, 0x49a0, 0x31e0
.long 0x15650, 0x49f0, 0x49b0, 0x31f0
.long 0x121a0, 0x4a20, 0x4a60, 0x3220
.long 0x12380, 0x4a30, 0x4a70, 0x3230
.long 0x125e0, 0x4a00, 0x4a40, 0x3200
.long 0x127c0, 0x4a10, 0x4a50, 0x3210
.long 0x121b0, 0x4a60, 0x4a20, 0x3260
.long 0x12390, 0x4a70, 0x4a30, 0x3270
.long 0x125f0, 0x4a40, 0x4a00, 0x3240
.long 0x127d0, 0x4a50, 0x4a10, 0x3250
.long 0x15020, 0x4aa0, 0x4ae0, 0x32a0
.long 0x15220, 0x4ab0, 0x4af0, 0x32b0
.long 0x15420, 0x4a80, 0x4ac0, 0x3280
.long 0x15620, 0x4a90, 0x4ad0, 0x3290
.long 0x15060, 0x4ae0, 0x4aa0, 0x32e0
.long 0x15260, 0x4af0, 0x4ab0, 0x32f0
.long 0x15460, 0x4ac0, 0x4a80, 0x32c0
.long 0x15660, 0x4ad0, 0x4a90, 0x32d0
.long 0x121e0, 0x4b20, 0x4b60, 0x3320
.long 0x123c0, 0x4b30, 0x4b70, 0x3330
.long 0x125a0, 0x4b00, 0x4b40, 0x3300
.long 0x12780, 0x4b10, 0x4b50, 0x3310
.long 0x121f0, 0x4b60, 0x4b20, 0x3360
.long 0x123d0, 0x4b70, 0x4b30, 0x3370
.long 0x125b0, 0x4b40, 0x4b00, 0x3340
.long 0x12790, 0x4b50, 0x4b10, 0x3350
.long 0x15030, 0x4ba0, 0x4be0, 0x33a0
.long 0x15230, 0x4bb0, 0x4bf0, 0x33b0
.long 0x15430, 0x4b80, 0x4bc0, 0x3380
.long 0x15630, 0x4b90, 0x4bd0, 0x3390
.long 0x15070, 0x4be0, 0x4ba0, 0x33e0
.long 0x15270, 0x4bf0, 0x4bb0, 0x33f0
.long 0x15470, 0x4bc0, 0x4b80, 0x33c0
.long 0x15670, 0x4bd0, 0x4b90, 0x33d0
.long 0x1840, 0x14800, 0x0, 0x0
.long 0x1850, 0x14810, 0x0, 0x0
.long 0x1860, 0x14820, 0x0, 0x0
.long 0x1870, 0x14830, 0x0, 0x0
.long 0x1800, 0x14840, 0x0, 0x0
.long 0x1810, 0x14850, 0x0, 0x0
.long 0x1820, 0x14860, 0x0, 0x0
.long 0x1830, 0x14870, 0x0, 0x0
.long 0x18c0, 0x14840, 0x0, 0x0
.long 0x18d0, 0x14850, 0x0, 0x0
.long 0x18e0, 0x14860, 0x0, 0x0
.long 0x18f0, 0x14870, 0x0, 0x0
.long 0x1880, 0x14840, 0x0, 0x0
.long 0x1890, 0x14850, 0x0, 0x0
.long 0x18a0, 0x14860, 0x0, 0x0
.long 0x18b0, 0x14870, 0x0, 0x0
.long 0x1940, 0x14840, 0x0, 0x0
.long 0x1950, 0x14850, 0x0, 0x0
.long 0x1960, 0x14860, 0x0, 0x0
.long 0x1970, 0x14870, 0x0, 0x0
.long 0x1900, 0x14800, 0x0, 0x0
.long 0x1910, 0x14810, 0x0, 0x0
.long 0x1920, 0x14820, 0x0, 0x0
.long 0x1930, 0x14830, 0x0, 0x0
.long 0x19c0, 0x14840, 0x0, 0x0
.long 0x19d0, 0x14850, 0x0, 0x0
.long 0x19e0, 0x14860, 0x0, 0x0
.long 0x19f0, 0x14870, 0x0, 0x0
.long 0x1980, 0x14840, 0x0, 0x0
.long 0x1990, 0x14850, 0x0, 0x0
.long 0x19a0, 0x14860, 0x0, 0x0
.long 0x19b0, 0x14870, 0x0, 0x0
.long 0x1a60, 0x14a00, 0x0, 0x0
.long 0x1a70, 0x14a10, 0x0, 0x0
.long 0x1a40, 0x14a20, 0x0, 0x0
.long 0x1a50, 0x14a30, 0x0, 0x0
.long 0x1a20, 0x14a40, 0x0, 0x0
.long 0x1a30, 0x14a50, 0x0, 0x0
.long 0x1a00, 0x14a60, 0x0, 0x0
.long 0x1a10, 0x14a70, 0x0, 0x0
.long 0x1ae0, 0x14a40, 0x0, 0x0
.long 0x1af0, 0x14a50, 0x0, 0x0
.long 0x1ac0, 0x14a60, 0x0, 0x0
.long 0x1ad0, 0x14a70, 0x0, 0x0
.long 0x1aa0, 0x14a40, 0x0, 0x0
.long 0x1ab0, 0x14a50, 0x0, 0x0
.long 0x1a80, 0x14a60, 0x0, 0x0
.long 0x1a90, 0x14a70, 0x0, 0x0
.long 0x1b60, 0x14a40, 0x0, 0x0
.long 0x1b70, 0x14a50, 0x0, 0x0
.long 0x1b40, 0x14a60, 0x0, 0x0
.long 0x1b50, 0x14a70, 0x0, 0x0
.long 0x1b20, 0x14a00, 0x0, 0x0
.long 0x1b30, 0x14a10, 0x0, 0x0
.long 0x1b00, 0x14a20, 0x0, 0x0
.long 0x1b10, 0x14a30, 0x0, 0x0
.long 0x1be0, 0x14a40, 0x0, 0x0
.long 0x1bf0, 0x14a50, 0x0, 0x0
.long 0x1bc0, 0x14a60, 0x0, 0x0
.long 0x1bd0, 0x14a70, 0x0, 0x0
.long 0x1ba0, 0x14a40, 0x0, 0x0
.long 0x1bb0, 0x14a50, 0x0, 0x0
.long 0x1b80, 0x14a60, 0x0, 0x0
.long 0x1b90, 0x14a70, 0x0, 0x0
.long 0x1840, 0x14800, 0x0, 0x0
.long 0x1850, 0x14810, 0x0, 0x0
.long 0x1860, 0x14820, 0x0, 0x0
.long 0x1870, 0x14830, 0x0, 0x0
.long 0x1800, 0x14840, 0x0, 0x0
.long 0x1810, 0x14850, 0x0, 0x0
.long 0x1820, 0x14860, 0x0, 0x0
.long 0x1830, 0x14870, 0x0, 0x0
.long 0x18c0, 0x14840, 0x0, 0x0
.long 0x18d0, 0x14850, 0x0, 0x0
.long 0x18e0, 0x14860, 0x0, 0x0
.long 0x18f0, 0x14870, 0x0, 0x0
.long 0x1880, 0x14840, 0x0, 0x0
.long 0x1890, 0x14850, 0x0, 0x0
.long 0x18a0, 0x14860, 0x0, 0x0
.long 0x18b0, 0x14870, 0x0, 0x0
.long 0x1940, 0x14840, 0x0, 0x0
.long 0x1950, 0x14850, 0x0, 0x0
.long 0x1960, 0x14860, 0x0, 0x0
.long 0x1970, 0x14870, 0x0, 0x0
.long 0x1900, 0x14800, 0x0, 0x0
.long 0x1910, 0x14810, 0x0, 0x0
.long 0x1920, 0x14820, 0x0, 0x0
.long 0x1930, 0x14830, 0x0, 0x0
.long 0x19c0, 0x14840, 0x0, 0x0
.long 0x19d0, 0x14850, 0x0, 0x0
.long 0x19e0, 0x14860, 0x0, 0x0
.long 0x19f0, 0x14870, 0x0, 0x0
.long 0x1980, 0x14840, 0x0, 0x0
.long 0x1990, 0x14850, 0x0, 0x0
.long 0x19a0, 0x14860, 0x0, 0x0
.long 0x19b0, 0x14870, 0x0, 0x0
.long 0x1a60, 0x14a00, 0x0, 0x0
.long 0x1a70, 0x14a10, 0x0, 0x0
.long 0x1a40, 0x14a20, 0x0, 0x0
.long 0x1a50, 0x14a30, 0x0, 0x0
.long 0x1a20, 0x14a40, 0x0, 0x0
.long 0x1a30, 0x14a50, 0x0, 0x0
.long 0x1a00, 0x14a60, 0x0, 0x0
.long 0x1a10, 0x14a70, 0x0, 0x0
.long 0x1ae0, 0x14a40, 0x0, 0x0
.long 0x1af0, 0x14a50, 0x0, 0x0
.long 0x1ac0, 0x14a60, 0x0, 0x0
.long 0x1ad0, 0x14a70, 0x0, 0x0
.long 0x1aa0, 0x14a40, 0x0, 0x0
.long 0x1ab0, 0x14a50, 0x0, 0x0
.long 0x1a80, 0x14a60, 0x0, 0x0
.long 0x1a90, 0x14a70, 0x0, 0x0
.long 0x1b60, 0x14a40, 0x0, 0x0
.long 0x1b70, 0x14a50, 0x0, 0x0
.long 0x1b40, 0x14a60, 0x0, 0x0
.long 0x1b50, 0x14a70, 0x0, 0x0
.long 0x1b20, 0x14a00, 0x0, 0x0
.long 0x1b30, 0x14a10, 0x0, 0x0
.long 0x1b00, 0x14a20, 0x0, 0x0
.long 0x1b10, 0x14a30, 0x0, 0x0
.long 0x1be0, 0x14a40, 0x0, 0x0
.long 0x1bf0, 0x14a50, 0x0, 0x0
.long 0x1bc0, 0x14a60, 0x0, 0x0
.long 0x1bd0, 0x14a70, 0x0, 0x0
.long 0x1ba0, 0x14a40, 0x0, 0x0
.long 0x1bb0, 0x14a50, 0x0, 0x0
.long 0x1b80, 0x14a60, 0x0, 0x0
.long 0x1b90, 0x14a70, 0x0, 0x0
.long 0x3040, 0x16000, 0x0, 0x0
.long 0x3050, 0x16010, 0x0, 0x0
.long 0x3060, 0x16020, 0x0, 0x0
.long 0x3070, 0x16030, 0x0, 0x0
.long 0x3000, 0x16040, 0x0, 0x0
.long 0x3010, 0x16050, 0x0, 0x0
.long 0x3020, 0x16060, 0x0, 0x0
.long 0x3030, 0x16070, 0x0, 0x0
.long 0x30c0, 0x16040, 0x0, 0x0
.long 0x30d0, 0x16050, 0x0, 0x0
.long 0x30e0, 0x16060, 0x0, 0x0
.long 0x30f0, 0x16070, 0x0, 0x0
.long 0x3080, 0x16040, 0x0, 0x0
.long 0x3090, 0x16050, 0x0, 0x0
.long 0x30a0, 0x16060, 0x0, 0x0
.long 0x30b0, 0x16070, 0x0, 0x0
.long 0x3140, 0x16040, 0x0, 0x0
.long 0x3150, 0x16050, 0x0, 0x0
.long 0x3160, 0x16060, 0x0, 0x0
.long 0x3170, 0x16070, 0x0, 0x0
.long 0x3100, 0x16000, 0x0, 0x0
.long 0x3110, 0x16010, 0x0, 0x0
.long 0x3120, 0x16020, 0x0, 0x0
.long 0x3130, 0x16030, 0x0, 0x0
.long 0x31c0, 0x16040, 0x0, 0x0
.long 0x31d0, 0x16050, 0x0, 0x0
.long 0x31e0, 0x16060, 0x0, 0x0
.long 0x31f0, 0x16070, 0x0, 0x0
.long 0x3180, 0x16040, 0x0, 0x0
.long 0x3190, 0x16050, 0x0, 0x0
.long 0x31a0, 0x16060, 0x0, 0x0
.long 0x31b0, 0x16070, 0x0, 0x0
.long 0x3260, 0x16200, 0x0, 0x0
.long 0x3270, 0x16210, 0x0, 0x0
.long 0x3240, 0x16220, 0x0, 0x0
.long 0x3250, 0x16230, 0x0, 0x0
.long 0x3220, 0x16240, 0x0, 0x0
.long 0x3230, 0x16250, 0x0, 0x0
.long 0x3200, 0x16260, 0x0, 0x0
.long 0x3210, 0x16270, 0x0, 0x0
.long 0x32e0, 0x16240, 0x0, 0x0
.long 0x32f0, 0x16250, 0x0, 0x0
.long 0x32c0, 0x16260, 0x0, 0x0
.long 0x32d0, 0x16270, 0x0, 0x0
.long 0x32a0, 0x16240, 0x0, 0x0
.long 0x32b0, 0x16250, 0x0, 0x0
.long 0x3280, 0x16260, 0x0, 0x0
.long 0x3290, 0x16270, 0x0, 0x0
.long 0x3360, 0x16240, 0x0, 0x0
.long 0x3370, 0x16250, 0x0, 0x0
.long 0x3340, 0x16260, 0x0, 0x0
.long 0x3350, 0x16270, 0x0, 0x0
.long 0x3320, 0x16200, 0x0, 0x0
.long 0x3330, 0x16210, 0x0, 0x0
.long 0x3300, 0x16220, 0x0, 0x0
.long 0x3310, 0x16230, 0x0, 0x0
.long 0x33e0, 0x16240, 0x0, 0x0
.long 0x33f0, 0x16250, 0x0, 0x0
.long 0x33c0, 0x16260, 0x0, 0x0
.long 0x33d0, 0x16270, 0x0, 0x0
.long 0x33a0, 0x16240, 0x0, 0x0
.long 0x33b0, 0x16250, 0x0, 0x0
.long 0x3380, 0x16260, 0x0, 0x0
.long 0x3390, 0x16270, 0x0, 0x0
.long 0x3040, 0x16000, 0x0, 0x0
.long 0x3050, 0x16010, 0x0, 0x0
.long 0x3060, 0x16020, 0x0, 0x0
.long 0x3070, 0x16030, 0x0, 0x0
.long 0x3000, 0x16040, 0x0, 0x0
.long 0x3010, 0x16050, 0x0, 0x0
.long 0x3020, 0x16060, 0x0, 0x0
.long 0x3030, 0x16070, 0x0, 0x0
.long 0x30c0, 0x16040, 0x0, 0x0
.long 0x30d0, 0x16050, 0x0, 0x0
.long 0x30e0, 0x16060, 0x0, 0x0
.long 0x30f0, 0x16070, 0x0, 0x0
.long 0x3080, 0x16040, 0x0, 0x0
.long 0x3090, 0x16050, 0x0, 0x0
.long 0x30a0, 0x16060, 0x0, 0x0
.long 0x30b0, 0x16070, 0x0, 0x0
.long 0x3140, 0x16040, 0x0, 0x0
.long 0x3150, 0x16050, 0x0, 0x0
.long 0x3160, 0x16060, 0x0, 0x0
.long 0x3170, 0x16070, 0x0, 0x0
.long 0x3100, 0x16000, 0x0, 0x0
.long 0x3110, 0x16010, 0x0, 0x0
.long 0x3120, 0x16020, 0x0, 0x0
.long 0x3130, 0x16030, 0x0, 0x0
.long 0x31c0, 0x16040, 0x0, 0x0
.long 0x31d0, 0x16050, 0x0, 0x0
.long 0x31e0, 0x16060, 0x0, 0x0
.long 0x31f0, 0x16070, 0x0, 0x0
.long 0x3180, 0x16040, 0x0, 0x0
.long 0x3190, 0x16050, 0x0, 0x0
.long 0x31a0, 0x16060, 0x0, 0x0
.long 0x31b0, 0x16070, 0x0, 0x0
.long 0x3260, 0x16200, 0x0, 0x0
.long 0x3270, 0x16210, 0x0, 0x0
.long 0x3240, 0x16220, 0x0, 0x0
.long 0x3250, 0x16230, 0x0, 0x0
.long 0x3220, 0x16240, 0x0, 0x0
.long 0x3230, 0x16250, 0x0, 0x0
.long 0x3200, 0x16260, 0x0, 0x0
.long 0x3210, 0x16270, 0x0, 0x0
.long 0x32e0, 0x16240, 0x0, 0x0
.long 0x32f0, 0x16250, 0x0, 0x0
.long 0x32c0, 0x16260, 0x0, 0x0
.long 0x32d0, 0x16270, 0x0, 0x0
.long 0x32a0, 0x16240, 0x0, 0x0
.long 0x32b0, 0x16250, 0x0, 0x0
.long 0x3280, 0x16260, 0x0, 0x0
.long 0x3290, 0x16270, 0x0, 0x0
.long 0x3360, 0x16240, 0x0, 0x0
.long 0x3370, 0x16250, 0x0, 0x0
.long 0x3340, 0x16260, 0x0, 0x0
.long 0x3350, 0x16270, 0x0, 0x0
.long 0x3320, 0x16200, 0x0, 0x0
.long 0x3330, 0x16210, 0x0, 0x0
.long 0x3300, 0x16220, 0x0, 0x0
.long 0x3310, 0x16230, 0x0, 0x0
.long 0x33e0, 0x16240, 0x0, 0x0
.long 0x33f0, 0x16250, 0x0, 0x0
.long 0x33c0, 0x16260, 0x0, 0x0
.long 0x33d0, 0x16270, 0x0, 0x0
.long 0x33a0, 0x16240, 0x0, 0x0
.long 0x33b0, 0x16250, 0x0, 0x0
.long 0x3380, 0x16260, 0x0, 0x0
.long 0x3390, 0x16270, 0x0, 0x0
.long 0x3f80, 0x0, 0x0, 0x0
.long 0x3f800000, 0x0, 0x0, 0x0
.long 0x0, 0x3f80, 0x0, 0x0
.long 0x0, 0x3f800000, 0x0, 0x0
.long 0x0, 0x0, 0x0, 0x0
.long 0x0, 0x0, 0x0, 0x0
.long 0x0, 0x0, 0x0, 0x0
.long 0x0, 0x0, 0x0, 0x0
.long 0x0, 0x0, 0x3f80, 0x0
.long 0x0, 0x0, 0x3f800000, 0x0
.long 0x0, 0x0, 0x0, 0x3f80
.long 0x0, 0x0, 0x0, 0x3f800000
.long 0x0, 0x0, 0x0, 0x0
.long 0x0, 0x0, 0x0, 0x0
.long 0x0, 0x0, 0x0, 0x0
.long 0x0, 0x0, 0x0, 0x0
.long 0x0, 0x0, 0x0, 0x0
.long 0x0, 0x0, 0x0, 0x0
.long 0x0, 0x0, 0x0, 0x0
.long 0x0, 0x0, 0x0, 0x0
.long 0x0, 0x0, 0x0, 0x0
.long 0x0, 0x0, 0x0, 0x0
.long 0x0, 0x0, 0x0, 0x0
.long 0x0, 0x0, 0x0, 0x0
.long 0x0, 0x0, 0x0, 0x0
.long 0x0, 0x0, 0x0, 0x0
.long 0x0, 0x0, 0x0, 0x0
.long 0x0, 0x0, 0x0, 0x0
.long 0x0, 0x0, 0x0, 0x0
.long 0x0, 0x0, 0x0, 0x0
.long 0x0, 0x0, 0x0, 0x0
.long 0x0, 0x0, 0x0, 0x0
.long 0x0, 0x0, 0x0, 0x0
.long 0x0, 0x0, 0x0, 0x0
.long 0x0, 0x0, 0x0, 0x0
.long 0x0, 0x0, 0x0, 0x0
.long 0x3f80, 0x0, 0x0, 0x0
.long 0x3f800000, 0x0, 0x0, 0x0
.long 0x0, 0x3f80, 0x0, 0x0
.long 0x0, 0x3f800000, 0x0, 0x0
.long 0x0, 0x0, 0x0, 0x0
.long 0x0, 0x0, 0x0, 0x0
.long 0x0, 0x0, 0x0, 0x0
.long 0x0, 0x0, 0x0, 0x0
.long 0x0, 0x0, 0x3f80, 0x0
.long 0x0, 0x0, 0x3f800000, 0x0
.long 0x0, 0x0, 0x0, 0x3f80
.long 0x0, 0x0, 0x0, 0x3f800000
.long 0x0, 0x0, 0x0, 0x0
.long 0x0, 0x0, 0x0, 0x0
.long 0x0, 0x0, 0x0, 0x0
.long 0x0, 0x0, 0x0, 0x0
.long 0x0, 0x0, 0x0, 0x0
.long 0x0, 0x0, 0x0, 0x0
.long 0x0, 0x0, 0x0, 0x0
.long 0x0, 0x0, 0x0, 0x0
.long 0x0, 0x0, 0x0, 0x0
.long 0x0, 0x0, 0x0, 0x0
.long 0x0, 0x0, 0x0, 0x0
.long 0x0, 0x0, 0x0, 0x0
.long 0x0, 0x0, 0x0, 0x0
.long 0x0, 0x0, 0x0, 0x0
.long 0x0, 0x0, 0x0, 0x0
.long 0x0, 0x0, 0x0, 0x0
.long 0x3f80, 0x0, 0x0, 0x0
.long 0x3f800000, 0x0, 0x0, 0x0
.long 0x0, 0x3f80, 0x0, 0x0
.long 0x0, 0x3f800000, 0x0, 0x0
.long 0x0, 0x0, 0x0, 0x0
.long 0x0, 0x0, 0x0, 0x0
.long 0x0, 0x0, 0x0, 0x0
.long 0x0, 0x0, 0x0, 0x0
.long 0x0, 0x0, 0x3f80, 0x0
.long 0x0, 0x0, 0x3f800000, 0x0
.long 0x0, 0x0, 0x0, 0x3f80
.long 0x0, 0x0, 0x0, 0x3f800000
.long 0x0, 0x0, 0x0, 0x0
.long 0x0, 0x0, 0x0, 0x0
.long 0x0, 0x0, 0x0, 0x0
.long 0x0, 0x0, 0x0, 0x0
.long 0x0, 0x0, 0x0, 0x0
.long 0x0, 0x0, 0x0, 0x0
.long 0x0, 0x0, 0x0, 0x0
.long 0x0, 0x0, 0x0, 0x0
.long 0x0, 0x0, 0x0, 0x0
.long 0x0, 0x0, 0x0, 0x0
.long 0x0, 0x0, 0x0, 0x0
.long 0x0, 0x0, 0x0, 0x0
.long 0x0, 0x0, 0x0, 0x0
.long 0x0, 0x0, 0x0, 0x0
.long 0x0, 0x0, 0x0, 0x0
.long 0x0, 0x0, 0x0, 0x0
.long 0x0, 0x0, 0x0, 0x0
.long 0x0, 0x0, 0x0, 0x0
.long 0x0, 0x0, 0x0, 0x0
.long 0x0, 0x0, 0x0, 0x0
.long 0x0, 0x0, 0x0, 0x0
.long 0x0, 0x0, 0x0, 0x0
.long 0x0, 0x0, 0x0, 0x0
.long 0x0, 0x0, 0x0, 0x0
.long 0x3f80, 0x0, 0x0, 0x0
.long 0x3f800000, 0x0, 0x0, 0x0
.long 0x0, 0x3f80, 0x0, 0x0
.long 0x0, 0x3f800000, 0x0, 0x0
.long 0x0, 0x0, 0x0, 0x0
.long 0x0, 0x0, 0x0, 0x0
.long 0x0, 0x0, 0x0, 0x0
.long 0x0, 0x0, 0x0, 0x0
.long 0x0, 0x0, 0x3f80, 0x0
.long 0x0, 0x0, 0x3f800000, 0x0
.long 0x0, 0x0, 0x0, 0x3f80
.long 0x0, 0x0, 0x0, 0x3f800000
.long 0x0, 0x0, 0x0, 0x0
.long 0x0, 0x0, 0x0, 0x0
.long 0x0, 0x0, 0x0, 0x0
.long 0x0, 0x0, 0x0, 0x0
.long 0x0, 0x0, 0x0, 0x0
.long 0x0, 0x0, 0x0, 0x0
.long 0x0, 0x0, 0x0, 0x0
.long 0x0, 0x0, 0x0, 0x0
.long 0x0, 0x0, 0x0, 0x0
.long 0x0, 0x0, 0x0, 0x0
.long 0x0, 0x0, 0x0, 0x0
.long 0x0, 0x0, 0x0, 0x0
.long 0x0, 0x0, 0x0, 0x0
.long 0x0, 0x0, 0x0, 0x0
.long 0x0, 0x0, 0x0, 0x0
.long 0x0, 0x0, 0x0, 0x0
.long 0x3f80, 0x0, 0x0, 0x0
.long 0x3f800000, 0x0, 0x0, 0x0
.long 0x0, 0x3f80, 0x0, 0x0
.long 0x0, 0x3f800000, 0x0, 0x0
.long 0x0, 0x0, 0x0, 0x0
.long 0x0, 0x0, 0x0, 0x0
.long 0x0, 0x0, 0x0, 0x0
.long 0x0, 0x0, 0x0, 0x0
.long 0x0, 0x0, 0x3f80, 0x0
.long 0x0, 0x0, 0x3f800000, 0x0
.long 0x0, 0x0, 0x0, 0x3f80
.long 0x0, 0x0, 0x0, 0x3f800000
.long 0x0, 0x0, 0x0, 0x0
.long 0x0, 0x0, 0x0, 0x0
.long 0x0, 0x0, 0x0, 0x0
.long 0x0, 0x0, 0x0, 0x0
.long 0x0, 0x0, 0x0, 0x0
.long 0x0, 0x0, 0x0, 0x0
.long 0x0, 0x0, 0x0, 0x0
.long 0x0, 0x0, 0x0, 0x0
.long 0x0, 0x0, 0x0, 0x0
.long 0x0, 0x0, 0x0, 0x0
.long 0x0, 0x0, 0x0, 0x0
.long 0x0, 0x0, 0x0, 0x0
.long 0x0, 0x0, 0x0, 0x0
.long 0x0, 0x0, 0x0, 0x0
.long 0x0, 0x0, 0x0, 0x0
.long 0x0, 0x0, 0x0, 0x0
.long 0x0, 0x0, 0x0, 0x0
.long 0x0, 0x0, 0x0, 0x0
.long 0x0, 0x0, 0x0, 0x0
.long 0x0, 0x0, 0x0, 0x0
.long 0x0, 0x0, 0x0, 0x0
.long 0x0, 0x0, 0x0, 0x0
.long 0x0, 0x0, 0x0, 0x0
.long 0x0, 0x0, 0x0, 0x0
.long 0x3f80, 0x0, 0x0, 0x0
.long 0x3f800000, 0x0, 0x0, 0x0
.long 0x0, 0x3f80, 0x0, 0x0
.long 0x0, 0x3f800000, 0x0, 0x0
.long 0x0, 0x0, 0x0, 0x0
.long 0x0, 0x0, 0x0, 0x0
.long 0x0, 0x0, 0x0, 0x0
.long 0x0, 0x0, 0x0, 0x0
.long 0x0, 0x0, 0x3f80, 0x0
.long 0x0, 0x0, 0x3f800000, 0x0
.long 0x0, 0x0, 0x0, 0x3f80
.long 0x0, 0x0, 0x0, 0x3f800000
.long 0x0, 0x0, 0x0, 0x0
.long 0x0, 0x0, 0x0, 0x0
.long 0x0, 0x0, 0x0, 0x0
.long 0x0, 0x0, 0x0, 0x0
.long 0x0, 0x0, 0x0, 0x0
.long 0x0, 0x0, 0x0, 0x0
.long 0x0, 0x0, 0x0, 0x0
.long 0x0, 0x0, 0x0, 0x0
.long 0x0, 0x0, 0x0, 0x0
.long 0x0, 0x0, 0x0, 0x0
.long 0x0, 0x0, 0x0, 0x0
.long 0x0, 0x0, 0x0, 0x0
.long 0x0, 0x0, 0x0, 0x0
.long 0x0, 0x0, 0x0, 0x0
.long 0x0, 0x0, 0x0, 0x0
.long 0x0, 0x0, 0x0, 0x0
.long 0x3f80, 0x0, 0x0, 0x0
.long 0x3f800000, 0x0, 0x0, 0x0
.long 0x0, 0x3f80, 0x0, 0x0
.long 0x0, 0x3f800000, 0x0, 0x0
.long 0x0, 0x0, 0x0, 0x0
.long 0x0, 0x0, 0x0, 0x0
.long 0x0, 0x0, 0x0, 0x0
.long 0x0, 0x0, 0x0, 0x0
.long 0x0, 0x0, 0x3f80, 0x0
.long 0x0, 0x0, 0x3f800000, 0x0
.long 0x0, 0x0, 0x0, 0x3f80
.long 0x0, 0x0, 0x0, 0x3f800000
.long 0x0, 0x0, 0x0, 0x0
.long 0x0, 0x0, 0x0, 0x0
.long 0x0, 0x0, 0x0, 0x0
.long 0x0, 0x0, 0x0, 0x0
.long 0x0, 0x0, 0x0, 0x0
.long 0x0, 0x0, 0x0, 0x0
.long 0x0, 0x0, 0x0, 0x0
.long 0x0, 0x0, 0x0, 0x0
.long 0x0, 0x0, 0x0, 0x0
.long 0x0, 0x0, 0x0, 0x0
.long 0x0, 0x0, 0x0, 0x0
.long 0x0, 0x0, 0x0, 0x0
.long 0x0, 0x0, 0x0, 0x0
.long 0x0, 0x0, 0x0, 0x0
.long 0x0, 0x0, 0x0, 0x0
.long 0x0, 0x0, 0x0, 0x0
.long 0x0, 0x0, 0x0, 0x0
.long 0x0, 0x0, 0x0, 0x0
.long 0x0, 0x0, 0x0, 0x0
.long 0x0, 0x0, 0x0, 0x0
.long 0x0, 0x0, 0x0, 0x0
.long 0x0, 0x0, 0x0, 0x0
.long 0x0, 0x0, 0x0, 0x0
.long 0x0, 0x0, 0x0, 0x0
.long 0x3f80, 0x0, 0x0, 0x0
.long 0x3f800000, 0x0, 0x0, 0x0
.long 0x0, 0x3f80, 0x0, 0x0
.long 0x0, 0x3f800000, 0x0, 0x0
.long 0x0, 0x0, 0x0, 0x0
.long 0x0, 0x0, 0x0, 0x0
.long 0x0, 0x0, 0x0, 0x0
.long 0x0, 0x0, 0x0, 0x0
.long 0x0, 0x0, 0x3f80, 0x0
.long 0x0, 0x0, 0x3f800000, 0x0
.long 0x0, 0x0, 0x0, 0x3f80
.long 0x0, 0x0, 0x0, 0x3f800000
.long 0x0, 0x0, 0x0, 0x0
.long 0x0, 0x0, 0x0, 0x0
.long 0x0, 0x0, 0x0, 0x0
.long 0x0, 0x0, 0x0, 0x0
.long 0x0, 0x0, 0x0, 0x0
.long 0x0, 0x0, 0x0, 0x0
.long 0x0, 0x0, 0x0, 0x0
.long 0x0, 0x0, 0x0, 0x0
.long 0x0, 0x0, 0x0, 0x0
.long 0x0, 0x0, 0x0, 0x0
.long 0x0, 0x0, 0x0, 0x0
.long 0x0, 0x0, 0x0, 0x0
.long 0x0, 0x0, 0x0, 0x0
.long 0x0, 0x0, 0x0, 0x0
.long 0x0, 0x0, 0x0, 0x0
.long 0x0, 0x0, 0x0, 0x0
.long 0x0, 0x0, 0x0, 0x0
.long 0x0, 0x0, 0x0, 0x0
.long 0x0, 0x0, 0x0, 0x0
.long 0x0, 0x0, 0x0, 0x0
.long 0x0, 0x0, 0x0, 0x0
.long 0x0, 0x0, 0x0, 0x0
.long 0x0, 0x0, 0x0, 0x0
.long 0x0, 0x0, 0x0, 0x0
.long 0x0, 0x0, 0x0, 0x0
.long 0x0, 0x0, 0x0, 0x0
.long 0x0, 0x0, 0x0, 0x0
.long 0x0, 0x0, 0x0, 0x0
.long 0x0, 0x0, 0x0, 0x0
.long 0x0, 0x0, 0x0, 0x0
.long 0x0, 0x0, 0x0, 0x0
.long 0x0, 0x0, 0x0, 0x0
.long 0x3f80, 0x0, 0x0, 0x0
.long 0x3f800000, 0x0, 0x0, 0x0
.long 0x0, 0x3f80, 0x0, 0x0
.long 0x0, 0x3f800000, 0x0, 0x0
.long 0x0, 0x0, 0x0, 0x0
.long 0x0, 0x0, 0x0, 0x0
.long 0x0, 0x0, 0x0, 0x0
.long 0x0, 0x0, 0x0, 0x0
.long 0x0, 0x0, 0x3f80, 0x0
.long 0x0, 0x0, 0x3f800000, 0x0
.long 0x0, 0x0, 0x0, 0x3f80
.long 0x0, 0x0, 0x0, 0x3f800000
.long 0x0, 0x0, 0x0, 0x0
.long 0x0, 0x0, 0x0, 0x0
.long 0x0, 0x0, 0x0, 0x0
.long 0x0, 0x0, 0x0, 0x0
.long 0x0, 0x0, 0x0, 0x0
.long 0x0, 0x0, 0x0, 0x0
.long 0x0, 0x0, 0x0, 0x0
.long 0x0, 0x0, 0x0, 0x0
.long 0x0, 0x0, 0x0, 0x0
.long 0x0, 0x0, 0x0, 0x0
.long 0x0, 0x0, 0x0, 0x0
.long 0x0, 0x0, 0x0, 0x0
.long 0x0, 0x0, 0x0, 0x0
.long 0x0, 0x0, 0x0, 0x0
.long 0x0, 0x0, 0x0, 0x0
.long 0x0, 0x0, 0x0, 0x0
.long 0x0, 0x0, 0x0, 0x0
.long 0x0, 0x0, 0x0, 0x0
.long 0x0, 0x0, 0x0, 0x0
.long 0x0, 0x0, 0x0, 0x0
.long 0x0, 0x0, 0x0, 0x0
.long 0x0, 0x0, 0x0, 0x0
.long 0x0, 0x0, 0x0, 0x0
.long 0x0, 0x0, 0x0, 0x0
.long 0x3f80, 0x0, 0x0, 0x0
.long 0x3f800000, 0x0, 0x0, 0x0
.long 0x0, 0x3f80, 0x0, 0x0
.long 0x0, 0x3f800000, 0x0, 0x0
.long 0x0, 0x0, 0x0, 0x0
.long 0x0, 0x0, 0x0, 0x0
.long 0x0, 0x0, 0x0, 0x0
.long 0x0, 0x0, 0x0, 0x0
.long 0x0, 0x0, 0x3f80, 0x0
.long 0x0, 0x0, 0x3f800000, 0x0
.long 0x0, 0x0, 0x0, 0x3f80
.long 0x0, 0x0, 0x0, 0x3f800000
.long 0x0, 0x0, 0x0, 0x0
.long 0x0, 0x0, 0x0, 0x0
.long 0x0, 0x0, 0x0, 0x0
.long 0x0, 0x0, 0x0, 0x0
.long 0x0, 0x0, 0x0, 0x0
.long 0x0, 0x0, 0x0, 0x0
.long 0x0, 0x0, 0x0, 0x0
.long 0x0, 0x0, 0x0, 0x0
.long 0x0, 0x0, 0x0, 0x0
.long 0x0, 0x0, 0x0, 0x0
.long 0x0, 0x0, 0x0, 0x0
.long 0x0, 0x0, 0x0, 0x0
.long 0x0, 0x0, 0x0, 0x0
.long 0x0, 0x0, 0x0, 0x0
.long 0x0, 0x0, 0x0, 0x0
.long 0x0, 0x0, 0x0, 0x0
.long 0x3f80, 0x0, 0x0, 0x0
.long 0x3f800000, 0x0, 0x0, 0x0
.long 0x0, 0x3f80, 0x0, 0x0
.long 0x0, 0x3f800000, 0x0, 0x0
.long 0x0, 0x0, 0x0, 0x0
.long 0x0, 0x0, 0x0, 0x0
.long 0x0, 0x0, 0x0, 0x0
.long 0x0, 0x0, 0x0, 0x0
.long 0x0, 0x0, 0x3f80, 0x0
.long 0x0, 0x0, 0x3f800000, 0x0
.long 0x0, 0x0, 0x0, 0x3f80
.long 0x0, 0x0, 0x0, 0x3f800000
.long 0x0, 0x0, 0x0, 0x0
.long 0x0, 0x0, 0x0, 0x0
.long 0x0, 0x0, 0x0, 0x0
.long 0x0, 0x0, 0x0, 0x0
.long 0x0, 0x0, 0x0, 0x0
.long 0x0, 0x0, 0x0, 0x0
.long 0x0, 0x0, 0x0, 0x0
.long 0x0, 0x0, 0x0, 0x0
.long 0x0, 0x0, 0x0, 0x0
.long 0x0, 0x0, 0x0, 0x0
.long 0x0, 0x0, 0x0, 0x0
.long 0x0, 0x0, 0x0, 0x0
.long 0x0, 0x0, 0x0, 0x0
.long 0x0, 0x0, 0x0, 0x0
.long 0x0, 0x0, 0x0, 0x0
.long 0x0, 0x0, 0x0, 0x0
.long 0x0, 0x0, 0x0, 0x0
.long 0x0, 0x0, 0x0, 0x0
.long 0x0, 0x0, 0x0, 0x0
.long 0x0, 0x0, 0x0, 0x0
.long 0x0, 0x0, 0x0, 0x0
.long 0x0, 0x0, 0x0, 0x0
.long 0x0, 0x0, 0x0, 0x0
.long 0x0, 0x0, 0x0, 0x0
.long 0x3f80, 0x0, 0x0, 0x0
.long 0x3f800000, 0x0, 0x0, 0x0
.long 0x0, 0x3f80, 0x0, 0x0
.long 0x0, 0x3f800000, 0x0, 0x0
.long 0x0, 0x0, 0x0, 0x0
.long 0x0, 0x0, 0x0, 0x0
.long 0x0, 0x0, 0x0, 0x0
.long 0x0, 0x0, 0x0, 0x0
.long 0x0, 0x0, 0x3f80, 0x0
.long 0x0, 0x0, 0x3f800000, 0x0
.long 0x0, 0x0, 0x0, 0x3f80
.long 0x0, 0x0, 0x0, 0x3f800000
.long 0x0, 0x0, 0x0, 0x0
.long 0x0, 0x0, 0x0, 0x0
.long 0x0, 0x0, 0x0, 0x0
.long 0x0, 0x0, 0x0, 0x0
.long 0x0, 0x0, 0x0, 0x0
.long 0x0, 0x0, 0x0, 0x0
.long 0x0, 0x0, 0x0, 0x0
.long 0x0, 0x0, 0x0, 0x0
.long 0x0, 0x0, 0x0, 0x0
.long 0x0, 0x0, 0x0, 0x0
.long 0x0, 0x0, 0x0, 0x0
.long 0x0, 0x0, 0x0, 0x0
.long 0x0, 0x0, 0x0, 0x0
.long 0x0, 0x0, 0x0, 0x0
.long 0x0, 0x0, 0x0, 0x0
.long 0x0, 0x0, 0x0, 0x0
.long 0x3f80, 0x0, 0x0, 0x0
.long 0x3f800000, 0x0, 0x0, 0x0
.long 0x0, 0x3f80, 0x0, 0x0
.long 0x0, 0x3f800000, 0x0, 0x0
.long 0x0, 0x0, 0x0, 0x0
.long 0x0, 0x0, 0x0, 0x0
.long 0x0, 0x0, 0x0, 0x0
.long 0x0, 0x0, 0x0, 0x0
.long 0x0, 0x0, 0x3f80, 0x0
.long 0x0, 0x0, 0x3f800000, 0x0
.long 0x0, 0x0, 0x0, 0x3f80
.long 0x0, 0x0, 0x0, 0x3f800000
.long 0x0, 0x0, 0x0, 0x0
.long 0x0, 0x0, 0x0, 0x0
.long 0x0, 0x0, 0x0, 0x0
.long 0x0, 0x0, 0x0, 0x0
.long 0x0, 0x0, 0x0, 0x0
.long 0x0, 0x0, 0x0, 0x0
.long 0x0, 0x0, 0x0, 0x0
.long 0x0, 0x0, 0x0, 0x0
.long 0x0, 0x0, 0x0, 0x0
.long 0x0, 0x0, 0x0, 0x0
.long 0x0, 0x0, 0x0, 0x0
.long 0x0, 0x0, 0x0, 0x0
.long 0x0, 0x0, 0x0, 0x0
.long 0x0, 0x0, 0x0, 0x0
.long 0x0, 0x0, 0x0, 0x0
.long 0x0, 0x0, 0x0, 0x0
.long 0x0, 0x0, 0x0, 0x0
.long 0x0, 0x0, 0x0, 0x0
.long 0x0, 0x0, 0x0, 0x0
.long 0x0, 0x0, 0x0, 0x0
.long 0x0, 0x0, 0x0, 0x0
.long 0x0, 0x0, 0x0, 0x0
.long 0x0, 0x0, 0x0, 0x0
.long 0x0, 0x0, 0x0, 0x0
.long 0x3f80, 0x0, 0x0, 0x0
.long 0x3f800000, 0x0, 0x0, 0x0
.long 0x0, 0x3f80, 0x0, 0x0
.long 0x0, 0x3f800000, 0x0, 0x0
.long 0x0, 0x0, 0x0, 0x0
.long 0x0, 0x0, 0x0, 0x0
.long 0x0, 0x0, 0x0, 0x0
.long 0x0, 0x0, 0x0, 0x0
.long 0x0, 0x0, 0x3f80, 0x0
.long 0x0, 0x0, 0x3f800000, 0x0
.long 0x0, 0x0, 0x0, 0x3f80
.long 0x0, 0x0, 0x0, 0x3f800000
.long 0x0, 0x0, 0x0, 0x0
.long 0x0, 0x0, 0x0, 0x0
.long 0x0, 0x0, 0x0, 0x0
.long 0x0, 0x0, 0x0, 0x0
.long 0x0, 0x0, 0x0, 0x0
.long 0x0, 0x0, 0x0, 0x0
.long 0x0, 0x0, 0x0, 0x0
.long 0x0, 0x0, 0x0, 0x0
.long 0x0, 0x0, 0x0, 0x0
.long 0x0, 0x0, 0x0, 0x0
.long 0x0, 0x0, 0x0, 0x0
.long 0x0, 0x0, 0x0, 0x0
.long 0x0, 0x0, 0x0, 0x0
.long 0x0, 0x0, 0x0, 0x0
.long 0x0, 0x0, 0x0, 0x0
.long 0x0, 0x0, 0x0, 0x0
.long 0x3f80, 0x0, 0x0, 0x0
.long 0x3f800000, 0x0, 0x0, 0x0
.long 0x0, 0x3f80, 0x0, 0x0
.long 0x0, 0x3f800000, 0x0, 0x0
.long 0x0, 0x0, 0x0, 0x0
.long 0x0, 0x0, 0x0, 0x0
.long 0x0, 0x0, 0x0, 0x0
.long 0x0, 0x0, 0x0, 0x0
.long 0x0, 0x0, 0x3f80, 0x0
.long 0x0, 0x0, 0x3f800000, 0x0
.long 0x0, 0x0, 0x0, 0x3f80
.long 0x0, 0x0, 0x0, 0x3f800000
.long 0x0, 0x0, 0x0, 0x0
.long 0x0, 0x0, 0x0, 0x0
.long 0x0, 0x0, 0x0, 0x0
.long 0x0, 0x0, 0x0, 0x0
.long 0x0, 0x0, 0x0, 0x0
.long 0x0, 0x0, 0x0, 0x0
.long 0x0, 0x0, 0x0, 0x0
.long 0x0, 0x0, 0x0, 0x0
.long 0x0, 0x0, 0x0, 0x0
.long 0x0, 0x0, 0x0, 0x0
.long 0x0, 0x0, 0x0, 0x0
.long 0x0, 0x0, 0x0, 0x0
.long 0x0, 0x0, 0x0, 0x0
.long 0x0, 0x0, 0x0, 0x0
.long 0x0, 0x0, 0x0, 0x0
.long 0x0, 0x0, 0x0, 0x0
.long 0x0, 0x0, 0x0, 0x0
.long 0x0, 0x0, 0x0, 0x0
.long 0x0, 0x0, 0x0, 0x0
.long 0x0, 0x0, 0x0, 0x0
.long 0x0, 0x0, 0x0, 0x0
.long 0x0, 0x0, 0x0, 0x0
.long 0x0, 0x0, 0x0, 0x0
.long 0x0, 0x0, 0x0, 0x0
.long 0x3f80, 0x0, 0x0, 0x0
.long 0x3f800000, 0x0, 0x0, 0x0
.long 0x0, 0x3f80, 0x0, 0x0
.long 0x0, 0x3f800000, 0x0, 0x0
.long 0x0, 0x0, 0x0, 0x0
.long 0x0, 0x0, 0x0, 0x0
.long 0x0, 0x0, 0x0, 0x0
.long 0x0, 0x0, 0x0, 0x0
.long 0x0, 0x0, 0x3f80, 0x0
.long 0x0, 0x0, 0x3f800000, 0x0
.long 0x0, 0x0, 0x0, 0x3f80
.long 0x0, 0x0, 0x0, 0x3f800000
L_TEND:
.section .rodata,"a"
.p2align 6
.amdhsa_kernel standalone__convnext_block__vision_kernel
  .amdhsa_next_free_vgpr 512
  .amdhsa_next_free_sgpr 96
  .amdhsa_accum_offset 256
  .amdhsa_group_segment_fixed_size 0
  .amdhsa_kernarg_size 56
  .amdhsa_user_sgpr_count 2
  .amdhsa_user_sgpr_kernarg_segment_ptr 1
  .amdhsa_system_sgpr_workgroup_id_x 1
.end_amdhsa_kernel
```
